```python
import torch

def _softmax(x, axis=-1):
    return torch.softmax(x, dim=axis)
def _gelu(x):
    return torch.nn.functional.gelu(x, approximate="tanh")
def _silu(x):
    return torch.nn.functional.silu(x)
def _sigmoid(x):
    return torch.sigmoid(x)
def _layernorm(x, axis=-1, eps=1e-5):
    m = x.mean(dim=axis, keepdim=True)
    v = x.var(dim=axis, keepdim=True, unbiased=False)
    return (x - m) / torch.sqrt(v + eps)
def _scatter_add(tgt, idx, src, axis=0):
    return tgt.clone().index_add_(axis, idx, src)
def _segment_sum(src, seg, n):
    out = torch.zeros((n,) + src.shape[1:], dtype=src.dtype)
    return out.index_add_(0, seg, src)
def _pad(x, pw):
    flat = tuple(v for pair in reversed(pw) for v in pair)
    return torch.nn.functional.pad(x, flat)

kernel_name = 'concat_heads__mha_block_cached__gqa_block_cached__near_ridge'

def setup_inputs():

    _w = (lambda a: (lambda t: t.to(torch.bfloat16) if t.is_floating_point() else t)(torch.as_tensor(a)))
    def _A_setup():
        B, Sq, D = 8, 192, 640
        H, Sk, Dh = 32, 1024, 128
        return {
            "x": _w((lambda *s: torch.randn(*s, dtype=torch.bfloat16) * 0.8)(B, Sq, D)),
            "k_cache": _w((lambda *s: torch.randn(*s, dtype=torch.bfloat16) * 0.8)(B, H, Sk, Dh)),
            "v_cache": _w((lambda *s: torch.randn(*s, dtype=torch.bfloat16) * 0.05)(B, H, Sk, Dh)),
            "wq": _w((lambda *s: torch.randn(*s, dtype=torch.bfloat16) * 0.8)(D, H * Dh) * (D ** -0.5)),
            "wo": _w((lambda *s: torch.randn(*s, dtype=torch.bfloat16) * 0.05)(H * Dh, D) * ((H * Dh) ** -0.5)),
        }
    _A_in = _A_setup()

    def _B_setup():
        B, Sq, D = 8, 192, 640
        Hq, Hkv, Sk, Dh = 32, 32, 1024, 128
        assert Hq % Hkv == 0, (Hq, Hkv)
        return {
            "x": _w((lambda *s: torch.randn(*s, dtype=torch.bfloat16) * 0.8)(B, Sq, D)),
            "k_cache": _w((lambda *s: torch.randn(*s, dtype=torch.bfloat16) * 0.8)(B, Hkv, Sk, Dh)),
            "v_cache": _w((lambda *s: torch.randn(*s, dtype=torch.bfloat16) * 0.05)(B, Hkv, Sk, Dh)),
            "wq": _w((lambda *s: torch.randn(*s, dtype=torch.bfloat16) * 0.8)(D, Hq * Dh) * (D ** -0.5)),
            "wo": _w((lambda *s: torch.randn(*s, dtype=torch.bfloat16) * 0.05)(Hq * Dh, D) * ((Hq * Dh) ** -0.5)),
        }
    _B_in = _B_setup()

    return {
        "A_x": _A_in["x"],
        "A_k_cache": _A_in["k_cache"],
        "A_v_cache": _A_in["v_cache"],
        "A_wq": _A_in["wq"],
        "A_wo": _A_in["wo"],
        "B_x": _B_in["x"],
        "B_k_cache": _B_in["k_cache"],
        "B_v_cache": _B_in["v_cache"],
        "B_wq": _B_in["wq"],
        "B_wo": _B_in["wo"],
    }

def reference(A_x, A_k_cache, A_v_cache, A_wq, A_wo, B_x, B_k_cache, B_v_cache, B_wq, B_wo):
    def _A_ref(x, k_cache, v_cache, wq, wo):
        B, Sq, D = x.shape
        H, Dh = 32, 128
        q = (lambda x, *d: x.permute(*d))((x @ wq).reshape(B, Sq, H, Dh), 0, 2, 1, 3)
        scores = torch.einsum("bhqd,bhkd->bhqk", q, k_cache) * (Dh ** -0.5)
        p = _softmax(scores, axis=-1)
        o = torch.einsum("bhqk,bhkd->bhqd", p, v_cache)
        return (lambda x, *d: x.permute(*d))(o, 0, 2, 1, 3).reshape(B, Sq, H * Dh) @ wo

    def _B_ref(x, k_cache, v_cache, wq, wo):
        B, Sq, D = x.shape
        Hq, Dh = 32, 128
        Hkv = k_cache.shape[1]
        rep = Hq // Hkv
        q = (lambda x, *d: x.permute(*d))((x @ wq).reshape(B, Sq, Hq, Dh), 0, 2, 1, 3)
        k = (lambda x, n, axis: torch.repeat_interleave(x, n, dim=axis))(k_cache, rep, axis=1)
        v = (lambda x, n, axis: torch.repeat_interleave(x, n, dim=axis))(v_cache, rep, axis=1)
        scores = torch.einsum("bhqd,bhkd->bhqk", q, k) * (Dh ** -0.5)
        p = _softmax(scores, axis=-1)
        o = torch.einsum("bhqk,bhkd->bhqd", p, v)
        return (lambda x, *d: x.permute(*d))(o, 0, 2, 1, 3).reshape(B, Sq, Hq * Dh) @ wo

    a = _A_ref(A_x, A_k_cache, A_v_cache, A_wq, A_wo)
    b = _B_ref(B_x, B_k_cache, B_v_cache, B_wq, B_wo)
    return torch.concatenate([a, b], axis=-1)
```

```asm
; @launch grid=(256,1,1) block=(256,1,1) lds=163840
.amdgcn_target "amdgcn-amd-amdhsa--gfx950"
.text
.globl concat_heads__mha_block_cached__gqa_block_cached__near_ridge_kernel
.p2align 8
.type concat_heads__mha_block_cached__gqa_block_cached__near_ridge_kernel,@function
concat_heads__mha_block_cached__gqa_block_cached__near_ridge_kernel:
    s_cmp_ge_u32 s2, 256
    s_cbranch_scc1 L_END
    s_load_dwordx16 s[16:31], s[0:1], 0
    s_load_dwordx8 s[32:39], s[0:1], 64
    s_load_dwordx2 s[40:41], s[0:1], 96
    s_memrealtime s[96:97]
    v_lshrrev_b32 v17, 6, v0
    v_and_b32 v1, 63, v0
    s_getpc_b64 s[98:99]
    s_lshr_b32 s5, s2, 3
    s_lshl_b32 s5, s5, 11
    v_lshrrev_b32 v16, 4, v0
    v_lshl_add_u32 v16, v16, 7, s5
    global_load_dword v16, v16, s[98:99]
    s_and_b32 s4, s2, 7
    s_lshr_b32 s5, s2, 3
    v_readfirstlane_b32 s60, v17
    s_lshr_b32 s61, s4, 2
    s_and_b32 s4, s4, 3
    s_lshl_b32 s63, s4, 2
    s_and_b32 s6, s5, 3
    s_add_u32 s63, s63, s6
    s_lshr_b32 s62, s5, 2
    s_lshl_b32 s7, s61, 3
    s_add_u32 s7, s7, s62
    s_and_b32 s8, s60, 1
    s_lshr_b32 s9, s60, 1
    v_lshrrev_b32 v18, 4, v1
    v_and_b32 v19, 15, v1
    v_lshrrev_b32 v22, 3, v1
    v_lshlrev_b32 v23, 1, v18
    v_and_b32 v24, 7, v1
    v_xor_b32 v23, v23, v24
    v_mul_u32_u24 v22, 1280, v22
    v_lshl_add_u32 v4, v23, 4, v22
    s_mul_i32 s10, s60, 61440
    v_add_u32 v4, s10, v4
    v_add_u32 v5, 10240, v4
    v_add_u32 v6, 20480, v4
    v_add_u32 v7, 30720, v4
    v_add_u32 v8, 40960, v4
    v_add_u32 v9, 51200, v4
    v_lshrrev_b32 v22, 1, v18
    v_lshlrev_b32 v22, 2, v22
    v_and_b32 v23, 1, v18
    v_lshl_add_u32 v22, v23, 4, v22
    v_lshlrev_b32 v22, 13, v22
    v_lshl_add_u32 v10, v19, 4, v22
    s_lshl_b32 s10, s8, 16
    s_lshl_b32 s11, s9, 8
    s_add_u32 s10, s10, s11
    v_add_u32 v10, s10, v10
    v_add_u32 v11, 8192, v10
    v_add_u32 v12, 16384, v10
    v_add_u32 v13, 24576, v10
    s_mul_i32 s10, s9, 8416
    s_mul_i32 s11, s8, 1056
    s_add_u32 s69, s10, s11
    s_mul_i32 s70, s60, 6144
    s_mov_b32 s64, 0
    s_mov_b32 s65, 0
    s_waitcnt lgkmcnt(0)
    s_or_b32 s10, s63, s60
    s_cmp_lg_u32 s10, 0
    s_cbranch_scc1 L_NOLEAD
    s_lshl_b32 s10, s7, 3
    s_or_b32 s96, s96, 1
    v_mov_b32 v22, s10
    v_mov_b32 v24, s96
    v_mov_b32 v25, s97
    global_store_dwordx2 v22, v[24:25], s[38:39] sc1
L_NOLEAD:
    s_getpc_b64 s[96:97]
    s_cmp_eq_u32 s61, 0
    s_cselect_b64 s[44:45], s[16:17], s[26:27]
    s_cselect_b64 s[48:49], s[22:23], s[32:33]
    s_cselect_b64 s[12:13], s[18:19], s[28:29]
    s_cselect_b64 s[14:15], s[20:21], s[30:31]
    s_cselect_b64 s[84:85], s[24:25], s[34:35]
    s_mul_i32 s10, s62, 245760
    s_add_u32 s44, s44, s10
    s_addc_u32 s45, s45, 0
    s_and_b32 s45, s45, 0xffff
    s_mov_b32 s46, 245760
    s_mov_b32 s47, 0x20000
    s_lshl_b32 s10, s63, 9
    s_add_u32 s48, s48, s10
    s_addc_u32 s49, s49, 0
    s_and_b32 s49, s49, 0xffff
    s_sub_u32 s50, 5242880, s10
    s_mov_b32 s51, 0x20000
    s_add_u32 m0, s70, 134656
    s_nop 0
    buffer_load_dwordx4 v4, s[44:47], s64 offen  lds
    s_add_u32 m0, s70, 135680
    s_nop 0
    buffer_load_dwordx4 v5, s[44:47], s64 offen  lds
    s_add_u32 m0, s70, 136704
    s_nop 0
    buffer_load_dwordx4 v6, s[44:47], s64 offen  lds
    s_add_u32 m0, s70, 137728
    s_nop 0
    buffer_load_dwordx4 v7, s[44:47], s64 offen  lds
    s_add_u32 m0, s70, 138752
    s_nop 0
    buffer_load_dwordx4 v8, s[44:47], s64 offen  lds
    s_add_u32 m0, s70, 139776
    s_nop 0
    buffer_load_dwordx4 v9, s[44:47], s64 offen  lds
    s_add_u32 m0, s69, 100992
    s_nop 0
    buffer_load_dwordx4 v10, s[48:51], s65 offen  lds
    s_add_u32 m0, s69, 103104
    s_nop 0
    buffer_load_dwordx4 v11, s[48:51], s65 offen  lds
    s_add_u32 m0, s69, 105216
    s_nop 0
    buffer_load_dwordx4 v12, s[48:51], s65 offen  lds
    s_add_u32 m0, s69, 107328
    s_nop 0
    buffer_load_dwordx4 v13, s[48:51], s65 offen  lds
    s_add_u32 s64, s64, 128
    s_cmp_eq_u32 s64, 1280
    s_cselect_b32 s64, 0, s64
    s_add_u32 s65, s65, 262144
    s_cmp_eq_u32 s65, 5242880
    s_cselect_b32 s65, 0, s65
    s_add_u32 m0, s70, 33664
    s_nop 0
    buffer_load_dwordx4 v4, s[44:47], s64 offen  lds
    s_add_u32 m0, s70, 34688
    s_nop 0
    buffer_load_dwordx4 v5, s[44:47], s64 offen  lds
    s_add_u32 m0, s70, 35712
    s_nop 0
    buffer_load_dwordx4 v6, s[44:47], s64 offen  lds
    s_add_u32 m0, s70, 36736
    s_nop 0
    buffer_load_dwordx4 v7, s[44:47], s64 offen  lds
    s_add_u32 m0, s70, 37760
    s_nop 0
    buffer_load_dwordx4 v8, s[44:47], s64 offen  lds
    s_add_u32 m0, s70, 38784
    s_nop 0
    buffer_load_dwordx4 v9, s[44:47], s64 offen  lds
    s_add_u32 m0, s69, 117824
    s_nop 0
    buffer_load_dwordx4 v10, s[48:51], s65 offen  lds
    s_add_u32 m0, s69, 119936
    s_nop 0
    buffer_load_dwordx4 v11, s[48:51], s65 offen  lds
    s_add_u32 m0, s69, 122048
    s_nop 0
    buffer_load_dwordx4 v12, s[48:51], s65 offen  lds
    s_add_u32 m0, s69, 124160
    s_nop 0
    buffer_load_dwordx4 v13, s[48:51], s65 offen  lds
    s_add_u32 s64, s64, 128
    s_cmp_eq_u32 s64, 1280
    s_cselect_b32 s64, 0, s64
    s_add_u32 s65, s65, 262144
    s_cmp_eq_u32 s65, 5242880
    s_cselect_b32 s65, 0, s65
    v_lshlrev_b32 v0, 4, v1
    v_and_b32 v20, 3, v1
    v_bfe_u32 v21, v1, 2, 2
    v_and_b32 v22, 1, v18
    v_lshl_add_u32 v22, v21, 1, v22
    v_mul_u32_u24 v22, 1056, v22
    v_lshrrev_b32 v23, 1, v18
    v_lshl_add_u32 v22, v23, 8, v22
    v_lshl_add_u32 v26, v20, 3, v22
    v_xor_b32 v24, 2, v20
    v_lshl_add_u32 v27, v24, 3, v22
    v_and_b32 v22, 1, v21
    v_lshl_add_u32 v22, v20, 1, v22
    v_mul_u32_u24 v22, 1056, v22
    v_lshrrev_b32 v23, 1, v21
    v_lshl_add_u32 v22, v23, 8, v22
    v_lshlrev_b32 v23, 1, v18
    v_mov_b32 v24, 0x9c
    v_lshrrev_b32 v23, v23, v24
    v_and_b32 v23, 3, v23
    v_lshl_add_u32 v2, v23, 4, v22
    v_and_b32 v22, 6, v19
    v_xor_b32 v22, v22, v18
    v_lshlrev_b32 v22, 4, v22
    v_lshl_add_u32 v28, v19, 7, v22
    s_mul_i32 s10, s8, 12288
    v_add_u32 v28, s10, v28
    v_xor_b32 v29, 64, v28
    s_mul_i32 s10, s9, 16832
    v_add_u32 v2, s10, v2
    s_add_u32 s10, s10, 8416
    v_add_u32 v3, s10, v26
    s_mul_i32 s10, s9, 8416
    v_add_u32 v26, s10, v26
    v_add_u32 v27, s10, v27
    s_mul_i32 s75, s60, 8416
    s_cmp_eq_u32 s8, 0
    s_cselect_b64 s[52:53], s[12:13], s[14:15]
    s_lshl_b32 s10, s62, 5
    s_lshl_b32 s11, s63, 1
    s_add_u32 s11, s11, s9
    s_add_u32 s10, s10, s11
    s_lshl_b32 s10, s10, 18
    s_add_u32 s52, s52, s10
    s_addc_u32 s53, s53, 0
    s_and_b32 s53, s53, 0xffff
    s_mov_b32 s54, 262144
    s_mov_b32 s55, 0x20000
    s_lshl_b32 s71, s2, 1
    s_add_u32 s71, s71, s9
    s_mul_i32 s71, s71, 0x9E3779B1
    s_lshr_b32 s71, s71, 24
    s_lshl_b32 s71, s71, 10
    s_add_u32 s72, s71, 4096
    s_mov_b32 s80, 100992
    s_mov_b32 s81, 117824
    s_mov_b32 s82, 82816
    s_mov_b32 s66, 134656
    s_mov_b32 s67, 33664
    s_mov_b32 s83, 58240
    v_add_u32 v14, s66, v28
    v_add_u32 v30, s80, v26
    v_add_u32 v31, s80, v27
    s_add_u32 s73, s82, s69
    s_add_u32 s74, s83, s70
    s_waitcnt vmcnt(10)
    s_barrier
    s_add_u32 m0, s74, 0
    ds_read_b128 a[160:163], v14 offset:0
    ds_read_b128 a[164:167], v14 offset:2048
    ds_read_b128 a[168:171], v14 offset:4096
    buffer_load_dwordx4 v4, s[44:47], s64 offen  lds
    s_add_u32 m0, s74, 1024
    ds_read_b128 a[172:175], v14 offset:6144
    ds_read_b128 a[176:179], v14 offset:8192
    ds_read_b128 a[180:183], v14 offset:10240
    buffer_load_dwordx4 v5, s[44:47], s64 offen  lds
    s_add_u32 m0, s74, 2048
    ds_read_b64_tr_b16 a[96:97], v30 offset:0
    ds_read_b64_tr_b16 a[98:99], v30 offset:512
    ds_read_b64_tr_b16 a[100:101], v31 offset:32
    ds_read_b64_tr_b16 a[102:103], v31 offset:544
    buffer_load_dwordx4 v6, s[44:47], s64 offen  lds
    s_add_u32 m0, s73, 0
    ds_read_b64_tr_b16 a[104:105], v30 offset:64
    ds_read_b64_tr_b16 a[106:107], v30 offset:576
    ds_read_b64_tr_b16 a[108:109], v31 offset:96
    buffer_load_dwordx4 v10, s[48:51], s65 offen  lds
    s_add_u32 m0, s73, 2112
    ds_read_b64_tr_b16 a[110:111], v31 offset:608
    ds_read_b64_tr_b16 a[112:113], v30 offset:128
    buffer_load_dwordx4 v11, s[48:51], s65 offen  lds
    s_add_u32 m0, s73, 4224
    ds_read_b64_tr_b16 a[114:115], v30 offset:640
    ds_read_b64_tr_b16 a[116:117], v31 offset:160
    ds_read_b64_tr_b16 a[118:119], v31 offset:672
    ds_read_b64_tr_b16 a[120:121], v30 offset:192
    buffer_load_dwordx4 v12, s[48:51], s65 offen  lds
    s_add_u32 m0, s73, 6336
    ds_read_b64_tr_b16 a[122:123], v30 offset:704
    ds_read_b64_tr_b16 a[124:125], v31 offset:224
    ds_read_b64_tr_b16 a[126:127], v31 offset:736
    buffer_load_dwordx4 v13, s[48:51], s65 offen  lds
    s_add_u32 s65, s65, 262144
    s_cmp_eq_u32 s65, 5242880
    s_cselect_b32 s65, 0, s65
    s_add_u32 s73, s80, s69
    s_mov_b32 s10, s80
    s_mov_b32 s80, s81
    s_mov_b32 s81, s82
    s_mov_b32 s82, s10
    v_add_u32 v30, s80, v26
    v_add_u32 v31, s80, v27
    v_add_u32 v14, s66, v29
    s_waitcnt vmcnt(7) lgkmcnt(0)
    s_barrier
    v_mfma_f32_16x16x32_bf16 v[64:67], a[96:99], a[160:163], 0
    s_add_u32 m0, s74, 3072
    ds_read_b128 a[192:195], v14 offset:0
    v_mfma_f32_16x16x32_bf16 v[96:99], a[96:99], a[164:167], 0
    ds_read_b128 a[196:199], v14 offset:2048
    v_mfma_f32_16x16x32_bf16 v[128:131], a[96:99], a[168:171], 0
    v_mfma_f32_16x16x32_bf16 v[160:163], a[96:99], a[172:175], 0
    ds_read_b128 a[200:203], v14 offset:4096
    v_mfma_f32_16x16x32_bf16 v[192:195], a[96:99], a[176:179], 0
    buffer_load_dwordx4 v7, s[44:47], s64 offen  lds
    s_add_u32 m0, s74, 4096
    v_mfma_f32_16x16x32_bf16 v[224:227], a[96:99], a[180:183], 0
    ds_read_b128 a[204:207], v14 offset:6144
    v_mfma_f32_16x16x32_bf16 v[68:71], a[100:103], a[160:163], 0
    ds_read_b128 a[208:211], v14 offset:8192
    v_mfma_f32_16x16x32_bf16 v[100:103], a[100:103], a[164:167], 0
    ds_read_b128 a[212:215], v14 offset:10240
    v_mfma_f32_16x16x32_bf16 v[132:135], a[100:103], a[168:171], 0
    v_mfma_f32_16x16x32_bf16 v[164:167], a[100:103], a[172:175], 0
    buffer_load_dwordx4 v8, s[44:47], s64 offen  lds
    s_add_u32 m0, s74, 5120
    v_mfma_f32_16x16x32_bf16 v[196:199], a[100:103], a[176:179], 0
    ds_read_b64_tr_b16 a[128:129], v30 offset:0
    ds_read_b64_tr_b16 a[130:131], v30 offset:512
    v_mfma_f32_16x16x32_bf16 v[228:231], a[100:103], a[180:183], 0
    v_mfma_f32_16x16x32_bf16 v[72:75], a[104:107], a[160:163], 0
    ds_read_b64_tr_b16 a[132:133], v31 offset:32
    v_mfma_f32_16x16x32_bf16 v[104:107], a[104:107], a[164:167], 0
    ds_read_b64_tr_b16 a[134:135], v31 offset:544
    v_mfma_f32_16x16x32_bf16 v[136:139], a[104:107], a[168:171], 0
    buffer_load_dwordx4 v9, s[44:47], s64 offen  lds
    s_add_u32 m0, s73, 0
    v_mfma_f32_16x16x32_bf16 v[168:171], a[104:107], a[172:175], 0
    ds_read_b64_tr_b16 a[136:137], v30 offset:64
    v_mfma_f32_16x16x32_bf16 v[200:203], a[104:107], a[176:179], 0
    v_mfma_f32_16x16x32_bf16 v[232:235], a[104:107], a[180:183], 0
    ds_read_b64_tr_b16 a[138:139], v30 offset:576
    v_mfma_f32_16x16x32_bf16 v[76:79], a[108:111], a[160:163], 0
    ds_read_b64_tr_b16 a[140:141], v31 offset:96
    v_mfma_f32_16x16x32_bf16 v[108:111], a[108:111], a[164:167], 0
    buffer_load_dwordx4 v10, s[48:51], s65 offen  lds
    s_add_u32 m0, s73, 2112
    v_mfma_f32_16x16x32_bf16 v[140:143], a[108:111], a[168:171], 0
    ds_read_b64_tr_b16 a[142:143], v31 offset:608
    v_mfma_f32_16x16x32_bf16 v[172:175], a[108:111], a[172:175], 0
    ds_read_b64_tr_b16 a[144:145], v30 offset:128
    v_mfma_f32_16x16x32_bf16 v[204:207], a[108:111], a[176:179], 0
    v_mfma_f32_16x16x32_bf16 v[236:239], a[108:111], a[180:183], 0
    buffer_load_dwordx4 v11, s[48:51], s65 offen  lds
    s_add_u32 m0, s73, 4224
    v_mfma_f32_16x16x32_bf16 v[80:83], a[112:115], a[160:163], 0
    ds_read_b64_tr_b16 a[146:147], v30 offset:640
    ds_read_b64_tr_b16 a[148:149], v31 offset:160
    v_mfma_f32_16x16x32_bf16 v[112:115], a[112:115], a[164:167], 0
    v_mfma_f32_16x16x32_bf16 v[144:147], a[112:115], a[168:171], 0
    ds_read_b64_tr_b16 a[150:151], v31 offset:672
    v_mfma_f32_16x16x32_bf16 v[176:179], a[112:115], a[172:175], 0
    ds_read_b64_tr_b16 a[152:153], v30 offset:192
    v_mfma_f32_16x16x32_bf16 v[208:211], a[112:115], a[176:179], 0
    buffer_load_dwordx4 v12, s[48:51], s65 offen  lds
    s_add_u32 m0, s73, 6336
    v_mfma_f32_16x16x32_bf16 v[240:243], a[112:115], a[180:183], 0
    ds_read_b64_tr_b16 a[154:155], v30 offset:704
    v_mfma_f32_16x16x32_bf16 v[84:87], a[116:119], a[160:163], 0
    ds_read_b64_tr_b16 a[156:157], v31 offset:224
    v_mfma_f32_16x16x32_bf16 v[116:119], a[116:119], a[164:167], 0
    v_mfma_f32_16x16x32_bf16 v[148:151], a[116:119], a[168:171], 0
    ds_read_b64_tr_b16 a[158:159], v31 offset:736
    v_mfma_f32_16x16x32_bf16 v[180:183], a[116:119], a[172:175], 0
    buffer_load_dwordx4 v13, s[48:51], s65 offen  lds
    v_mfma_f32_16x16x32_bf16 v[212:215], a[116:119], a[176:179], 0
    v_mfma_f32_16x16x32_bf16 v[244:247], a[116:119], a[180:183], 0
    v_mfma_f32_16x16x32_bf16 v[88:91], a[120:123], a[160:163], 0
    v_mfma_f32_16x16x32_bf16 v[120:123], a[120:123], a[164:167], 0
    v_mfma_f32_16x16x32_bf16 v[152:155], a[120:123], a[168:171], 0
    s_add_u32 s65, s65, 262144
    s_cmp_eq_u32 s65, 5242880
    v_mfma_f32_16x16x32_bf16 v[184:187], a[120:123], a[172:175], 0
    s_cselect_b32 s65, 0, s65
    s_add_u32 s73, s80, s69
    v_mfma_f32_16x16x32_bf16 v[216:219], a[120:123], a[176:179], 0
    s_mov_b32 s10, s80
    s_mov_b32 s80, s81
    v_mfma_f32_16x16x32_bf16 v[248:251], a[120:123], a[180:183], 0
    s_mov_b32 s81, s82
    s_mov_b32 s82, s10
    v_mfma_f32_16x16x32_bf16 v[92:95], a[124:127], a[160:163], 0
    v_add_u32 v30, s80, v26
    v_add_u32 v31, s80, v27
    v_mfma_f32_16x16x32_bf16 v[124:127], a[124:127], a[164:167], 0
    s_add_u32 s64, s64, 128
    s_cmp_eq_u32 s64, 1280
    v_mfma_f32_16x16x32_bf16 v[156:159], a[124:127], a[168:171], 0
    s_cselect_b32 s64, 0, s64
    s_add_u32 s74, s66, s70
    v_mfma_f32_16x16x32_bf16 v[188:191], a[124:127], a[172:175], 0
    s_mov_b32 s10, s66
    s_mov_b32 s66, s67
    v_mfma_f32_16x16x32_bf16 v[220:223], a[124:127], a[176:179], 0
    s_mov_b32 s67, s83
    s_mov_b32 s83, s10
    v_mfma_f32_16x16x32_bf16 v[252:255], a[124:127], a[180:183], 0
    v_add_u32 v14, s66, v28
    s_waitcnt vmcnt(7) lgkmcnt(0)
    s_barrier
    v_mfma_f32_16x16x32_bf16 v[64:67], a[128:131], a[192:195], v[64:67]
    s_add_u32 m0, s74, 0
    ds_read_b128 a[160:163], v14 offset:0
    v_mfma_f32_16x16x32_bf16 v[96:99], a[128:131], a[196:199], v[96:99]
    ds_read_b128 a[164:167], v14 offset:2048
    s_lshl_b32 s35, s63, 1
    v_mfma_f32_16x16x32_bf16 v[128:131], a[128:131], a[200:203], v[128:131]
    s_add_u32 s35, s35, s9
    v_mfma_f32_16x16x32_bf16 v[160:163], a[128:131], a[204:207], v[160:163]
    ds_read_b128 a[168:171], v14 offset:4096
    v_mfma_f32_16x16x32_bf16 v[192:195], a[128:131], a[208:211], v[192:195]
    buffer_load_dwordx4 v4, s[44:47], s64 offen  lds
    s_add_u32 m0, s74, 1024
    v_mfma_f32_16x16x32_bf16 v[224:227], a[128:131], a[212:215], v[224:227]
    ds_read_b128 a[172:175], v14 offset:6144
    s_mul_i32 s34, s7, 12
    v_mfma_f32_16x16x32_bf16 v[68:71], a[132:135], a[192:195], v[68:71]
    ds_read_b128 a[176:179], v14 offset:8192
    v_mfma_f32_16x16x32_bf16 v[100:103], a[132:135], a[196:199], v[100:103]
    ds_read_b128 a[180:183], v14 offset:10240
    s_mul_i32 s3, s8, 6
    v_mfma_f32_16x16x32_bf16 v[132:135], a[132:135], a[200:203], v[132:135]
    v_mfma_f32_16x16x32_bf16 v[164:167], a[132:135], a[204:207], v[164:167]
    buffer_load_dwordx4 v5, s[44:47], s64 offen  lds
    s_add_u32 m0, s74, 2048
    v_mfma_f32_16x16x32_bf16 v[196:199], a[132:135], a[208:211], v[196:199]
    ds_read_b64_tr_b16 a[96:97], v30 offset:0
    ds_read_b64_tr_b16 a[98:99], v30 offset:512
    v_mfma_f32_16x16x32_bf16 v[228:231], a[132:135], a[212:215], v[228:231]
    s_add_u32 s34, s34, s3
    v_mfma_f32_16x16x32_bf16 v[72:75], a[136:139], a[192:195], v[72:75]
    ds_read_b64_tr_b16 a[100:101], v31 offset:32
    s_lshl_b32 s34, s34, 17
    v_mfma_f32_16x16x32_bf16 v[104:107], a[136:139], a[196:199], v[104:107]
    ds_read_b64_tr_b16 a[102:103], v31 offset:544
    v_mfma_f32_16x16x32_bf16 v[136:139], a[136:139], a[200:203], v[136:139]
    buffer_load_dwordx4 v6, s[44:47], s64 offen  lds
    s_add_u32 m0, s73, 0
    v_mfma_f32_16x16x32_bf16 v[168:171], a[136:139], a[204:207], v[168:171]
    ds_read_b64_tr_b16 a[104:105], v30 offset:64
    s_lshl_b32 s35, s35, 12
    v_mfma_f32_16x16x32_bf16 v[200:203], a[136:139], a[208:211], v[200:203]
    v_mfma_f32_16x16x32_bf16 v[232:235], a[136:139], a[212:215], v[232:235]
    ds_read_b64_tr_b16 a[106:107], v30 offset:576
    v_mfma_f32_16x16x32_bf16 v[76:79], a[140:143], a[192:195], v[76:79]
    ds_read_b64_tr_b16 a[108:109], v31 offset:96
    s_add_u32 s34, s34, s35
    v_mfma_f32_16x16x32_bf16 v[108:111], a[140:143], a[196:199], v[108:111]
    buffer_load_dwordx4 v10, s[48:51], s65 offen  lds
    s_add_u32 m0, s73, 2112
    v_mfma_f32_16x16x32_bf16 v[140:143], a[140:143], a[200:203], v[140:143]
    ds_read_b64_tr_b16 a[110:111], v31 offset:608
    s_add_u32 s56, s40, s34
    s_addc_u32 s57, s41, 0
    v_mfma_f32_16x16x32_bf16 v[172:175], a[140:143], a[204:207], v[172:175]
    ds_read_b64_tr_b16 a[112:113], v30 offset:128
    v_mfma_f32_16x16x32_bf16 v[204:207], a[140:143], a[208:211], v[204:207]
    v_mfma_f32_16x16x32_bf16 v[236:239], a[140:143], a[212:215], v[236:239]
    buffer_load_dwordx4 v11, s[48:51], s65 offen  lds
    s_add_u32 m0, s73, 4224
    v_mfma_f32_16x16x32_bf16 v[80:83], a[144:147], a[192:195], v[80:83]
    ds_read_b64_tr_b16 a[114:115], v30 offset:640
    ds_read_b64_tr_b16 a[116:117], v31 offset:160
    v_mfma_f32_16x16x32_bf16 v[112:115], a[144:147], a[196:199], v[112:115]
    s_and_b32 s57, s57, 0xffff
    s_mov_b32 s58, 659456
    v_mfma_f32_16x16x32_bf16 v[144:147], a[144:147], a[200:203], v[144:147]
    ds_read_b64_tr_b16 a[118:119], v31 offset:672
    v_mfma_f32_16x16x32_bf16 v[176:179], a[144:147], a[204:207], v[176:179]
    ds_read_b64_tr_b16 a[120:121], v30 offset:192
    v_mfma_f32_16x16x32_bf16 v[208:211], a[144:147], a[208:211], v[208:211]
    buffer_load_dwordx4 v12, s[48:51], s65 offen  lds
    s_add_u32 m0, s73, 6336
    v_mfma_f32_16x16x32_bf16 v[240:243], a[144:147], a[212:215], v[240:243]
    ds_read_b64_tr_b16 a[122:123], v30 offset:704
    s_mov_b32 s59, 0x20000
    v_mfma_f32_16x16x32_bf16 v[84:87], a[148:151], a[192:195], v[84:87]
    ds_read_b64_tr_b16 a[124:125], v31 offset:224
    s_mul_i32 s34, s4, 1310720
    v_mfma_f32_16x16x32_bf16 v[116:119], a[148:151], a[196:199], v[116:119]
    v_mfma_f32_16x16x32_bf16 v[148:151], a[148:151], a[200:203], v[148:151]
    ds_read_b64_tr_b16 a[126:127], v31 offset:736
    v_mfma_f32_16x16x32_bf16 v[180:183], a[148:151], a[204:207], v[180:183]
    buffer_load_dwordx4 v13, s[48:51], s65 offen  lds
    s_add_u32 s92, s84, s34
    s_addc_u32 s93, s85, 0
    v_mfma_f32_16x16x32_bf16 v[212:215], a[148:151], a[208:211], v[212:215]
    v_mfma_f32_16x16x32_bf16 v[244:247], a[148:151], a[212:215], v[244:247]
    v_mfma_f32_16x16x32_bf16 v[88:91], a[152:155], a[192:195], v[88:91]
    v_mfma_f32_16x16x32_bf16 v[120:123], a[152:155], a[196:199], v[120:123]
    v_mfma_f32_16x16x32_bf16 v[152:155], a[152:155], a[200:203], v[152:155]
    s_add_u32 s65, s65, 262144
    s_cmp_eq_u32 s65, 5242880
    v_mfma_f32_16x16x32_bf16 v[184:187], a[152:155], a[204:207], v[184:187]
    s_cselect_b32 s65, 0, s65
    s_add_u32 s73, s80, s69
    v_mfma_f32_16x16x32_bf16 v[216:219], a[152:155], a[208:211], v[216:219]
    s_mov_b32 s10, s80
    s_mov_b32 s80, s81
    v_mfma_f32_16x16x32_bf16 v[248:251], a[152:155], a[212:215], v[248:251]
    s_mov_b32 s81, s82
    s_mov_b32 s82, s10
    v_mfma_f32_16x16x32_bf16 v[92:95], a[156:159], a[192:195], v[92:95]
    v_add_u32 v30, s80, v26
    v_add_u32 v31, s80, v27
    v_mfma_f32_16x16x32_bf16 v[124:127], a[156:159], a[196:199], v[124:127]
    v_add_u32 v14, s66, v29
    v_mfma_f32_16x16x32_bf16 v[156:159], a[156:159], a[200:203], v[156:159]
    v_mfma_f32_16x16x32_bf16 v[188:191], a[156:159], a[204:207], v[188:191]
    v_mfma_f32_16x16x32_bf16 v[220:223], a[156:159], a[208:211], v[220:223]
    v_mfma_f32_16x16x32_bf16 v[252:255], a[156:159], a[212:215], v[252:255]
    s_waitcnt vmcnt(7) lgkmcnt(0)
    s_barrier
    v_mfma_f32_16x16x32_bf16 v[64:67], a[96:99], a[160:163], v[64:67]
    s_add_u32 m0, s74, 3072
    ds_read_b128 a[192:195], v14 offset:0
    v_mfma_f32_16x16x32_bf16 v[96:99], a[96:99], a[164:167], v[96:99]
    ds_read_b128 a[196:199], v14 offset:2048
    s_and_b32 s93, s93, 0xffff
    v_mfma_f32_16x16x32_bf16 v[128:131], a[96:99], a[168:171], v[128:131]
    s_mov_b32 s94, 1310720
    v_mfma_f32_16x16x32_bf16 v[160:163], a[96:99], a[172:175], v[160:163]
    buffer_load_dwordx4 v7, s[44:47], s64 offen  lds
    s_add_u32 m0, s74, 4096
    v_mfma_f32_16x16x32_bf16 v[192:195], a[96:99], a[176:179], v[192:195]
    ds_read_b128 a[200:203], v14 offset:4096
    ds_read_b128 a[204:207], v14 offset:6144
    v_mfma_f32_16x16x32_bf16 v[224:227], a[96:99], a[180:183], v[224:227]
    s_mov_b32 s95, 0x20000
    v_mfma_f32_16x16x32_bf16 v[68:71], a[100:103], a[160:163], v[68:71]
    buffer_load_dwordx4 v8, s[44:47], s64 offen  lds
    s_add_u32 m0, s74, 5120
    v_mfma_f32_16x16x32_bf16 v[100:103], a[100:103], a[164:167], v[100:103]
    ds_read_b128 a[208:211], v14 offset:8192
    ds_read_b128 a[212:215], v14 offset:10240
    v_mfma_f32_16x16x32_bf16 v[132:135], a[100:103], a[168:171], v[132:135]
    s_mul_i32 s35, s6, 320
    v_mfma_f32_16x16x32_bf16 v[164:167], a[100:103], a[172:175], v[164:167]
    ds_read_b64_tr_b16 a[128:129], v30 offset:0
    v_mfma_f32_16x16x32_bf16 v[196:199], a[100:103], a[176:179], v[196:199]
    buffer_load_dwordx4 v9, s[44:47], s64 offen  lds
    s_add_u32 m0, s73, 0
    v_mfma_f32_16x16x32_bf16 v[228:231], a[100:103], a[180:183], v[228:231]
    ds_read_b64_tr_b16 a[130:131], v30 offset:512
    s_add_u32 s34, s34, s35
    v_mfma_f32_16x16x32_bf16 v[72:75], a[104:107], a[160:163], v[72:75]
    ds_read_b64_tr_b16 a[132:133], v31 offset:32
    s_add_u32 s84, s84, s34
    s_addc_u32 s85, s85, 0
    v_mfma_f32_16x16x32_bf16 v[104:107], a[104:107], a[164:167], v[104:107]
    buffer_load_dwordx4 v10, s[48:51], s65 offen  lds
    s_add_u32 m0, s73, 2112
    v_mfma_f32_16x16x32_bf16 v[136:139], a[104:107], a[168:171], v[136:139]
    ds_read_b64_tr_b16 a[134:135], v31 offset:544
    v_mfma_f32_16x16x32_bf16 v[168:171], a[104:107], a[172:175], v[168:171]
    ds_read_b64_tr_b16 a[136:137], v30 offset:64
    s_and_b32 s85, s85, 0xffff
    v_mfma_f32_16x16x32_bf16 v[200:203], a[104:107], a[176:179], v[200:203]
    v_mfma_f32_16x16x32_bf16 v[232:235], a[104:107], a[180:183], v[232:235]
    buffer_load_dwordx4 v11, s[48:51], s65 offen  lds
    s_add_u32 m0, s73, 4224
    v_mfma_f32_16x16x32_bf16 v[76:79], a[108:111], a[160:163], v[76:79]
    ds_read_b64_tr_b16 a[138:139], v30 offset:576
    ds_read_b64_tr_b16 a[140:141], v31 offset:96
    v_mfma_f32_16x16x32_bf16 v[108:111], a[108:111], a[164:167], v[108:111]
    s_sub_u32 s86, 5242880, s34
    v_mfma_f32_16x16x32_bf16 v[140:143], a[108:111], a[168:171], v[140:143]
    buffer_load_dwordx4 v12, s[48:51], s65 offen  lds
    s_add_u32 m0, s73, 6336
    v_mfma_f32_16x16x32_bf16 v[172:175], a[108:111], a[172:175], v[172:175]
    ds_read_b64_tr_b16 a[142:143], v31 offset:608
    ds_read_b64_tr_b16 a[144:145], v30 offset:128
    v_mfma_f32_16x16x32_bf16 v[204:207], a[108:111], a[176:179], v[204:207]
    s_mov_b32 s87, 0x20000
    v_mfma_f32_16x16x32_bf16 v[236:239], a[108:111], a[180:183], v[236:239]
    ds_read_b64_tr_b16 a[146:147], v30 offset:640
    s_mul_i32 s34, s7, 12
    v_mfma_f32_16x16x32_bf16 v[80:83], a[112:115], a[160:163], v[80:83]
    buffer_load_dwordx4 v13, s[48:51], s65 offen  lds
    s_add_u32 m0, s75, 0
    s_add_u32 s71, s71, 1024
    s_and_b32 s71, s71, 0x3ffff
    v_mfma_f32_16x16x32_bf16 v[112:115], a[112:115], a[164:167], v[112:115]
    ds_read_b64_tr_b16 a[148:149], v31 offset:160
    s_mul_i32 s35, s60, 3
    v_mfma_f32_16x16x32_bf16 v[144:147], a[112:115], a[168:171], v[144:147]
    ds_read_b64_tr_b16 a[150:151], v31 offset:672
    v_mfma_f32_16x16x32_bf16 v[176:179], a[112:115], a[172:175], v[176:179]
    buffer_load_dwordx4 v0, s[52:55], s71 offen nt lds
    s_add_u32 m0, s75, 1056
    s_add_u32 s71, s71, 1024
    s_and_b32 s71, s71, 0x3ffff
    v_mfma_f32_16x16x32_bf16 v[208:211], a[112:115], a[176:179], v[208:211]
    ds_read_b64_tr_b16 a[152:153], v30 offset:192
    s_add_u32 s34, s34, s35
    v_mfma_f32_16x16x32_bf16 v[240:243], a[112:115], a[180:183], v[240:243]
    ds_read_b64_tr_b16 a[154:155], v30 offset:704
    v_mfma_f32_16x16x32_bf16 v[84:87], a[116:119], a[160:163], v[84:87]
    ds_read_b64_tr_b16 a[156:157], v31 offset:224
    s_lshl_b32 s34, s34, 17
    v_mfma_f32_16x16x32_bf16 v[116:119], a[116:119], a[164:167], v[116:119]
    buffer_load_dwordx4 v0, s[52:55], s71 offen nt lds
    s_add_u32 m0, s75, 2112
    s_add_u32 s71, s71, 1024
    s_and_b32 s71, s71, 0x3ffff
    v_mfma_f32_16x16x32_bf16 v[148:151], a[116:119], a[168:171], v[148:151]
    ds_read_b64_tr_b16 a[158:159], v31 offset:736
    v_mfma_f32_16x16x32_bf16 v[180:183], a[116:119], a[172:175], v[180:183]
    s_lshl_b32 s35, s4, 15
    v_mfma_f32_16x16x32_bf16 v[212:215], a[116:119], a[176:179], v[212:215]
    buffer_load_dwordx4 v0, s[52:55], s71 offen nt lds
    v_mfma_f32_16x16x32_bf16 v[244:247], a[116:119], a[180:183], v[244:247]
    v_mfma_f32_16x16x32_bf16 v[88:91], a[120:123], a[160:163], v[88:91]
    v_mfma_f32_16x16x32_bf16 v[120:123], a[120:123], a[164:167], v[120:123]
    v_mfma_f32_16x16x32_bf16 v[152:155], a[120:123], a[168:171], v[152:155]
    s_add_u32 s65, s65, 262144
    s_cmp_eq_u32 s65, 5242880
    v_mfma_f32_16x16x32_bf16 v[184:187], a[120:123], a[172:175], v[184:187]
    s_cselect_b32 s65, 0, s65
    s_add_u32 s73, s80, s69
    v_mfma_f32_16x16x32_bf16 v[216:219], a[120:123], a[176:179], v[216:219]
    s_mov_b32 s10, s80
    s_mov_b32 s80, s81
    v_mfma_f32_16x16x32_bf16 v[248:251], a[120:123], a[180:183], v[248:251]
    s_mov_b32 s81, s82
    s_mov_b32 s82, s10
    v_mfma_f32_16x16x32_bf16 v[92:95], a[124:127], a[160:163], v[92:95]
    v_add_u32 v30, s80, v26
    v_add_u32 v31, s80, v27
    v_mfma_f32_16x16x32_bf16 v[124:127], a[124:127], a[164:167], v[124:127]
    s_add_u32 s64, s64, 128
    s_cmp_eq_u32 s64, 1280
    v_mfma_f32_16x16x32_bf16 v[156:159], a[124:127], a[168:171], v[156:159]
    s_cselect_b32 s64, 0, s64
    s_add_u32 s74, s66, s70
    v_mfma_f32_16x16x32_bf16 v[188:191], a[124:127], a[172:175], v[188:191]
    s_mov_b32 s10, s66
    s_mov_b32 s66, s67
    v_mfma_f32_16x16x32_bf16 v[220:223], a[124:127], a[176:179], v[220:223]
    s_mov_b32 s67, s83
    s_mov_b32 s83, s10
    v_mfma_f32_16x16x32_bf16 v[252:255], a[124:127], a[180:183], v[252:255]
    v_add_u32 v14, s66, v28
    s_waitcnt vmcnt(10) lgkmcnt(0)
    s_barrier
    v_mfma_f32_16x16x32_bf16 v[64:67], a[128:131], a[192:195], v[64:67]
    s_add_u32 m0, s74, 0
    ds_read_b128 a[160:163], v14 offset:0
    v_mfma_f32_16x16x32_bf16 v[96:99], a[128:131], a[196:199], v[96:99]
    ds_read_b128 a[164:167], v14 offset:2048
    s_add_u32 s34, s34, s35
    v_mfma_f32_16x16x32_bf16 v[128:131], a[128:131], a[200:203], v[128:131]
    s_add_u32 s88, s40, s34
    s_addc_u32 s89, s41, 0
    v_mfma_f32_16x16x32_bf16 v[160:163], a[128:131], a[204:207], v[160:163]
    buffer_load_dwordx4 v4, s[44:47], s64 offen  lds
    s_add_u32 m0, s74, 1024
    v_mfma_f32_16x16x32_bf16 v[192:195], a[128:131], a[208:211], v[192:195]
    ds_read_b128 a[168:171], v14 offset:4096
    ds_read_b128 a[172:175], v14 offset:6144
    v_mfma_f32_16x16x32_bf16 v[224:227], a[128:131], a[212:215], v[224:227]
    s_and_b32 s89, s89, 0xffff
    v_mfma_f32_16x16x32_bf16 v[68:71], a[132:135], a[192:195], v[68:71]
    buffer_load_dwordx4 v5, s[44:47], s64 offen  lds
    s_add_u32 m0, s74, 2048
    v_mfma_f32_16x16x32_bf16 v[100:103], a[132:135], a[196:199], v[100:103]
    ds_read_b128 a[176:179], v14 offset:8192
    ds_read_b128 a[180:183], v14 offset:10240
    v_mfma_f32_16x16x32_bf16 v[132:135], a[132:135], a[200:203], v[132:135]
    s_mov_b32 s90, 294912
    v_mfma_f32_16x16x32_bf16 v[164:167], a[132:135], a[204:207], v[164:167]
    ds_read_b64_tr_b16 a[96:97], v30 offset:0
    v_mfma_f32_16x16x32_bf16 v[196:199], a[132:135], a[208:211], v[196:199]
    buffer_load_dwordx4 v6, s[44:47], s64 offen  lds
    s_add_u32 m0, s73, 0
    v_mfma_f32_16x16x32_bf16 v[228:231], a[132:135], a[212:215], v[228:231]
    ds_read_b64_tr_b16 a[98:99], v30 offset:512
    s_mov_b32 s91, 0x20000
    v_mfma_f32_16x16x32_bf16 v[72:75], a[136:139], a[192:195], v[72:75]
    ds_read_b64_tr_b16 a[100:101], v31 offset:32
    s_lshl_b32 s34, s7, 4
    v_mfma_f32_16x16x32_bf16 v[104:107], a[136:139], a[196:199], v[104:107]
    buffer_load_dwordx4 v10, s[48:51], s65 offen  lds
    s_add_u32 m0, s73, 2112
    v_mfma_f32_16x16x32_bf16 v[136:139], a[136:139], a[200:203], v[136:139]
    ds_read_b64_tr_b16 a[102:103], v31 offset:544
    v_mfma_f32_16x16x32_bf16 v[168:171], a[136:139], a[204:207], v[168:171]
    ds_read_b64_tr_b16 a[104:105], v30 offset:64
    s_add_u32 s35, s34, s63
    v_mfma_f32_16x16x32_bf16 v[200:203], a[136:139], a[208:211], v[200:203]
    v_mfma_f32_16x16x32_bf16 v[232:235], a[136:139], a[212:215], v[232:235]
    buffer_load_dwordx4 v11, s[48:51], s65 offen  lds
    s_add_u32 m0, s73, 4224
    v_mfma_f32_16x16x32_bf16 v[76:79], a[140:143], a[192:195], v[76:79]
    ds_read_b64_tr_b16 a[106:107], v30 offset:576
    ds_read_b64_tr_b16 a[108:109], v31 offset:96
    v_mfma_f32_16x16x32_bf16 v[108:111], a[140:143], a[196:199], v[108:111]
    s_lshl_b32 s35, s35, 2
    v_mfma_f32_16x16x32_bf16 v[140:143], a[140:143], a[200:203], v[140:143]
    buffer_load_dwordx4 v12, s[48:51], s65 offen  lds
    s_add_u32 m0, s73, 6336
    v_mfma_f32_16x16x32_bf16 v[172:175], a[140:143], a[204:207], v[172:175]
    ds_read_b64_tr_b16 a[110:111], v31 offset:608
    ds_read_b64_tr_b16 a[112:113], v30 offset:128
    v_mfma_f32_16x16x32_bf16 v[204:207], a[140:143], a[208:211], v[204:207]
    s_add_u32 s35, s35, s60
    v_mfma_f32_16x16x32_bf16 v[236:239], a[140:143], a[212:215], v[236:239]
    ds_read_b64_tr_b16 a[114:115], v30 offset:640
    s_lshl_b32 s35, s35, 6
    v_mfma_f32_16x16x32_bf16 v[80:83], a[144:147], a[192:195], v[80:83]
    buffer_load_dwordx4 v13, s[48:51], s65 offen  lds
    s_add_u32 m0, s75, 3168
    s_add_u32 s71, s71, 1024
    s_and_b32 s71, s71, 0x3ffff
    v_mfma_f32_16x16x32_bf16 v[112:115], a[144:147], a[196:199], v[112:115]
    ds_read_b64_tr_b16 a[116:117], v31 offset:160
    s_add_u32 s30, s35, 66060288
    v_mfma_f32_16x16x32_bf16 v[144:147], a[144:147], a[200:203], v[144:147]
    ds_read_b64_tr_b16 a[118:119], v31 offset:672
    v_mfma_f32_16x16x32_bf16 v[176:179], a[144:147], a[204:207], v[176:179]
    buffer_load_dwordx4 v0, s[52:55], s71 offen nt lds
    s_add_u32 m0, s75, 4224
    s_add_u32 s71, s71, 1024
    s_and_b32 s71, s71, 0x3ffff
    v_mfma_f32_16x16x32_bf16 v[208:211], a[144:147], a[208:211], v[208:211]
    ds_read_b64_tr_b16 a[120:121], v30 offset:192
    s_lshl_b32 s35, s4, 2
    v_mfma_f32_16x16x32_bf16 v[240:243], a[144:147], a[212:215], v[240:243]
    ds_read_b64_tr_b16 a[122:123], v30 offset:704
    v_mfma_f32_16x16x32_bf16 v[84:87], a[148:151], a[192:195], v[84:87]
    ds_read_b64_tr_b16 a[124:125], v31 offset:224
    s_add_u32 s35, s35, s34
    v_mfma_f32_16x16x32_bf16 v[116:119], a[148:151], a[196:199], v[116:119]
    buffer_load_dwordx4 v0, s[52:55], s71 offen nt lds
    s_add_u32 m0, s75, 5280
    s_add_u32 s71, s71, 1024
    s_and_b32 s71, s71, 0x3ffff
    v_mfma_f32_16x16x32_bf16 v[148:151], a[148:151], a[200:203], v[148:151]
    ds_read_b64_tr_b16 a[126:127], v31 offset:736
    v_mfma_f32_16x16x32_bf16 v[180:183], a[148:151], a[204:207], v[180:183]
    s_lshl_b32 s35, s35, 2
    v_mfma_f32_16x16x32_bf16 v[212:215], a[148:151], a[208:211], v[212:215]
    buffer_load_dwordx4 v0, s[52:55], s71 offen nt lds
    v_mfma_f32_16x16x32_bf16 v[244:247], a[148:151], a[212:215], v[244:247]
    v_mfma_f32_16x16x32_bf16 v[88:91], a[152:155], a[192:195], v[88:91]
    v_mfma_f32_16x16x32_bf16 v[120:123], a[152:155], a[196:199], v[120:123]
    v_mfma_f32_16x16x32_bf16 v[152:155], a[152:155], a[200:203], v[152:155]
    s_add_u32 s65, s65, 262144
    s_cmp_eq_u32 s65, 5242880
    v_mfma_f32_16x16x32_bf16 v[184:187], a[152:155], a[204:207], v[184:187]
    s_cselect_b32 s65, 0, s65
    s_add_u32 s73, s80, s69
    v_mfma_f32_16x16x32_bf16 v[216:219], a[152:155], a[208:211], v[216:219]
    s_mov_b32 s10, s80
    s_mov_b32 s80, s81
    v_mfma_f32_16x16x32_bf16 v[248:251], a[152:155], a[212:215], v[248:251]
    s_mov_b32 s81, s82
    s_mov_b32 s82, s10
    v_mfma_f32_16x16x32_bf16 v[92:95], a[156:159], a[192:195], v[92:95]
    v_add_u32 v30, s80, v26
    v_add_u32 v31, s80, v27
    v_mfma_f32_16x16x32_bf16 v[124:127], a[156:159], a[196:199], v[124:127]
    v_add_u32 v14, s66, v29
    v_mfma_f32_16x16x32_bf16 v[156:159], a[156:159], a[200:203], v[156:159]
    v_mfma_f32_16x16x32_bf16 v[188:191], a[156:159], a[204:207], v[188:191]
    v_mfma_f32_16x16x32_bf16 v[220:223], a[156:159], a[208:211], v[220:223]
    v_mfma_f32_16x16x32_bf16 v[252:255], a[156:159], a[212:215], v[252:255]
    s_waitcnt vmcnt(13) lgkmcnt(0)
    s_barrier
    v_mfma_f32_16x16x32_bf16 v[64:67], a[96:99], a[160:163], v[64:67]
    s_add_u32 m0, s74, 3072
    ds_read_b128 a[192:195], v14 offset:0
    v_mfma_f32_16x16x32_bf16 v[96:99], a[96:99], a[164:167], v[96:99]
    ds_read_b128 a[196:199], v14 offset:2048
    s_add_u32 s35, s35, s9
    v_mfma_f32_16x16x32_bf16 v[128:131], a[96:99], a[168:171], v[128:131]
    s_lshl_b32 s35, s35, 6
    v_mfma_f32_16x16x32_bf16 v[160:163], a[96:99], a[172:175], v[160:163]
    buffer_load_dwordx4 v7, s[44:47], s64 offen  lds
    s_add_u32 m0, s74, 4096
    v_mfma_f32_16x16x32_bf16 v[192:195], a[96:99], a[176:179], v[192:195]
    ds_read_b128 a[200:203], v14 offset:4096
    ds_read_b128 a[204:207], v14 offset:6144
    v_mfma_f32_16x16x32_bf16 v[224:227], a[96:99], a[180:183], v[224:227]
    s_add_u32 s31, s35, 66060288
    v_mfma_f32_16x16x32_bf16 v[68:71], a[100:103], a[160:163], v[68:71]
    ds_read_b128 a[208:211], v14 offset:8192
    v_mfma_f32_16x16x32_bf16 v[100:103], a[100:103], a[164:167], v[100:103]
    buffer_load_dwordx4 v8, s[44:47], s64 offen  lds
    s_add_u32 m0, s74, 5120
    v_mfma_f32_16x16x32_bf16 v[132:135], a[100:103], a[168:171], v[132:135]
    ds_read_b128 a[212:215], v14 offset:10240
    s_add_u32 s35, s34, s6
    v_mfma_f32_16x16x32_bf16 v[164:167], a[100:103], a[172:175], v[164:167]
    ds_read_b64_tr_b16 a[128:129], v30 offset:0
    v_mfma_f32_16x16x32_bf16 v[196:199], a[100:103], a[176:179], v[196:199]
    ds_read_b64_tr_b16 a[130:131], v30 offset:512
    s_lshl_b32 s35, s35, 2
    v_mfma_f32_16x16x32_bf16 v[228:231], a[100:103], a[180:183], v[228:231]
    buffer_load_dwordx4 v9, s[44:47], s64 offen  lds
    s_add_u32 m0, s73, 0
    v_mfma_f32_16x16x32_bf16 v[72:75], a[104:107], a[160:163], v[72:75]
    ds_read_b64_tr_b16 a[132:133], v31 offset:32
    s_add_u32 s35, s35, s4
    v_mfma_f32_16x16x32_bf16 v[104:107], a[104:107], a[164:167], v[104:107]
    ds_read_b64_tr_b16 a[134:135], v31 offset:544
    v_mfma_f32_16x16x32_bf16 v[136:139], a[104:107], a[168:171], v[136:139]
    v_mfma_f32_16x16x32_bf16 v[168:171], a[104:107], a[172:175], v[168:171]
    buffer_load_dwordx4 v10, s[48:51], s65 offen  lds
    s_add_u32 m0, s73, 2112
    v_mfma_f32_16x16x32_bf16 v[200:203], a[104:107], a[176:179], v[200:203]
    ds_read_b64_tr_b16 a[136:137], v30 offset:64
    s_lshl_b32 s35, s35, 6
    v_mfma_f32_16x16x32_bf16 v[232:235], a[104:107], a[180:183], v[232:235]
    ds_read_b64_tr_b16 a[138:139], v30 offset:576
    v_mfma_f32_16x16x32_bf16 v[76:79], a[108:111], a[160:163], v[76:79]
    ds_read_b64_tr_b16 a[140:141], v31 offset:96
    s_add_u32 s32, s35, 66125824
    v_mfma_f32_16x16x32_bf16 v[108:111], a[108:111], a[164:167], v[108:111]
    buffer_load_dwordx4 v11, s[48:51], s65 offen  lds
    s_add_u32 m0, s73, 4224
    v_mfma_f32_16x16x32_bf16 v[140:143], a[108:111], a[168:171], v[140:143]
    ds_read_b64_tr_b16 a[142:143], v31 offset:608
    s_mul_i32 s34, s60, 3072
    v_mfma_f32_16x16x32_bf16 v[172:175], a[108:111], a[172:175], v[172:175]
    ds_read_b64_tr_b16 a[144:145], v30 offset:128
    v_mfma_f32_16x16x32_bf16 v[204:207], a[108:111], a[176:179], v[204:207]
    buffer_load_dwordx4 v12, s[48:51], s65 offen  lds
    s_add_u32 m0, s73, 6336
    v_mfma_f32_16x16x32_bf16 v[236:239], a[108:111], a[180:183], v[236:239]
    ds_read_b64_tr_b16 a[146:147], v30 offset:640
    s_add_u32 s33, s34, 65536
    v_mfma_f32_16x16x32_bf16 v[80:83], a[112:115], a[160:163], v[80:83]
    ds_read_b64_tr_b16 a[148:149], v31 offset:160
    v_mfma_f32_16x16x32_bf16 v[112:115], a[112:115], a[164:167], v[112:115]
    s_add_u32 s34, s6, 1
    v_mfma_f32_16x16x32_bf16 v[144:147], a[112:115], a[168:171], v[144:147]
    buffer_load_dwordx4 v13, s[48:51], s65 offen  lds
    s_add_u32 m0, s75, 6336
    s_add_u32 s71, s71, 1024
    s_and_b32 s71, s71, 0x3ffff
    v_mfma_f32_16x16x32_bf16 v[176:179], a[112:115], a[172:175], v[176:179]
    ds_read_b64_tr_b16 a[150:151], v31 offset:672
    ds_read_b64_tr_b16 a[152:153], v30 offset:192
    v_mfma_f32_16x16x32_bf16 v[208:211], a[112:115], a[176:179], v[208:211]
    s_and_b32 s34, s34, 3
    v_mfma_f32_16x16x32_bf16 v[240:243], a[112:115], a[180:183], v[240:243]
    ds_read_b64_tr_b16 a[154:155], v30 offset:704
    v_mfma_f32_16x16x32_bf16 v[84:87], a[116:119], a[160:163], v[84:87]
    buffer_load_dwordx4 v0, s[52:55], s71 offen nt lds
    s_add_u32 m0, s75, 7392
    s_add_u32 s71, s71, 1024
    s_and_b32 s71, s71, 0x3ffff
    v_mfma_f32_16x16x32_bf16 v[116:119], a[116:119], a[164:167], v[116:119]
    ds_read_b64_tr_b16 a[156:157], v31 offset:224
    s_lshl_b32 s16, s34, 13
    v_mfma_f32_16x16x32_bf16 v[148:151], a[116:119], a[168:171], v[148:151]
    ds_read_b64_tr_b16 a[158:159], v31 offset:736
    v_mfma_f32_16x16x32_bf16 v[180:183], a[116:119], a[172:175], v[180:183]
    s_add_u32 s17, s16, 4096
    v_mfma_f32_16x16x32_bf16 v[212:215], a[116:119], a[176:179], v[212:215]
    buffer_load_dwordx4 v0, s[52:55], s71 offen nt lds
    v_mfma_f32_16x16x32_bf16 v[244:247], a[116:119], a[180:183], v[244:247]
    v_mfma_f32_16x16x32_bf16 v[88:91], a[120:123], a[160:163], v[88:91]
    v_mfma_f32_16x16x32_bf16 v[120:123], a[120:123], a[164:167], v[120:123]
    v_mfma_f32_16x16x32_bf16 v[152:155], a[120:123], a[168:171], v[152:155]
    s_add_u32 s65, s65, 262144
    s_cmp_eq_u32 s65, 5242880
    v_mfma_f32_16x16x32_bf16 v[184:187], a[120:123], a[172:175], v[184:187]
    s_cselect_b32 s65, 0, s65
    s_add_u32 s73, s80, s69
    v_mfma_f32_16x16x32_bf16 v[216:219], a[120:123], a[176:179], v[216:219]
    s_mov_b32 s10, s80
    s_mov_b32 s80, s81
    v_mfma_f32_16x16x32_bf16 v[248:251], a[120:123], a[180:183], v[248:251]
    s_mov_b32 s81, s82
    s_mov_b32 s82, s10
    v_mfma_f32_16x16x32_bf16 v[92:95], a[124:127], a[160:163], v[92:95]
    v_add_u32 v30, s80, v26
    v_add_u32 v31, s80, v27
    v_mfma_f32_16x16x32_bf16 v[124:127], a[124:127], a[164:167], v[124:127]
    s_add_u32 s64, s64, 128
    s_cmp_eq_u32 s64, 1280
    v_mfma_f32_16x16x32_bf16 v[156:159], a[124:127], a[168:171], v[156:159]
    s_cselect_b32 s64, 0, s64
    s_add_u32 s74, s66, s70
    v_mfma_f32_16x16x32_bf16 v[188:191], a[124:127], a[172:175], v[188:191]
    s_mov_b32 s10, s66
    s_mov_b32 s66, s67
    v_mfma_f32_16x16x32_bf16 v[220:223], a[124:127], a[176:179], v[220:223]
    s_mov_b32 s67, s83
    s_mov_b32 s83, s10
    v_mfma_f32_16x16x32_bf16 v[252:255], a[124:127], a[180:183], v[252:255]
    v_add_u32 v14, s66, v28
    s_waitcnt vmcnt(12) lgkmcnt(0)
    s_barrier
    v_mfma_f32_16x16x32_bf16 v[64:67], a[128:131], a[192:195], v[64:67]
    s_add_u32 m0, s74, 0
    ds_read_b128 a[160:163], v14 offset:0
    v_mfma_f32_16x16x32_bf16 v[96:99], a[128:131], a[196:199], v[96:99]
    ds_read_b128 a[164:167], v14 offset:2048
    s_lshl_b32 s34, s34, 1
    v_mfma_f32_16x16x32_bf16 v[128:131], a[128:131], a[200:203], v[128:131]
    s_lshl_b32 s24, 3, s34
    v_mfma_f32_16x16x32_bf16 v[160:163], a[128:131], a[204:207], v[160:163]
    buffer_load_dwordx4 v4, s[44:47], s64 offen  lds
    s_add_u32 m0, s74, 1024
    v_mfma_f32_16x16x32_bf16 v[192:195], a[128:131], a[208:211], v[192:195]
    ds_read_b128 a[168:171], v14 offset:4096
    ds_read_b128 a[172:175], v14 offset:6144
    v_mfma_f32_16x16x32_bf16 v[224:227], a[128:131], a[212:215], v[224:227]
    s_mov_b32 s25, 0
    v_mfma_f32_16x16x32_bf16 v[68:71], a[132:135], a[192:195], v[68:71]
    ds_read_b128 a[176:179], v14 offset:8192
    v_mfma_f32_16x16x32_bf16 v[100:103], a[132:135], a[196:199], v[100:103]
    buffer_load_dwordx4 v5, s[44:47], s64 offen  lds
    s_add_u32 m0, s74, 2048
    v_mfma_f32_16x16x32_bf16 v[132:135], a[132:135], a[200:203], v[132:135]
    ds_read_b128 a[180:183], v14 offset:10240
    s_add_u32 s34, s6, 2
    v_mfma_f32_16x16x32_bf16 v[164:167], a[132:135], a[204:207], v[164:167]
    ds_read_b64_tr_b16 a[96:97], v30 offset:0
    v_mfma_f32_16x16x32_bf16 v[196:199], a[132:135], a[208:211], v[196:199]
    ds_read_b64_tr_b16 a[98:99], v30 offset:512
    s_and_b32 s34, s34, 3
    v_mfma_f32_16x16x32_bf16 v[228:231], a[132:135], a[212:215], v[228:231]
    buffer_load_dwordx4 v6, s[44:47], s64 offen  lds
    s_add_u32 m0, s73, 0
    v_mfma_f32_16x16x32_bf16 v[72:75], a[136:139], a[192:195], v[72:75]
    ds_read_b64_tr_b16 a[100:101], v31 offset:32
    s_lshl_b32 s18, s34, 13
    v_mfma_f32_16x16x32_bf16 v[104:107], a[136:139], a[196:199], v[104:107]
    ds_read_b64_tr_b16 a[102:103], v31 offset:544
    v_mfma_f32_16x16x32_bf16 v[136:139], a[136:139], a[200:203], v[136:139]
    v_mfma_f32_16x16x32_bf16 v[168:171], a[136:139], a[204:207], v[168:171]
    buffer_load_dwordx4 v10, s[48:51], s65 offen  lds
    s_add_u32 m0, s73, 2112
    v_mfma_f32_16x16x32_bf16 v[200:203], a[136:139], a[208:211], v[200:203]
    ds_read_b64_tr_b16 a[104:105], v30 offset:64
    s_add_u32 s19, s18, 4096
    v_mfma_f32_16x16x32_bf16 v[232:235], a[136:139], a[212:215], v[232:235]
    ds_read_b64_tr_b16 a[106:107], v30 offset:576
    v_mfma_f32_16x16x32_bf16 v[76:79], a[140:143], a[192:195], v[76:79]
    ds_read_b64_tr_b16 a[108:109], v31 offset:96
    s_lshl_b32 s34, s34, 1
    v_mfma_f32_16x16x32_bf16 v[108:111], a[140:143], a[196:199], v[108:111]
    buffer_load_dwordx4 v11, s[48:51], s65 offen  lds
    s_add_u32 m0, s73, 4224
    v_mfma_f32_16x16x32_bf16 v[140:143], a[140:143], a[200:203], v[140:143]
    ds_read_b64_tr_b16 a[110:111], v31 offset:608
    s_lshl_b32 s26, 3, s34
    v_mfma_f32_16x16x32_bf16 v[172:175], a[140:143], a[204:207], v[172:175]
    ds_read_b64_tr_b16 a[112:113], v30 offset:128
    v_mfma_f32_16x16x32_bf16 v[204:207], a[140:143], a[208:211], v[204:207]
    buffer_load_dwordx4 v12, s[48:51], s65 offen  lds
    s_add_u32 m0, s73, 6336
    v_mfma_f32_16x16x32_bf16 v[236:239], a[140:143], a[212:215], v[236:239]
    ds_read_b64_tr_b16 a[114:115], v30 offset:640
    s_mov_b32 s27, 0
    v_mfma_f32_16x16x32_bf16 v[80:83], a[144:147], a[192:195], v[80:83]
    ds_read_b64_tr_b16 a[116:117], v31 offset:160
    v_mfma_f32_16x16x32_bf16 v[112:115], a[144:147], a[196:199], v[112:115]
    s_add_u32 s34, s6, 3
    v_mfma_f32_16x16x32_bf16 v[144:147], a[144:147], a[200:203], v[144:147]
    buffer_load_dwordx4 v13, s[48:51], s65 offen  lds
    s_add_u32 s71, s71, 1024
    s_and_b32 s71, s71, 0x3ffff
    v_mfma_f32_16x16x32_bf16 v[176:179], a[144:147], a[204:207], v[176:179]
    ds_read_b64_tr_b16 a[118:119], v31 offset:672
    ds_read_b64_tr_b16 a[120:121], v30 offset:192
    v_mfma_f32_16x16x32_bf16 v[208:211], a[144:147], a[208:211], v[208:211]
    s_and_b32 s34, s34, 3
    v_mfma_f32_16x16x32_bf16 v[240:243], a[144:147], a[212:215], v[240:243]
    ds_read_b64_tr_b16 a[122:123], v30 offset:704
    v_mfma_f32_16x16x32_bf16 v[84:87], a[148:151], a[192:195], v[84:87]
    buffer_load_dwordx4 a[0:3], v0, s[52:55], s71 offen nt
    s_add_u32 s71, s71, 1024
    s_and_b32 s71, s71, 0x3ffff
    v_mfma_f32_16x16x32_bf16 v[116:119], a[148:151], a[196:199], v[116:119]
    ds_read_b64_tr_b16 a[124:125], v31 offset:224
    s_lshl_b32 s20, s34, 13
    v_mfma_f32_16x16x32_bf16 v[148:151], a[148:151], a[200:203], v[148:151]
    ds_read_b64_tr_b16 a[126:127], v31 offset:736
    v_mfma_f32_16x16x32_bf16 v[180:183], a[148:151], a[204:207], v[180:183]
    s_add_u32 s21, s20, 4096
    v_mfma_f32_16x16x32_bf16 v[212:215], a[148:151], a[208:211], v[212:215]
    buffer_load_dwordx4 a[4:7], v0, s[52:55], s71 offen nt
    v_mfma_f32_16x16x32_bf16 v[244:247], a[148:151], a[212:215], v[244:247]
    v_mfma_f32_16x16x32_bf16 v[88:91], a[152:155], a[192:195], v[88:91]
    v_mfma_f32_16x16x32_bf16 v[120:123], a[152:155], a[196:199], v[120:123]
    v_mfma_f32_16x16x32_bf16 v[152:155], a[152:155], a[200:203], v[152:155]
    s_add_u32 s65, s65, 262144
    s_cmp_eq_u32 s65, 5242880
    v_mfma_f32_16x16x32_bf16 v[184:187], a[152:155], a[204:207], v[184:187]
    s_cselect_b32 s65, 0, s65
    s_add_u32 s73, s80, s69
    v_mfma_f32_16x16x32_bf16 v[216:219], a[152:155], a[208:211], v[216:219]
    s_mov_b32 s10, s80
    s_mov_b32 s80, s81
    v_mfma_f32_16x16x32_bf16 v[248:251], a[152:155], a[212:215], v[248:251]
    s_mov_b32 s81, s82
    s_mov_b32 s82, s10
    v_mfma_f32_16x16x32_bf16 v[92:95], a[156:159], a[192:195], v[92:95]
    v_add_u32 v30, s80, v26
    v_add_u32 v31, s80, v27
    v_mfma_f32_16x16x32_bf16 v[124:127], a[156:159], a[196:199], v[124:127]
    v_add_u32 v14, s66, v29
    v_mfma_f32_16x16x32_bf16 v[156:159], a[156:159], a[200:203], v[156:159]
    v_mfma_f32_16x16x32_bf16 v[188:191], a[156:159], a[204:207], v[188:191]
    v_mfma_f32_16x16x32_bf16 v[220:223], a[156:159], a[208:211], v[220:223]
    v_mfma_f32_16x16x32_bf16 v[252:255], a[156:159], a[212:215], v[252:255]
    s_waitcnt vmcnt(11) lgkmcnt(0)
    s_barrier
    v_mfma_f32_16x16x32_bf16 v[64:67], a[96:99], a[160:163], v[64:67]
    s_add_u32 m0, s74, 3072
    ds_read_b128 a[192:195], v14 offset:0
    v_mfma_f32_16x16x32_bf16 v[96:99], a[96:99], a[164:167], v[96:99]
    ds_read_b128 a[196:199], v14 offset:2048
    s_lshl_b32 s34, s34, 1
    v_mfma_f32_16x16x32_bf16 v[128:131], a[96:99], a[168:171], v[128:131]
    s_lshl_b32 s28, 3, s34
    v_mfma_f32_16x16x32_bf16 v[160:163], a[96:99], a[172:175], v[160:163]
    buffer_load_dwordx4 v7, s[44:47], s64 offen  lds
    s_add_u32 m0, s74, 4096
    v_mfma_f32_16x16x32_bf16 v[192:195], a[96:99], a[176:179], v[192:195]
    ds_read_b128 a[200:203], v14 offset:4096
    ds_read_b128 a[204:207], v14 offset:6144
    v_mfma_f32_16x16x32_bf16 v[224:227], a[96:99], a[180:183], v[224:227]
    s_mov_b32 s29, 0
    v_mfma_f32_16x16x32_bf16 v[68:71], a[100:103], a[160:163], v[68:71]
    ds_read_b128 a[208:211], v14 offset:8192
    v_mfma_f32_16x16x32_bf16 v[100:103], a[100:103], a[164:167], v[100:103]
    buffer_load_dwordx4 v8, s[44:47], s64 offen  lds
    s_add_u32 m0, s74, 5120
    v_mfma_f32_16x16x32_bf16 v[132:135], a[100:103], a[168:171], v[132:135]
    ds_read_b128 a[212:215], v14 offset:10240
    s_mov_b32 s76, 0x3e0293ee
    v_mfma_f32_16x16x32_bf16 v[164:167], a[100:103], a[172:175], v[164:167]
    ds_read_b64_tr_b16 a[128:129], v30 offset:0
    v_mfma_f32_16x16x32_bf16 v[196:199], a[100:103], a[176:179], v[196:199]
    ds_read_b64_tr_b16 a[130:131], v30 offset:512
    s_mov_b32 s77, 0x3e0293ee
    v_mfma_f32_16x16x32_bf16 v[228:231], a[100:103], a[180:183], v[228:231]
    buffer_load_dwordx4 v9, s[44:47], s64 offen  lds
    s_add_u32 m0, s73, 0
    v_mfma_f32_16x16x32_bf16 v[72:75], a[104:107], a[160:163], v[72:75]
    ds_read_b64_tr_b16 a[132:133], v31 offset:32
    s_mov_b32 s78, 0
    v_mfma_f32_16x16x32_bf16 v[104:107], a[104:107], a[164:167], v[104:107]
    ds_read_b64_tr_b16 a[134:135], v31 offset:544
    v_mfma_f32_16x16x32_bf16 v[136:139], a[104:107], a[168:171], v[136:139]
    v_mfma_f32_16x16x32_bf16 v[168:171], a[104:107], a[172:175], v[168:171]
    buffer_load_dwordx4 v10, s[48:51], s65 offen  lds
    s_add_u32 m0, s73, 2112
    v_mfma_f32_16x16x32_bf16 v[200:203], a[104:107], a[176:179], v[200:203]
    ds_read_b64_tr_b16 a[136:137], v30 offset:64
    s_cmp_lt_u32 s4, 0
    s_cselect_b32 s42, 0, 0
    s_cselect_b32 s43, 64, 12
    v_mfma_f32_16x16x32_bf16 v[232:235], a[104:107], a[180:183], v[232:235]
    ds_read_b64_tr_b16 a[138:139], v30 offset:576
    v_mfma_f32_16x16x32_bf16 v[76:79], a[108:111], a[160:163], v[76:79]
    ds_read_b64_tr_b16 a[140:141], v31 offset:96
    s_add_u32 s34, s5, s2
    v_mfma_f32_16x16x32_bf16 v[108:111], a[108:111], a[164:167], v[108:111]
    buffer_load_dwordx4 v11, s[48:51], s65 offen  lds
    s_add_u32 m0, s73, 4224
    v_mfma_f32_16x16x32_bf16 v[140:143], a[108:111], a[168:171], v[140:143]
    ds_read_b64_tr_b16 a[142:143], v31 offset:608
    s_and_b32 s34, s34, 7
    v_mfma_f32_16x16x32_bf16 v[172:175], a[108:111], a[172:175], v[172:175]
    ds_read_b64_tr_b16 a[144:145], v30 offset:128
    v_mfma_f32_16x16x32_bf16 v[204:207], a[108:111], a[176:179], v[204:207]
    buffer_load_dwordx4 v12, s[48:51], s65 offen  lds
    s_add_u32 m0, s73, 6336
    v_mfma_f32_16x16x32_bf16 v[236:239], a[108:111], a[180:183], v[236:239]
    ds_read_b64_tr_b16 a[146:147], v30 offset:640
    s_cmp_eq_u32 s34, 0
    s_cselect_b32 s43, 702, s43
    v_mfma_f32_16x16x32_bf16 v[80:83], a[112:115], a[160:163], v[80:83]
    ds_read_b64_tr_b16 a[148:149], v31 offset:160
    v_mfma_f32_16x16x32_bf16 v[112:115], a[112:115], a[164:167], v[112:115]
    s_cmp_eq_u32 s34, 1
    s_cselect_b32 s43, 1246, s43
    v_mfma_f32_16x16x32_bf16 v[144:147], a[112:115], a[168:171], v[144:147]
    buffer_load_dwordx4 v13, s[48:51], s65 offen  lds
    s_add_u32 s71, s71, 1024
    s_and_b32 s71, s71, 0x3ffff
    v_mfma_f32_16x16x32_bf16 v[176:179], a[112:115], a[172:175], v[176:179]
    ds_read_b64_tr_b16 a[150:151], v31 offset:672
    ds_read_b64_tr_b16 a[152:153], v30 offset:192
    v_mfma_f32_16x16x32_bf16 v[208:211], a[112:115], a[176:179], v[208:211]
    s_cmp_eq_u32 s34, 2
    s_cselect_b32 s43, 1374, s43
    v_mfma_f32_16x16x32_bf16 v[240:243], a[112:115], a[180:183], v[240:243]
    ds_read_b64_tr_b16 a[154:155], v30 offset:704
    v_mfma_f32_16x16x32_bf16 v[84:87], a[116:119], a[160:163], v[84:87]
    buffer_load_dwordx4 a[8:11], v0, s[52:55], s71 offen nt
    s_add_u32 s71, s71, 1024
    s_and_b32 s71, s71, 0x3ffff
    v_mfma_f32_16x16x32_bf16 v[116:119], a[116:119], a[164:167], v[116:119]
    ds_read_b64_tr_b16 a[156:157], v31 offset:224
    s_cmp_eq_u32 s34, 3
    s_cselect_b32 s43, 2398, s43
    v_mfma_f32_16x16x32_bf16 v[148:151], a[116:119], a[168:171], v[148:151]
    ds_read_b64_tr_b16 a[158:159], v31 offset:736
    v_mfma_f32_16x16x32_bf16 v[180:183], a[116:119], a[172:175], v[180:183]
    s_cmp_eq_u32 s34, 4
    s_cselect_b32 s43, 2414, s43
    v_mfma_f32_16x16x32_bf16 v[212:215], a[116:119], a[176:179], v[212:215]
    buffer_load_dwordx4 a[12:15], v0, s[52:55], s71 offen nt
    v_mfma_f32_16x16x32_bf16 v[244:247], a[116:119], a[180:183], v[244:247]
    v_mfma_f32_16x16x32_bf16 v[88:91], a[120:123], a[160:163], v[88:91]
    v_mfma_f32_16x16x32_bf16 v[120:123], a[120:123], a[164:167], v[120:123]
    v_mfma_f32_16x16x32_bf16 v[152:155], a[120:123], a[168:171], v[152:155]
    s_add_u32 s65, s65, 262144
    s_cmp_eq_u32 s65, 5242880
    v_mfma_f32_16x16x32_bf16 v[184:187], a[120:123], a[172:175], v[184:187]
    s_cselect_b32 s65, 0, s65
    s_add_u32 s73, s80, s69
    v_mfma_f32_16x16x32_bf16 v[216:219], a[120:123], a[176:179], v[216:219]
    s_mov_b32 s10, s80
    s_mov_b32 s80, s81
    v_mfma_f32_16x16x32_bf16 v[248:251], a[120:123], a[180:183], v[248:251]
    s_mov_b32 s81, s82
    s_mov_b32 s82, s10
    v_mfma_f32_16x16x32_bf16 v[92:95], a[124:127], a[160:163], v[92:95]
    v_add_u32 v30, s80, v26
    v_add_u32 v31, s80, v27
    v_mfma_f32_16x16x32_bf16 v[124:127], a[124:127], a[164:167], v[124:127]
    s_add_u32 s64, s64, 128
    s_cmp_eq_u32 s64, 1280
    v_mfma_f32_16x16x32_bf16 v[156:159], a[124:127], a[168:171], v[156:159]
    s_cselect_b32 s64, 0, s64
    s_add_u32 s74, s66, s70
    v_mfma_f32_16x16x32_bf16 v[188:191], a[124:127], a[172:175], v[188:191]
    s_mov_b32 s10, s66
    s_mov_b32 s66, s67
    v_mfma_f32_16x16x32_bf16 v[220:223], a[124:127], a[176:179], v[220:223]
    s_mov_b32 s67, s83
    s_mov_b32 s83, s10
    v_mfma_f32_16x16x32_bf16 v[252:255], a[124:127], a[180:183], v[252:255]
    v_add_u32 v14, s66, v28
    s_waitcnt vmcnt(11) lgkmcnt(0)
    s_barrier
    v_mfma_f32_16x16x32_bf16 v[64:67], a[128:131], a[192:195], v[64:67]
    s_add_u32 m0, s74, 0
    ds_read_b128 a[160:163], v14 offset:0
    v_mfma_f32_16x16x32_bf16 v[96:99], a[128:131], a[196:199], v[96:99]
    ds_read_b128 a[164:167], v14 offset:2048
    s_cmp_eq_u32 s34, 5
    s_cselect_b32 s43, 4462, s43
    v_mfma_f32_16x16x32_bf16 v[128:131], a[128:131], a[200:203], v[128:131]
    v_mfma_f32_16x16x32_bf16 v[160:163], a[128:131], a[204:207], v[160:163]
    buffer_load_dwordx4 v4, s[44:47], s64 offen  lds
    s_add_u32 m0, s74, 1024
    v_mfma_f32_16x16x32_bf16 v[192:195], a[128:131], a[208:211], v[192:195]
    ds_read_b128 a[168:171], v14 offset:4096
    ds_read_b128 a[172:175], v14 offset:6144
    v_mfma_f32_16x16x32_bf16 v[224:227], a[128:131], a[212:215], v[224:227]
    s_cmp_eq_u32 s34, 6
    s_cselect_b32 s43, 694, s43
    v_mfma_f32_16x16x32_bf16 v[68:71], a[132:135], a[192:195], v[68:71]
    ds_read_b128 a[176:179], v14 offset:8192
    s_cmp_eq_u32 s34, 7
    s_cselect_b32 s43, 698, s43
    v_mfma_f32_16x16x32_bf16 v[100:103], a[132:135], a[196:199], v[100:103]
    buffer_load_dwordx4 v5, s[44:47], s64 offen  lds
    s_add_u32 m0, s74, 2048
    v_mfma_f32_16x16x32_bf16 v[132:135], a[132:135], a[200:203], v[132:135]
    ds_read_b128 a[180:183], v14 offset:10240
    v_mfma_f32_16x16x32_bf16 v[164:167], a[132:135], a[204:207], v[164:167]
    ds_read_b64_tr_b16 a[96:97], v30 offset:0
    v_mov_b32 v17, 0x3f803f80
    v_mfma_f32_16x16x32_bf16 v[196:199], a[132:135], a[208:211], v[196:199]
    ds_read_b64_tr_b16 a[98:99], v30 offset:512
    v_mfma_f32_16x16x32_bf16 v[228:231], a[132:135], a[212:215], v[228:231]
    buffer_load_dwordx4 v6, s[44:47], s64 offen  lds
    s_add_u32 m0, s73, 0
    v_mfma_f32_16x16x32_bf16 v[72:75], a[136:139], a[192:195], v[72:75]
    ds_read_b64_tr_b16 a[100:101], v31 offset:32
    v_mfma_f32_16x16x32_bf16 v[104:107], a[136:139], a[196:199], v[104:107]
    ds_read_b64_tr_b16 a[102:103], v31 offset:544
    v_cmp_eq_u32 vcc, 0, v20
    v_mfma_f32_16x16x32_bf16 v[136:139], a[136:139], a[200:203], v[136:139]
    v_mfma_f32_16x16x32_bf16 v[168:171], a[136:139], a[204:207], v[168:171]
    buffer_load_dwordx4 v10, s[48:51], s65 offen  lds
    s_add_u32 m0, s73, 2112
    v_mfma_f32_16x16x32_bf16 v[200:203], a[136:139], a[208:211], v[200:203]
    ds_read_b64_tr_b16 a[104:105], v30 offset:64
    s_nop 1
    v_mfma_f32_16x16x32_bf16 v[232:235], a[136:139], a[212:215], v[232:235]
    ds_read_b64_tr_b16 a[106:107], v30 offset:576
    v_mfma_f32_16x16x32_bf16 v[76:79], a[140:143], a[192:195], v[76:79]
    ds_read_b64_tr_b16 a[108:109], v31 offset:96
    v_mfma_f32_16x16x32_bf16 v[108:111], a[140:143], a[196:199], v[108:111]
    buffer_load_dwordx4 v11, s[48:51], s65 offen  lds
    s_add_u32 m0, s73, 4224
    v_mfma_f32_16x16x32_bf16 v[140:143], a[140:143], a[200:203], v[140:143]
    ds_read_b64_tr_b16 a[110:111], v31 offset:608
    v_cndmask_b32 v17, 0, v17, vcc
    v_mfma_f32_16x16x32_bf16 v[172:175], a[140:143], a[204:207], v[172:175]
    ds_read_b64_tr_b16 a[112:113], v30 offset:128
    v_mfma_f32_16x16x32_bf16 v[204:207], a[140:143], a[208:211], v[204:207]
    buffer_load_dwordx4 v12, s[48:51], s65 offen  lds
    s_add_u32 m0, s73, 6336
    v_mfma_f32_16x16x32_bf16 v[236:239], a[140:143], a[212:215], v[236:239]
    ds_read_b64_tr_b16 a[114:115], v30 offset:640
    v_accvgpr_write_b32 a248, v17
    v_mfma_f32_16x16x32_bf16 v[80:83], a[144:147], a[192:195], v[80:83]
    ds_read_b64_tr_b16 a[116:117], v31 offset:160
    v_mfma_f32_16x16x32_bf16 v[112:115], a[144:147], a[196:199], v[112:115]
    v_mfma_f32_16x16x32_bf16 v[144:147], a[144:147], a[200:203], v[144:147]
    buffer_load_dwordx4 v13, s[48:51], s65 offen  lds
    s_add_u32 s71, s71, 1024
    s_and_b32 s71, s71, 0x3ffff
    v_mfma_f32_16x16x32_bf16 v[176:179], a[144:147], a[204:207], v[176:179]
    ds_read_b64_tr_b16 a[118:119], v31 offset:672
    ds_read_b64_tr_b16 a[120:121], v30 offset:192
    v_mfma_f32_16x16x32_bf16 v[208:211], a[144:147], a[208:211], v[208:211]
    v_accvgpr_write_b32 a249, v17
    v_mfma_f32_16x16x32_bf16 v[240:243], a[144:147], a[212:215], v[240:243]
    ds_read_b64_tr_b16 a[122:123], v30 offset:704
    v_accvgpr_write_b32 a250, v17
    v_mfma_f32_16x16x32_bf16 v[84:87], a[148:151], a[192:195], v[84:87]
    buffer_load_dwordx4 a[16:19], v0, s[52:55], s71 offen nt
    s_add_u32 s71, s71, 1024
    s_and_b32 s71, s71, 0x3ffff
    v_mfma_f32_16x16x32_bf16 v[116:119], a[148:151], a[196:199], v[116:119]
    ds_read_b64_tr_b16 a[124:125], v31 offset:224
    v_mfma_f32_16x16x32_bf16 v[148:151], a[148:151], a[200:203], v[148:151]
    ds_read_b64_tr_b16 a[126:127], v31 offset:736
    v_accvgpr_write_b32 a251, v17
    v_mfma_f32_16x16x32_bf16 v[180:183], a[148:151], a[204:207], v[180:183]
    v_mfma_f32_16x16x32_bf16 v[212:215], a[148:151], a[208:211], v[212:215]
    buffer_load_dwordx4 a[20:23], v0, s[52:55], s71 offen nt
    v_mfma_f32_16x16x32_bf16 v[244:247], a[148:151], a[212:215], v[244:247]
    v_mfma_f32_16x16x32_bf16 v[88:91], a[152:155], a[192:195], v[88:91]
    v_mfma_f32_16x16x32_bf16 v[120:123], a[152:155], a[196:199], v[120:123]
    v_mfma_f32_16x16x32_bf16 v[152:155], a[152:155], a[200:203], v[152:155]
    s_add_u32 s65, s65, 262144
    s_cmp_eq_u32 s65, 5242880
    v_mfma_f32_16x16x32_bf16 v[184:187], a[152:155], a[204:207], v[184:187]
    s_cselect_b32 s65, 0, s65
    s_add_u32 s73, s80, s69
    v_mfma_f32_16x16x32_bf16 v[216:219], a[152:155], a[208:211], v[216:219]
    s_mov_b32 s10, s80
    s_mov_b32 s80, s81
    v_mfma_f32_16x16x32_bf16 v[248:251], a[152:155], a[212:215], v[248:251]
    s_mov_b32 s81, s82
    s_mov_b32 s82, s10
    v_mfma_f32_16x16x32_bf16 v[92:95], a[156:159], a[192:195], v[92:95]
    v_add_u32 v30, s80, v26
    v_add_u32 v31, s80, v27
    v_mfma_f32_16x16x32_bf16 v[124:127], a[156:159], a[196:199], v[124:127]
    v_add_u32 v14, s66, v29
    v_mfma_f32_16x16x32_bf16 v[156:159], a[156:159], a[200:203], v[156:159]
    v_mfma_f32_16x16x32_bf16 v[188:191], a[156:159], a[204:207], v[188:191]
    v_mfma_f32_16x16x32_bf16 v[220:223], a[156:159], a[208:211], v[220:223]
    v_mfma_f32_16x16x32_bf16 v[252:255], a[156:159], a[212:215], v[252:255]
    s_waitcnt vmcnt(11) lgkmcnt(0)
    s_barrier
    v_mfma_f32_16x16x32_bf16 v[64:67], a[96:99], a[160:163], v[64:67]
    s_add_u32 m0, s74, 3072
    ds_read_b128 a[192:195], v14 offset:0
    v_mfma_f32_16x16x32_bf16 v[96:99], a[96:99], a[164:167], v[96:99]
    ds_read_b128 a[196:199], v14 offset:2048
    v_mfma_f32_16x16x32_bf16 v[128:131], a[96:99], a[168:171], v[128:131]
    v_mfma_f32_16x16x32_bf16 v[160:163], a[96:99], a[172:175], v[160:163]
    buffer_load_dwordx4 v7, s[44:47], s64 offen  lds
    s_add_u32 m0, s74, 4096
    v_mfma_f32_16x16x32_bf16 v[192:195], a[96:99], a[176:179], v[192:195]
    ds_read_b128 a[200:203], v14 offset:4096
    ds_read_b128 a[204:207], v14 offset:6144
    v_mfma_f32_16x16x32_bf16 v[224:227], a[96:99], a[180:183], v[224:227]
    v_mfma_f32_16x16x32_bf16 v[68:71], a[100:103], a[160:163], v[68:71]
    ds_read_b128 a[208:211], v14 offset:8192
    v_mfma_f32_16x16x32_bf16 v[100:103], a[100:103], a[164:167], v[100:103]
    buffer_load_dwordx4 v8, s[44:47], s64 offen  lds
    s_add_u32 m0, s74, 5120
    v_mfma_f32_16x16x32_bf16 v[132:135], a[100:103], a[168:171], v[132:135]
    ds_read_b128 a[212:215], v14 offset:10240
    v_mfma_f32_16x16x32_bf16 v[164:167], a[100:103], a[172:175], v[164:167]
    ds_read_b64_tr_b16 a[128:129], v30 offset:0
    v_mfma_f32_16x16x32_bf16 v[196:199], a[100:103], a[176:179], v[196:199]
    ds_read_b64_tr_b16 a[130:131], v30 offset:512
    v_mfma_f32_16x16x32_bf16 v[228:231], a[100:103], a[180:183], v[228:231]
    buffer_load_dwordx4 v9, s[44:47], s64 offen  lds
    s_add_u32 m0, s73, 0
    v_mfma_f32_16x16x32_bf16 v[72:75], a[104:107], a[160:163], v[72:75]
    ds_read_b64_tr_b16 a[132:133], v31 offset:32
    v_mfma_f32_16x16x32_bf16 v[104:107], a[104:107], a[164:167], v[104:107]
    ds_read_b64_tr_b16 a[134:135], v31 offset:544
    v_mfma_f32_16x16x32_bf16 v[136:139], a[104:107], a[168:171], v[136:139]
    v_mfma_f32_16x16x32_bf16 v[168:171], a[104:107], a[172:175], v[168:171]
    buffer_load_dwordx4 v10, s[48:51], s65 offen  lds
    s_add_u32 m0, s73, 2112
    v_mfma_f32_16x16x32_bf16 v[200:203], a[104:107], a[176:179], v[200:203]
    ds_read_b64_tr_b16 a[136:137], v30 offset:64
    v_mfma_f32_16x16x32_bf16 v[232:235], a[104:107], a[180:183], v[232:235]
    ds_read_b64_tr_b16 a[138:139], v30 offset:576
    v_mfma_f32_16x16x32_bf16 v[76:79], a[108:111], a[160:163], v[76:79]
    ds_read_b64_tr_b16 a[140:141], v31 offset:96
    v_mfma_f32_16x16x32_bf16 v[108:111], a[108:111], a[164:167], v[108:111]
    buffer_load_dwordx4 v11, s[48:51], s65 offen  lds
    s_add_u32 m0, s73, 4224
    v_mfma_f32_16x16x32_bf16 v[140:143], a[108:111], a[168:171], v[140:143]
    ds_read_b64_tr_b16 a[142:143], v31 offset:608
    v_mfma_f32_16x16x32_bf16 v[172:175], a[108:111], a[172:175], v[172:175]
    ds_read_b64_tr_b16 a[144:145], v30 offset:128
    v_mfma_f32_16x16x32_bf16 v[204:207], a[108:111], a[176:179], v[204:207]
    buffer_load_dwordx4 v12, s[48:51], s65 offen  lds
    s_add_u32 m0, s73, 6336
    v_mfma_f32_16x16x32_bf16 v[236:239], a[108:111], a[180:183], v[236:239]
    ds_read_b64_tr_b16 a[146:147], v30 offset:640
    v_mfma_f32_16x16x32_bf16 v[80:83], a[112:115], a[160:163], v[80:83]
    ds_read_b64_tr_b16 a[148:149], v31 offset:160
    v_mfma_f32_16x16x32_bf16 v[112:115], a[112:115], a[164:167], v[112:115]
    v_mfma_f32_16x16x32_bf16 v[144:147], a[112:115], a[168:171], v[144:147]
    buffer_load_dwordx4 v13, s[48:51], s65 offen  lds
    s_add_u32 s71, s71, 1024
    s_and_b32 s71, s71, 0x3ffff
    v_mfma_f32_16x16x32_bf16 v[176:179], a[112:115], a[172:175], v[176:179]
    ds_read_b64_tr_b16 a[150:151], v31 offset:672
    ds_read_b64_tr_b16 a[152:153], v30 offset:192
    v_mfma_f32_16x16x32_bf16 v[208:211], a[112:115], a[176:179], v[208:211]
    v_mfma_f32_16x16x32_bf16 v[240:243], a[112:115], a[180:183], v[240:243]
    ds_read_b64_tr_b16 a[154:155], v30 offset:704
    v_mfma_f32_16x16x32_bf16 v[84:87], a[116:119], a[160:163], v[84:87]
    buffer_load_dwordx4 a[24:27], v0, s[52:55], s71 offen nt
    s_add_u32 s71, s71, 1024
    s_and_b32 s71, s71, 0x3ffff
    v_mfma_f32_16x16x32_bf16 v[116:119], a[116:119], a[164:167], v[116:119]
    ds_read_b64_tr_b16 a[156:157], v31 offset:224
    v_mfma_f32_16x16x32_bf16 v[148:151], a[116:119], a[168:171], v[148:151]
    ds_read_b64_tr_b16 a[158:159], v31 offset:736
    v_mfma_f32_16x16x32_bf16 v[180:183], a[116:119], a[172:175], v[180:183]
    v_mfma_f32_16x16x32_bf16 v[212:215], a[116:119], a[176:179], v[212:215]
    buffer_load_dwordx4 a[28:31], v0, s[52:55], s71 offen nt
    v_mfma_f32_16x16x32_bf16 v[244:247], a[116:119], a[180:183], v[244:247]
    v_mfma_f32_16x16x32_bf16 v[88:91], a[120:123], a[160:163], v[88:91]
    v_mfma_f32_16x16x32_bf16 v[120:123], a[120:123], a[164:167], v[120:123]
    v_mfma_f32_16x16x32_bf16 v[152:155], a[120:123], a[168:171], v[152:155]
    s_add_u32 s65, s65, 262144
    s_cmp_eq_u32 s65, 5242880
    v_mfma_f32_16x16x32_bf16 v[184:187], a[120:123], a[172:175], v[184:187]
    s_cselect_b32 s65, 0, s65
    s_add_u32 s73, s80, s69
    v_mfma_f32_16x16x32_bf16 v[216:219], a[120:123], a[176:179], v[216:219]
    s_mov_b32 s10, s80
    s_mov_b32 s80, s81
    v_mfma_f32_16x16x32_bf16 v[248:251], a[120:123], a[180:183], v[248:251]
    s_mov_b32 s81, s82
    s_mov_b32 s82, s10
    v_mfma_f32_16x16x32_bf16 v[92:95], a[124:127], a[160:163], v[92:95]
    v_add_u32 v30, s80, v26
    v_add_u32 v31, s80, v27
    v_mfma_f32_16x16x32_bf16 v[124:127], a[124:127], a[164:167], v[124:127]
    s_add_u32 s64, s64, 128
    s_cmp_eq_u32 s64, 1280
    v_mfma_f32_16x16x32_bf16 v[156:159], a[124:127], a[168:171], v[156:159]
    s_cselect_b32 s64, 0, s64
    s_add_u32 s74, s66, s70
    v_mfma_f32_16x16x32_bf16 v[188:191], a[124:127], a[172:175], v[188:191]
    s_mov_b32 s10, s66
    s_mov_b32 s66, s67
    v_mfma_f32_16x16x32_bf16 v[220:223], a[124:127], a[176:179], v[220:223]
    s_mov_b32 s67, s83
    s_mov_b32 s83, s10
    v_mfma_f32_16x16x32_bf16 v[252:255], a[124:127], a[180:183], v[252:255]
    v_add_u32 v14, s66, v28
    s_waitcnt vmcnt(11) lgkmcnt(0)
    s_barrier
    v_mfma_f32_16x16x32_bf16 v[64:67], a[128:131], a[192:195], v[64:67]
    s_add_u32 m0, s74, 0
    ds_read_b128 a[160:163], v14 offset:0
    v_mfma_f32_16x16x32_bf16 v[96:99], a[128:131], a[196:199], v[96:99]
    ds_read_b128 a[164:167], v14 offset:2048
    v_mfma_f32_16x16x32_bf16 v[128:131], a[128:131], a[200:203], v[128:131]
    v_mfma_f32_16x16x32_bf16 v[160:163], a[128:131], a[204:207], v[160:163]
    buffer_load_dwordx4 v4, s[44:47], s64 offen  lds
    s_add_u32 m0, s74, 1024
    v_mfma_f32_16x16x32_bf16 v[192:195], a[128:131], a[208:211], v[192:195]
    ds_read_b128 a[168:171], v14 offset:4096
    ds_read_b128 a[172:175], v14 offset:6144
    v_mfma_f32_16x16x32_bf16 v[224:227], a[128:131], a[212:215], v[224:227]
    v_mfma_f32_16x16x32_bf16 v[68:71], a[132:135], a[192:195], v[68:71]
    ds_read_b128 a[176:179], v14 offset:8192
    v_mfma_f32_16x16x32_bf16 v[100:103], a[132:135], a[196:199], v[100:103]
    buffer_load_dwordx4 v5, s[44:47], s64 offen  lds
    s_add_u32 m0, s74, 2048
    v_mfma_f32_16x16x32_bf16 v[132:135], a[132:135], a[200:203], v[132:135]
    ds_read_b128 a[180:183], v14 offset:10240
    v_mfma_f32_16x16x32_bf16 v[164:167], a[132:135], a[204:207], v[164:167]
    ds_read_b64_tr_b16 a[96:97], v30 offset:0
    v_mfma_f32_16x16x32_bf16 v[196:199], a[132:135], a[208:211], v[196:199]
    ds_read_b64_tr_b16 a[98:99], v30 offset:512
    v_mfma_f32_16x16x32_bf16 v[228:231], a[132:135], a[212:215], v[228:231]
    buffer_load_dwordx4 v6, s[44:47], s64 offen  lds
    s_add_u32 m0, s73, 0
    v_mfma_f32_16x16x32_bf16 v[72:75], a[136:139], a[192:195], v[72:75]
    ds_read_b64_tr_b16 a[100:101], v31 offset:32
    v_mfma_f32_16x16x32_bf16 v[104:107], a[136:139], a[196:199], v[104:107]
    ds_read_b64_tr_b16 a[102:103], v31 offset:544
    v_mfma_f32_16x16x32_bf16 v[136:139], a[136:139], a[200:203], v[136:139]
    v_mfma_f32_16x16x32_bf16 v[168:171], a[136:139], a[204:207], v[168:171]
    buffer_load_dwordx4 v10, s[48:51], s65 offen  lds
    s_add_u32 m0, s73, 2112
    v_mfma_f32_16x16x32_bf16 v[200:203], a[136:139], a[208:211], v[200:203]
    ds_read_b64_tr_b16 a[104:105], v30 offset:64
    v_mfma_f32_16x16x32_bf16 v[232:235], a[136:139], a[212:215], v[232:235]
    ds_read_b64_tr_b16 a[106:107], v30 offset:576
    v_mfma_f32_16x16x32_bf16 v[76:79], a[140:143], a[192:195], v[76:79]
    ds_read_b64_tr_b16 a[108:109], v31 offset:96
    v_mfma_f32_16x16x32_bf16 v[108:111], a[140:143], a[196:199], v[108:111]
    buffer_load_dwordx4 v11, s[48:51], s65 offen  lds
    s_add_u32 m0, s73, 4224
    v_mfma_f32_16x16x32_bf16 v[140:143], a[140:143], a[200:203], v[140:143]
    ds_read_b64_tr_b16 a[110:111], v31 offset:608
    v_mfma_f32_16x16x32_bf16 v[172:175], a[140:143], a[204:207], v[172:175]
    ds_read_b64_tr_b16 a[112:113], v30 offset:128
    v_mfma_f32_16x16x32_bf16 v[204:207], a[140:143], a[208:211], v[204:207]
    buffer_load_dwordx4 v12, s[48:51], s65 offen  lds
    s_add_u32 m0, s73, 6336
    v_mfma_f32_16x16x32_bf16 v[236:239], a[140:143], a[212:215], v[236:239]
    ds_read_b64_tr_b16 a[114:115], v30 offset:640
    v_mfma_f32_16x16x32_bf16 v[80:83], a[144:147], a[192:195], v[80:83]
    ds_read_b64_tr_b16 a[116:117], v31 offset:160
    v_mfma_f32_16x16x32_bf16 v[112:115], a[144:147], a[196:199], v[112:115]
    v_mfma_f32_16x16x32_bf16 v[144:147], a[144:147], a[200:203], v[144:147]
    buffer_load_dwordx4 v13, s[48:51], s65 offen  lds
    s_add_u32 s71, s71, 1024
    s_and_b32 s71, s71, 0x3ffff
    v_mfma_f32_16x16x32_bf16 v[176:179], a[144:147], a[204:207], v[176:179]
    ds_read_b64_tr_b16 a[118:119], v31 offset:672
    ds_read_b64_tr_b16 a[120:121], v30 offset:192
    v_mfma_f32_16x16x32_bf16 v[208:211], a[144:147], a[208:211], v[208:211]
    v_mfma_f32_16x16x32_bf16 v[240:243], a[144:147], a[212:215], v[240:243]
    ds_read_b64_tr_b16 a[122:123], v30 offset:704
    v_mfma_f32_16x16x32_bf16 v[84:87], a[148:151], a[192:195], v[84:87]
    buffer_load_dwordx4 a[32:35], v0, s[52:55], s71 offen nt
    s_add_u32 s71, s71, 1024
    s_and_b32 s71, s71, 0x3ffff
    v_mfma_f32_16x16x32_bf16 v[116:119], a[148:151], a[196:199], v[116:119]
    ds_read_b64_tr_b16 a[124:125], v31 offset:224
    v_mfma_f32_16x16x32_bf16 v[148:151], a[148:151], a[200:203], v[148:151]
    ds_read_b64_tr_b16 a[126:127], v31 offset:736
    v_mfma_f32_16x16x32_bf16 v[180:183], a[148:151], a[204:207], v[180:183]
    v_mfma_f32_16x16x32_bf16 v[212:215], a[148:151], a[208:211], v[212:215]
    buffer_load_dwordx4 a[36:39], v0, s[52:55], s71 offen nt
    v_mfma_f32_16x16x32_bf16 v[244:247], a[148:151], a[212:215], v[244:247]
    v_mfma_f32_16x16x32_bf16 v[88:91], a[152:155], a[192:195], v[88:91]
    v_mfma_f32_16x16x32_bf16 v[120:123], a[152:155], a[196:199], v[120:123]
    v_mfma_f32_16x16x32_bf16 v[152:155], a[152:155], a[200:203], v[152:155]
    s_add_u32 s65, s65, 262144
    s_cmp_eq_u32 s65, 5242880
    v_mfma_f32_16x16x32_bf16 v[184:187], a[152:155], a[204:207], v[184:187]
    s_cselect_b32 s65, 0, s65
    s_add_u32 s73, s80, s69
    v_mfma_f32_16x16x32_bf16 v[216:219], a[152:155], a[208:211], v[216:219]
    s_mov_b32 s10, s80
    s_mov_b32 s80, s81
    v_mfma_f32_16x16x32_bf16 v[248:251], a[152:155], a[212:215], v[248:251]
    s_mov_b32 s81, s82
    s_mov_b32 s82, s10
    v_mfma_f32_16x16x32_bf16 v[92:95], a[156:159], a[192:195], v[92:95]
    v_add_u32 v30, s80, v26
    v_add_u32 v31, s80, v27
    v_mfma_f32_16x16x32_bf16 v[124:127], a[156:159], a[196:199], v[124:127]
    v_add_u32 v14, s66, v29
    v_mfma_f32_16x16x32_bf16 v[156:159], a[156:159], a[200:203], v[156:159]
    v_mfma_f32_16x16x32_bf16 v[188:191], a[156:159], a[204:207], v[188:191]
    v_mfma_f32_16x16x32_bf16 v[220:223], a[156:159], a[208:211], v[220:223]
    v_mfma_f32_16x16x32_bf16 v[252:255], a[156:159], a[212:215], v[252:255]
    s_waitcnt vmcnt(11) lgkmcnt(0)
    s_barrier
    v_mfma_f32_16x16x32_bf16 v[64:67], a[96:99], a[160:163], v[64:67]
    s_add_u32 m0, s74, 3072
    ds_read_b128 a[192:195], v14 offset:0
    v_mfma_f32_16x16x32_bf16 v[96:99], a[96:99], a[164:167], v[96:99]
    ds_read_b128 a[196:199], v14 offset:2048
    v_mfma_f32_16x16x32_bf16 v[128:131], a[96:99], a[168:171], v[128:131]
    v_mfma_f32_16x16x32_bf16 v[160:163], a[96:99], a[172:175], v[160:163]
    buffer_load_dwordx4 v7, s[44:47], s64 offen  lds
    s_add_u32 m0, s74, 4096
    v_mfma_f32_16x16x32_bf16 v[192:195], a[96:99], a[176:179], v[192:195]
    ds_read_b128 a[200:203], v14 offset:4096
    ds_read_b128 a[204:207], v14 offset:6144
    v_mfma_f32_16x16x32_bf16 v[224:227], a[96:99], a[180:183], v[224:227]
    v_mfma_f32_16x16x32_bf16 v[68:71], a[100:103], a[160:163], v[68:71]
    ds_read_b128 a[208:211], v14 offset:8192
    v_mfma_f32_16x16x32_bf16 v[100:103], a[100:103], a[164:167], v[100:103]
    buffer_load_dwordx4 v8, s[44:47], s64 offen  lds
    s_add_u32 m0, s74, 5120
    v_mfma_f32_16x16x32_bf16 v[132:135], a[100:103], a[168:171], v[132:135]
    ds_read_b128 a[212:215], v14 offset:10240
    v_mfma_f32_16x16x32_bf16 v[164:167], a[100:103], a[172:175], v[164:167]
    ds_read_b64_tr_b16 a[128:129], v30 offset:0
    v_mfma_f32_16x16x32_bf16 v[196:199], a[100:103], a[176:179], v[196:199]
    ds_read_b64_tr_b16 a[130:131], v30 offset:512
    v_mfma_f32_16x16x32_bf16 v[228:231], a[100:103], a[180:183], v[228:231]
    buffer_load_dwordx4 v9, s[44:47], s64 offen  lds
    s_add_u32 m0, s73, 0
    v_mfma_f32_16x16x32_bf16 v[72:75], a[104:107], a[160:163], v[72:75]
    ds_read_b64_tr_b16 a[132:133], v31 offset:32
    v_mfma_f32_16x16x32_bf16 v[104:107], a[104:107], a[164:167], v[104:107]
    ds_read_b64_tr_b16 a[134:135], v31 offset:544
    v_mfma_f32_16x16x32_bf16 v[136:139], a[104:107], a[168:171], v[136:139]
    v_mfma_f32_16x16x32_bf16 v[168:171], a[104:107], a[172:175], v[168:171]
    buffer_load_dwordx4 v10, s[48:51], s65 offen  lds
    s_add_u32 m0, s73, 2112
    v_mfma_f32_16x16x32_bf16 v[200:203], a[104:107], a[176:179], v[200:203]
    ds_read_b64_tr_b16 a[136:137], v30 offset:64
    v_mfma_f32_16x16x32_bf16 v[232:235], a[104:107], a[180:183], v[232:235]
    ds_read_b64_tr_b16 a[138:139], v30 offset:576
    v_mfma_f32_16x16x32_bf16 v[76:79], a[108:111], a[160:163], v[76:79]
    ds_read_b64_tr_b16 a[140:141], v31 offset:96
    v_mfma_f32_16x16x32_bf16 v[108:111], a[108:111], a[164:167], v[108:111]
    buffer_load_dwordx4 v11, s[48:51], s65 offen  lds
    s_add_u32 m0, s73, 4224
    v_mfma_f32_16x16x32_bf16 v[140:143], a[108:111], a[168:171], v[140:143]
    ds_read_b64_tr_b16 a[142:143], v31 offset:608
    v_mfma_f32_16x16x32_bf16 v[172:175], a[108:111], a[172:175], v[172:175]
    ds_read_b64_tr_b16 a[144:145], v30 offset:128
    v_mfma_f32_16x16x32_bf16 v[204:207], a[108:111], a[176:179], v[204:207]
    buffer_load_dwordx4 v12, s[48:51], s65 offen  lds
    s_add_u32 m0, s73, 6336
    v_mfma_f32_16x16x32_bf16 v[236:239], a[108:111], a[180:183], v[236:239]
    ds_read_b64_tr_b16 a[146:147], v30 offset:640
    v_mfma_f32_16x16x32_bf16 v[80:83], a[112:115], a[160:163], v[80:83]
    ds_read_b64_tr_b16 a[148:149], v31 offset:160
    v_mfma_f32_16x16x32_bf16 v[112:115], a[112:115], a[164:167], v[112:115]
    v_mfma_f32_16x16x32_bf16 v[144:147], a[112:115], a[168:171], v[144:147]
    buffer_load_dwordx4 v13, s[48:51], s65 offen  lds
    s_add_u32 s71, s71, 1024
    s_and_b32 s71, s71, 0x3ffff
    v_mfma_f32_16x16x32_bf16 v[176:179], a[112:115], a[172:175], v[176:179]
    ds_read_b64_tr_b16 a[150:151], v31 offset:672
    ds_read_b64_tr_b16 a[152:153], v30 offset:192
    v_mfma_f32_16x16x32_bf16 v[208:211], a[112:115], a[176:179], v[208:211]
    v_mfma_f32_16x16x32_bf16 v[240:243], a[112:115], a[180:183], v[240:243]
    ds_read_b64_tr_b16 a[154:155], v30 offset:704
    v_mfma_f32_16x16x32_bf16 v[84:87], a[116:119], a[160:163], v[84:87]
    buffer_load_dwordx4 a[40:43], v0, s[52:55], s71 offen nt
    s_add_u32 s71, s71, 1024
    s_and_b32 s71, s71, 0x3ffff
    v_mfma_f32_16x16x32_bf16 v[116:119], a[116:119], a[164:167], v[116:119]
    ds_read_b64_tr_b16 a[156:157], v31 offset:224
    v_mfma_f32_16x16x32_bf16 v[148:151], a[116:119], a[168:171], v[148:151]
    ds_read_b64_tr_b16 a[158:159], v31 offset:736
    v_mfma_f32_16x16x32_bf16 v[180:183], a[116:119], a[172:175], v[180:183]
    v_mfma_f32_16x16x32_bf16 v[212:215], a[116:119], a[176:179], v[212:215]
    buffer_load_dwordx4 a[44:47], v0, s[52:55], s71 offen nt
    v_mfma_f32_16x16x32_bf16 v[244:247], a[116:119], a[180:183], v[244:247]
    v_mfma_f32_16x16x32_bf16 v[88:91], a[120:123], a[160:163], v[88:91]
    v_mfma_f32_16x16x32_bf16 v[120:123], a[120:123], a[164:167], v[120:123]
    v_mfma_f32_16x16x32_bf16 v[152:155], a[120:123], a[168:171], v[152:155]
    s_add_u32 s65, s65, 262144
    s_cmp_eq_u32 s65, 5242880
    v_mfma_f32_16x16x32_bf16 v[184:187], a[120:123], a[172:175], v[184:187]
    s_cselect_b32 s65, 0, s65
    s_add_u32 s73, s80, s69
    v_mfma_f32_16x16x32_bf16 v[216:219], a[120:123], a[176:179], v[216:219]
    s_mov_b32 s10, s80
    s_mov_b32 s80, s81
    v_mfma_f32_16x16x32_bf16 v[248:251], a[120:123], a[180:183], v[248:251]
    s_mov_b32 s81, s82
    s_mov_b32 s82, s10
    v_mfma_f32_16x16x32_bf16 v[92:95], a[124:127], a[160:163], v[92:95]
    v_add_u32 v30, s80, v26
    v_add_u32 v31, s80, v27
    v_mfma_f32_16x16x32_bf16 v[124:127], a[124:127], a[164:167], v[124:127]
    s_add_u32 s64, s64, 128
    s_cmp_eq_u32 s64, 1280
    v_mfma_f32_16x16x32_bf16 v[156:159], a[124:127], a[168:171], v[156:159]
    s_cselect_b32 s64, 0, s64
    s_add_u32 s74, s66, s70
    v_mfma_f32_16x16x32_bf16 v[188:191], a[124:127], a[172:175], v[188:191]
    s_mov_b32 s10, s66
    s_mov_b32 s66, s67
    v_mfma_f32_16x16x32_bf16 v[220:223], a[124:127], a[176:179], v[220:223]
    s_mov_b32 s67, s83
    s_mov_b32 s83, s10
    v_mfma_f32_16x16x32_bf16 v[252:255], a[124:127], a[180:183], v[252:255]
    v_add_u32 v14, s66, v28
    s_waitcnt vmcnt(11) lgkmcnt(0)
    s_barrier
    v_mfma_f32_16x16x32_bf16 v[64:67], a[128:131], a[192:195], v[64:67]
    s_add_u32 m0, s74, 0
    ds_read_b128 a[160:163], v14 offset:0
    v_mfma_f32_16x16x32_bf16 v[96:99], a[128:131], a[196:199], v[96:99]
    ds_read_b128 a[164:167], v14 offset:2048
    v_mfma_f32_16x16x32_bf16 v[128:131], a[128:131], a[200:203], v[128:131]
    v_mfma_f32_16x16x32_bf16 v[160:163], a[128:131], a[204:207], v[160:163]
    buffer_load_dwordx4 v4, s[44:47], s64 offen  lds
    s_add_u32 m0, s74, 1024
    v_mfma_f32_16x16x32_bf16 v[192:195], a[128:131], a[208:211], v[192:195]
    ds_read_b128 a[168:171], v14 offset:4096
    ds_read_b128 a[172:175], v14 offset:6144
    v_mfma_f32_16x16x32_bf16 v[224:227], a[128:131], a[212:215], v[224:227]
    v_mfma_f32_16x16x32_bf16 v[68:71], a[132:135], a[192:195], v[68:71]
    ds_read_b128 a[176:179], v14 offset:8192
    v_mfma_f32_16x16x32_bf16 v[100:103], a[132:135], a[196:199], v[100:103]
    buffer_load_dwordx4 v5, s[44:47], s64 offen  lds
    s_add_u32 m0, s74, 2048
    v_mfma_f32_16x16x32_bf16 v[132:135], a[132:135], a[200:203], v[132:135]
    ds_read_b128 a[180:183], v14 offset:10240
    v_mfma_f32_16x16x32_bf16 v[164:167], a[132:135], a[204:207], v[164:167]
    ds_read_b64_tr_b16 a[96:97], v30 offset:0
    v_mfma_f32_16x16x32_bf16 v[196:199], a[132:135], a[208:211], v[196:199]
    ds_read_b64_tr_b16 a[98:99], v30 offset:512
    v_mfma_f32_16x16x32_bf16 v[228:231], a[132:135], a[212:215], v[228:231]
    buffer_load_dwordx4 v6, s[44:47], s64 offen  lds
    s_add_u32 m0, s73, 0
    v_mfma_f32_16x16x32_bf16 v[72:75], a[136:139], a[192:195], v[72:75]
    ds_read_b64_tr_b16 a[100:101], v31 offset:32
    v_mfma_f32_16x16x32_bf16 v[104:107], a[136:139], a[196:199], v[104:107]
    ds_read_b64_tr_b16 a[102:103], v31 offset:544
    v_mfma_f32_16x16x32_bf16 v[136:139], a[136:139], a[200:203], v[136:139]
    v_mfma_f32_16x16x32_bf16 v[168:171], a[136:139], a[204:207], v[168:171]
    buffer_load_dwordx4 v10, s[48:51], s65 offen  lds
    s_add_u32 m0, s73, 2112
    v_mfma_f32_16x16x32_bf16 v[200:203], a[136:139], a[208:211], v[200:203]
    ds_read_b64_tr_b16 a[104:105], v30 offset:64
    v_mfma_f32_16x16x32_bf16 v[232:235], a[136:139], a[212:215], v[232:235]
    ds_read_b64_tr_b16 a[106:107], v30 offset:576
    v_mfma_f32_16x16x32_bf16 v[76:79], a[140:143], a[192:195], v[76:79]
    ds_read_b64_tr_b16 a[108:109], v31 offset:96
    v_mfma_f32_16x16x32_bf16 v[108:111], a[140:143], a[196:199], v[108:111]
    buffer_load_dwordx4 v11, s[48:51], s65 offen  lds
    s_add_u32 m0, s73, 4224
    v_mfma_f32_16x16x32_bf16 v[140:143], a[140:143], a[200:203], v[140:143]
    ds_read_b64_tr_b16 a[110:111], v31 offset:608
    v_mfma_f32_16x16x32_bf16 v[172:175], a[140:143], a[204:207], v[172:175]
    ds_read_b64_tr_b16 a[112:113], v30 offset:128
    v_mfma_f32_16x16x32_bf16 v[204:207], a[140:143], a[208:211], v[204:207]
    buffer_load_dwordx4 v12, s[48:51], s65 offen  lds
    s_add_u32 m0, s73, 6336
    v_mfma_f32_16x16x32_bf16 v[236:239], a[140:143], a[212:215], v[236:239]
    ds_read_b64_tr_b16 a[114:115], v30 offset:640
    v_mfma_f32_16x16x32_bf16 v[80:83], a[144:147], a[192:195], v[80:83]
    ds_read_b64_tr_b16 a[116:117], v31 offset:160
    v_mfma_f32_16x16x32_bf16 v[112:115], a[144:147], a[196:199], v[112:115]
    v_mfma_f32_16x16x32_bf16 v[144:147], a[144:147], a[200:203], v[144:147]
    buffer_load_dwordx4 v13, s[48:51], s65 offen  lds
    s_add_u32 s71, s71, 1024
    s_and_b32 s71, s71, 0x3ffff
    v_mfma_f32_16x16x32_bf16 v[176:179], a[144:147], a[204:207], v[176:179]
    ds_read_b64_tr_b16 a[118:119], v31 offset:672
    ds_read_b64_tr_b16 a[120:121], v30 offset:192
    v_mfma_f32_16x16x32_bf16 v[208:211], a[144:147], a[208:211], v[208:211]
    v_mfma_f32_16x16x32_bf16 v[240:243], a[144:147], a[212:215], v[240:243]
    ds_read_b64_tr_b16 a[122:123], v30 offset:704
    v_mfma_f32_16x16x32_bf16 v[84:87], a[148:151], a[192:195], v[84:87]
    buffer_load_dwordx4 a[48:51], v0, s[52:55], s71 offen nt
    s_add_u32 s71, s71, 1024
    s_and_b32 s71, s71, 0x3ffff
    v_mfma_f32_16x16x32_bf16 v[116:119], a[148:151], a[196:199], v[116:119]
    ds_read_b64_tr_b16 a[124:125], v31 offset:224
    v_mfma_f32_16x16x32_bf16 v[148:151], a[148:151], a[200:203], v[148:151]
    ds_read_b64_tr_b16 a[126:127], v31 offset:736
    v_mfma_f32_16x16x32_bf16 v[180:183], a[148:151], a[204:207], v[180:183]
    v_mfma_f32_16x16x32_bf16 v[212:215], a[148:151], a[208:211], v[212:215]
    buffer_load_dwordx4 a[52:55], v0, s[52:55], s71 offen nt
    v_mfma_f32_16x16x32_bf16 v[244:247], a[148:151], a[212:215], v[244:247]
    v_mfma_f32_16x16x32_bf16 v[88:91], a[152:155], a[192:195], v[88:91]
    v_mfma_f32_16x16x32_bf16 v[120:123], a[152:155], a[196:199], v[120:123]
    v_mfma_f32_16x16x32_bf16 v[152:155], a[152:155], a[200:203], v[152:155]
    s_add_u32 s65, s65, 262144
    s_cmp_eq_u32 s65, 5242880
    v_mfma_f32_16x16x32_bf16 v[184:187], a[152:155], a[204:207], v[184:187]
    s_cselect_b32 s65, 0, s65
    s_add_u32 s73, s80, s69
    v_mfma_f32_16x16x32_bf16 v[216:219], a[152:155], a[208:211], v[216:219]
    s_mov_b32 s10, s80
    s_mov_b32 s80, s81
    v_mfma_f32_16x16x32_bf16 v[248:251], a[152:155], a[212:215], v[248:251]
    s_mov_b32 s81, s82
    s_mov_b32 s82, s10
    v_mfma_f32_16x16x32_bf16 v[92:95], a[156:159], a[192:195], v[92:95]
    v_add_u32 v30, s80, v26
    v_add_u32 v31, s80, v27
    v_mfma_f32_16x16x32_bf16 v[124:127], a[156:159], a[196:199], v[124:127]
    v_add_u32 v14, s66, v29
    v_mfma_f32_16x16x32_bf16 v[156:159], a[156:159], a[200:203], v[156:159]
    v_mfma_f32_16x16x32_bf16 v[188:191], a[156:159], a[204:207], v[188:191]
    v_mfma_f32_16x16x32_bf16 v[220:223], a[156:159], a[208:211], v[220:223]
    v_mfma_f32_16x16x32_bf16 v[252:255], a[156:159], a[212:215], v[252:255]
    s_waitcnt vmcnt(11) lgkmcnt(0)
    s_barrier
    v_mfma_f32_16x16x32_bf16 v[64:67], a[96:99], a[160:163], v[64:67]
    s_add_u32 m0, s74, 3072
    ds_read_b128 a[192:195], v14 offset:0
    v_mfma_f32_16x16x32_bf16 v[96:99], a[96:99], a[164:167], v[96:99]
    ds_read_b128 a[196:199], v14 offset:2048
    v_mfma_f32_16x16x32_bf16 v[128:131], a[96:99], a[168:171], v[128:131]
    v_mfma_f32_16x16x32_bf16 v[160:163], a[96:99], a[172:175], v[160:163]
    buffer_load_dwordx4 v7, s[44:47], s64 offen  lds
    s_add_u32 m0, s74, 4096
    v_mfma_f32_16x16x32_bf16 v[192:195], a[96:99], a[176:179], v[192:195]
    ds_read_b128 a[200:203], v14 offset:4096
    ds_read_b128 a[204:207], v14 offset:6144
    v_mfma_f32_16x16x32_bf16 v[224:227], a[96:99], a[180:183], v[224:227]
    v_mfma_f32_16x16x32_bf16 v[68:71], a[100:103], a[160:163], v[68:71]
    ds_read_b128 a[208:211], v14 offset:8192
    v_mfma_f32_16x16x32_bf16 v[100:103], a[100:103], a[164:167], v[100:103]
    buffer_load_dwordx4 v8, s[44:47], s64 offen  lds
    s_add_u32 m0, s74, 5120
    v_mfma_f32_16x16x32_bf16 v[132:135], a[100:103], a[168:171], v[132:135]
    ds_read_b128 a[212:215], v14 offset:10240
    v_mfma_f32_16x16x32_bf16 v[164:167], a[100:103], a[172:175], v[164:167]
    ds_read_b64_tr_b16 a[128:129], v30 offset:0
    v_mfma_f32_16x16x32_bf16 v[196:199], a[100:103], a[176:179], v[196:199]
    ds_read_b64_tr_b16 a[130:131], v30 offset:512
    v_mfma_f32_16x16x32_bf16 v[228:231], a[100:103], a[180:183], v[228:231]
    buffer_load_dwordx4 v9, s[44:47], s64 offen  lds
    s_add_u32 m0, s73, 0
    v_mfma_f32_16x16x32_bf16 v[72:75], a[104:107], a[160:163], v[72:75]
    ds_read_b64_tr_b16 a[132:133], v31 offset:32
    v_mfma_f32_16x16x32_bf16 v[104:107], a[104:107], a[164:167], v[104:107]
    ds_read_b64_tr_b16 a[134:135], v31 offset:544
    v_mfma_f32_16x16x32_bf16 v[136:139], a[104:107], a[168:171], v[136:139]
    v_mfma_f32_16x16x32_bf16 v[168:171], a[104:107], a[172:175], v[168:171]
    buffer_load_dwordx4 v10, s[48:51], s65 offen  lds
    s_add_u32 m0, s73, 2112
    v_mfma_f32_16x16x32_bf16 v[200:203], a[104:107], a[176:179], v[200:203]
    ds_read_b64_tr_b16 a[136:137], v30 offset:64
    v_mfma_f32_16x16x32_bf16 v[232:235], a[104:107], a[180:183], v[232:235]
    ds_read_b64_tr_b16 a[138:139], v30 offset:576
    v_mfma_f32_16x16x32_bf16 v[76:79], a[108:111], a[160:163], v[76:79]
    ds_read_b64_tr_b16 a[140:141], v31 offset:96
    v_mfma_f32_16x16x32_bf16 v[108:111], a[108:111], a[164:167], v[108:111]
    buffer_load_dwordx4 v11, s[48:51], s65 offen  lds
    s_add_u32 m0, s73, 4224
    v_mfma_f32_16x16x32_bf16 v[140:143], a[108:111], a[168:171], v[140:143]
    ds_read_b64_tr_b16 a[142:143], v31 offset:608
    v_mfma_f32_16x16x32_bf16 v[172:175], a[108:111], a[172:175], v[172:175]
    ds_read_b64_tr_b16 a[144:145], v30 offset:128
    v_mfma_f32_16x16x32_bf16 v[204:207], a[108:111], a[176:179], v[204:207]
    buffer_load_dwordx4 v12, s[48:51], s65 offen  lds
    s_add_u32 m0, s73, 6336
    v_mfma_f32_16x16x32_bf16 v[236:239], a[108:111], a[180:183], v[236:239]
    ds_read_b64_tr_b16 a[146:147], v30 offset:640
    v_mfma_f32_16x16x32_bf16 v[80:83], a[112:115], a[160:163], v[80:83]
    ds_read_b64_tr_b16 a[148:149], v31 offset:160
    v_mfma_f32_16x16x32_bf16 v[112:115], a[112:115], a[164:167], v[112:115]
    v_mfma_f32_16x16x32_bf16 v[144:147], a[112:115], a[168:171], v[144:147]
    buffer_load_dwordx4 v13, s[48:51], s65 offen  lds
    s_add_u32 s71, s71, 1024
    s_and_b32 s71, s71, 0x3ffff
    v_mfma_f32_16x16x32_bf16 v[176:179], a[112:115], a[172:175], v[176:179]
    ds_read_b64_tr_b16 a[150:151], v31 offset:672
    ds_read_b64_tr_b16 a[152:153], v30 offset:192
    v_mfma_f32_16x16x32_bf16 v[208:211], a[112:115], a[176:179], v[208:211]
    v_mfma_f32_16x16x32_bf16 v[240:243], a[112:115], a[180:183], v[240:243]
    ds_read_b64_tr_b16 a[154:155], v30 offset:704
    v_mfma_f32_16x16x32_bf16 v[84:87], a[116:119], a[160:163], v[84:87]
    buffer_load_dwordx4 a[56:59], v0, s[52:55], s71 offen nt
    s_add_u32 s71, s71, 1024
    s_and_b32 s71, s71, 0x3ffff
    v_mfma_f32_16x16x32_bf16 v[116:119], a[116:119], a[164:167], v[116:119]
    ds_read_b64_tr_b16 a[156:157], v31 offset:224
    v_mfma_f32_16x16x32_bf16 v[148:151], a[116:119], a[168:171], v[148:151]
    ds_read_b64_tr_b16 a[158:159], v31 offset:736
    v_mfma_f32_16x16x32_bf16 v[180:183], a[116:119], a[172:175], v[180:183]
    v_mfma_f32_16x16x32_bf16 v[212:215], a[116:119], a[176:179], v[212:215]
    buffer_load_dwordx4 a[60:63], v0, s[52:55], s71 offen nt
    v_mfma_f32_16x16x32_bf16 v[244:247], a[116:119], a[180:183], v[244:247]
    v_mfma_f32_16x16x32_bf16 v[88:91], a[120:123], a[160:163], v[88:91]
    v_mfma_f32_16x16x32_bf16 v[120:123], a[120:123], a[164:167], v[120:123]
    v_mfma_f32_16x16x32_bf16 v[152:155], a[120:123], a[168:171], v[152:155]
    s_add_u32 s65, s65, 262144
    s_cmp_eq_u32 s65, 5242880
    v_mfma_f32_16x16x32_bf16 v[184:187], a[120:123], a[172:175], v[184:187]
    s_cselect_b32 s65, 0, s65
    s_add_u32 s73, s80, s69
    v_mfma_f32_16x16x32_bf16 v[216:219], a[120:123], a[176:179], v[216:219]
    s_mov_b32 s10, s80
    s_mov_b32 s80, s81
    v_mfma_f32_16x16x32_bf16 v[248:251], a[120:123], a[180:183], v[248:251]
    s_mov_b32 s81, s82
    s_mov_b32 s82, s10
    v_mfma_f32_16x16x32_bf16 v[92:95], a[124:127], a[160:163], v[92:95]
    v_add_u32 v30, s80, v26
    v_add_u32 v31, s80, v27
    v_mfma_f32_16x16x32_bf16 v[124:127], a[124:127], a[164:167], v[124:127]
    s_add_u32 s64, s64, 128
    s_cmp_eq_u32 s64, 1280
    v_mfma_f32_16x16x32_bf16 v[156:159], a[124:127], a[168:171], v[156:159]
    s_cselect_b32 s64, 0, s64
    s_add_u32 s74, s66, s70
    v_mfma_f32_16x16x32_bf16 v[188:191], a[124:127], a[172:175], v[188:191]
    s_mov_b32 s10, s66
    s_mov_b32 s66, s67
    v_mfma_f32_16x16x32_bf16 v[220:223], a[124:127], a[176:179], v[220:223]
    s_mov_b32 s67, s83
    s_mov_b32 s83, s10
    v_mfma_f32_16x16x32_bf16 v[252:255], a[124:127], a[180:183], v[252:255]
    v_add_u32 v14, s66, v28
    s_waitcnt vmcnt(11) lgkmcnt(0)
    s_barrier
    v_mfma_f32_16x16x32_bf16 v[64:67], a[128:131], a[192:195], v[64:67]
    s_add_u32 m0, s74, 0
    ds_read_b128 a[160:163], v14 offset:0
    v_mfma_f32_16x16x32_bf16 v[96:99], a[128:131], a[196:199], v[96:99]
    ds_read_b128 a[164:167], v14 offset:2048
    v_mfma_f32_16x16x32_bf16 v[128:131], a[128:131], a[200:203], v[128:131]
    v_mfma_f32_16x16x32_bf16 v[160:163], a[128:131], a[204:207], v[160:163]
    buffer_load_dwordx4 v4, s[44:47], s64 offen  lds
    s_add_u32 m0, s74, 1024
    v_mfma_f32_16x16x32_bf16 v[192:195], a[128:131], a[208:211], v[192:195]
    ds_read_b128 a[168:171], v14 offset:4096
    ds_read_b128 a[172:175], v14 offset:6144
    v_mfma_f32_16x16x32_bf16 v[224:227], a[128:131], a[212:215], v[224:227]
    v_mfma_f32_16x16x32_bf16 v[68:71], a[132:135], a[192:195], v[68:71]
    ds_read_b128 a[176:179], v14 offset:8192
    v_mfma_f32_16x16x32_bf16 v[100:103], a[132:135], a[196:199], v[100:103]
    buffer_load_dwordx4 v5, s[44:47], s64 offen  lds
    s_add_u32 m0, s74, 2048
    v_mfma_f32_16x16x32_bf16 v[132:135], a[132:135], a[200:203], v[132:135]
    ds_read_b128 a[180:183], v14 offset:10240
    v_mfma_f32_16x16x32_bf16 v[164:167], a[132:135], a[204:207], v[164:167]
    ds_read_b64_tr_b16 a[96:97], v30 offset:0
    v_mfma_f32_16x16x32_bf16 v[196:199], a[132:135], a[208:211], v[196:199]
    ds_read_b64_tr_b16 a[98:99], v30 offset:512
    v_mfma_f32_16x16x32_bf16 v[228:231], a[132:135], a[212:215], v[228:231]
    buffer_load_dwordx4 v6, s[44:47], s64 offen  lds
    s_add_u32 m0, s73, 0
    v_mfma_f32_16x16x32_bf16 v[72:75], a[136:139], a[192:195], v[72:75]
    ds_read_b64_tr_b16 a[100:101], v31 offset:32
    v_mfma_f32_16x16x32_bf16 v[104:107], a[136:139], a[196:199], v[104:107]
    ds_read_b64_tr_b16 a[102:103], v31 offset:544
    v_mfma_f32_16x16x32_bf16 v[136:139], a[136:139], a[200:203], v[136:139]
    v_mfma_f32_16x16x32_bf16 v[168:171], a[136:139], a[204:207], v[168:171]
    buffer_load_dwordx4 v10, s[48:51], s65 offen  lds
    s_add_u32 m0, s73, 2112
    v_mfma_f32_16x16x32_bf16 v[200:203], a[136:139], a[208:211], v[200:203]
    ds_read_b64_tr_b16 a[104:105], v30 offset:64
    v_mfma_f32_16x16x32_bf16 v[232:235], a[136:139], a[212:215], v[232:235]
    ds_read_b64_tr_b16 a[106:107], v30 offset:576
    v_mfma_f32_16x16x32_bf16 v[76:79], a[140:143], a[192:195], v[76:79]
    ds_read_b64_tr_b16 a[108:109], v31 offset:96
    v_mfma_f32_16x16x32_bf16 v[108:111], a[140:143], a[196:199], v[108:111]
    buffer_load_dwordx4 v11, s[48:51], s65 offen  lds
    s_add_u32 m0, s73, 4224
    v_mfma_f32_16x16x32_bf16 v[140:143], a[140:143], a[200:203], v[140:143]
    ds_read_b64_tr_b16 a[110:111], v31 offset:608
    v_mfma_f32_16x16x32_bf16 v[172:175], a[140:143], a[204:207], v[172:175]
    ds_read_b64_tr_b16 a[112:113], v30 offset:128
    v_mfma_f32_16x16x32_bf16 v[204:207], a[140:143], a[208:211], v[204:207]
    buffer_load_dwordx4 v12, s[48:51], s65 offen  lds
    s_add_u32 m0, s73, 6336
    v_mfma_f32_16x16x32_bf16 v[236:239], a[140:143], a[212:215], v[236:239]
    ds_read_b64_tr_b16 a[114:115], v30 offset:640
    v_mfma_f32_16x16x32_bf16 v[80:83], a[144:147], a[192:195], v[80:83]
    ds_read_b64_tr_b16 a[116:117], v31 offset:160
    v_mfma_f32_16x16x32_bf16 v[112:115], a[144:147], a[196:199], v[112:115]
    v_mfma_f32_16x16x32_bf16 v[144:147], a[144:147], a[200:203], v[144:147]
    buffer_load_dwordx4 v13, s[48:51], s65 offen  lds
    s_add_u32 s71, s71, 1024
    s_and_b32 s71, s71, 0x3ffff
    v_mfma_f32_16x16x32_bf16 v[176:179], a[144:147], a[204:207], v[176:179]
    ds_read_b64_tr_b16 a[118:119], v31 offset:672
    ds_read_b64_tr_b16 a[120:121], v30 offset:192
    v_mfma_f32_16x16x32_bf16 v[208:211], a[144:147], a[208:211], v[208:211]
    v_mfma_f32_16x16x32_bf16 v[240:243], a[144:147], a[212:215], v[240:243]
    ds_read_b64_tr_b16 a[122:123], v30 offset:704
    v_mfma_f32_16x16x32_bf16 v[84:87], a[148:151], a[192:195], v[84:87]
    buffer_load_dwordx4 a[64:67], v0, s[52:55], s71 offen nt
    s_add_u32 s71, s71, 1024
    s_and_b32 s71, s71, 0x3ffff
    v_mfma_f32_16x16x32_bf16 v[116:119], a[148:151], a[196:199], v[116:119]
    ds_read_b64_tr_b16 a[124:125], v31 offset:224
    v_mfma_f32_16x16x32_bf16 v[148:151], a[148:151], a[200:203], v[148:151]
    ds_read_b64_tr_b16 a[126:127], v31 offset:736
    v_mfma_f32_16x16x32_bf16 v[180:183], a[148:151], a[204:207], v[180:183]
    v_mfma_f32_16x16x32_bf16 v[212:215], a[148:151], a[208:211], v[212:215]
    buffer_load_dwordx4 a[68:71], v0, s[52:55], s71 offen nt
    v_mfma_f32_16x16x32_bf16 v[244:247], a[148:151], a[212:215], v[244:247]
    v_mfma_f32_16x16x32_bf16 v[88:91], a[152:155], a[192:195], v[88:91]
    v_mfma_f32_16x16x32_bf16 v[120:123], a[152:155], a[196:199], v[120:123]
    v_mfma_f32_16x16x32_bf16 v[152:155], a[152:155], a[200:203], v[152:155]
    s_add_u32 s65, s65, 262144
    s_cmp_eq_u32 s65, 5242880
    v_mfma_f32_16x16x32_bf16 v[184:187], a[152:155], a[204:207], v[184:187]
    s_cselect_b32 s65, 0, s65
    s_add_u32 s73, s80, s69
    v_mfma_f32_16x16x32_bf16 v[216:219], a[152:155], a[208:211], v[216:219]
    s_mov_b32 s10, s80
    s_mov_b32 s80, s81
    v_mfma_f32_16x16x32_bf16 v[248:251], a[152:155], a[212:215], v[248:251]
    s_mov_b32 s81, s82
    s_mov_b32 s82, s10
    v_mfma_f32_16x16x32_bf16 v[92:95], a[156:159], a[192:195], v[92:95]
    v_add_u32 v30, s80, v26
    v_add_u32 v31, s80, v27
    v_mfma_f32_16x16x32_bf16 v[124:127], a[156:159], a[196:199], v[124:127]
    v_add_u32 v14, s66, v29
    v_mfma_f32_16x16x32_bf16 v[156:159], a[156:159], a[200:203], v[156:159]
    v_mfma_f32_16x16x32_bf16 v[188:191], a[156:159], a[204:207], v[188:191]
    v_mfma_f32_16x16x32_bf16 v[220:223], a[156:159], a[208:211], v[220:223]
    v_mfma_f32_16x16x32_bf16 v[252:255], a[156:159], a[212:215], v[252:255]
    s_waitcnt vmcnt(11) lgkmcnt(0)
    s_barrier
    v_mfma_f32_16x16x32_bf16 v[64:67], a[96:99], a[160:163], v[64:67]
    s_add_u32 m0, s74, 3072
    ds_read_b128 a[192:195], v14 offset:0
    v_mfma_f32_16x16x32_bf16 v[96:99], a[96:99], a[164:167], v[96:99]
    ds_read_b128 a[196:199], v14 offset:2048
    v_mfma_f32_16x16x32_bf16 v[128:131], a[96:99], a[168:171], v[128:131]
    v_mfma_f32_16x16x32_bf16 v[160:163], a[96:99], a[172:175], v[160:163]
    buffer_load_dwordx4 v7, s[44:47], s64 offen  lds
    s_add_u32 m0, s74, 4096
    v_mfma_f32_16x16x32_bf16 v[192:195], a[96:99], a[176:179], v[192:195]
    ds_read_b128 a[200:203], v14 offset:4096
    ds_read_b128 a[204:207], v14 offset:6144
    v_mfma_f32_16x16x32_bf16 v[224:227], a[96:99], a[180:183], v[224:227]
    v_mfma_f32_16x16x32_bf16 v[68:71], a[100:103], a[160:163], v[68:71]
    ds_read_b128 a[208:211], v14 offset:8192
    v_mfma_f32_16x16x32_bf16 v[100:103], a[100:103], a[164:167], v[100:103]
    buffer_load_dwordx4 v8, s[44:47], s64 offen  lds
    s_add_u32 m0, s74, 5120
    v_mfma_f32_16x16x32_bf16 v[132:135], a[100:103], a[168:171], v[132:135]
    ds_read_b128 a[212:215], v14 offset:10240
    v_mfma_f32_16x16x32_bf16 v[164:167], a[100:103], a[172:175], v[164:167]
    ds_read_b64_tr_b16 a[128:129], v30 offset:0
    v_mfma_f32_16x16x32_bf16 v[196:199], a[100:103], a[176:179], v[196:199]
    ds_read_b64_tr_b16 a[130:131], v30 offset:512
    v_mfma_f32_16x16x32_bf16 v[228:231], a[100:103], a[180:183], v[228:231]
    buffer_load_dwordx4 v9, s[44:47], s64 offen  lds
    s_add_u32 m0, s73, 0
    v_mfma_f32_16x16x32_bf16 v[72:75], a[104:107], a[160:163], v[72:75]
    ds_read_b64_tr_b16 a[132:133], v31 offset:32
    v_mfma_f32_16x16x32_bf16 v[104:107], a[104:107], a[164:167], v[104:107]
    ds_read_b64_tr_b16 a[134:135], v31 offset:544
    v_mfma_f32_16x16x32_bf16 v[136:139], a[104:107], a[168:171], v[136:139]
    v_mfma_f32_16x16x32_bf16 v[168:171], a[104:107], a[172:175], v[168:171]
    buffer_load_dwordx4 v10, s[48:51], s65 offen  lds
    s_add_u32 m0, s73, 2112
    v_mfma_f32_16x16x32_bf16 v[200:203], a[104:107], a[176:179], v[200:203]
    ds_read_b64_tr_b16 a[136:137], v30 offset:64
    v_mfma_f32_16x16x32_bf16 v[232:235], a[104:107], a[180:183], v[232:235]
    ds_read_b64_tr_b16 a[138:139], v30 offset:576
    v_mfma_f32_16x16x32_bf16 v[76:79], a[108:111], a[160:163], v[76:79]
    ds_read_b64_tr_b16 a[140:141], v31 offset:96
    v_mfma_f32_16x16x32_bf16 v[108:111], a[108:111], a[164:167], v[108:111]
    buffer_load_dwordx4 v11, s[48:51], s65 offen  lds
    s_add_u32 m0, s73, 4224
    v_mfma_f32_16x16x32_bf16 v[140:143], a[108:111], a[168:171], v[140:143]
    ds_read_b64_tr_b16 a[142:143], v31 offset:608
    v_mfma_f32_16x16x32_bf16 v[172:175], a[108:111], a[172:175], v[172:175]
    ds_read_b64_tr_b16 a[144:145], v30 offset:128
    v_mfma_f32_16x16x32_bf16 v[204:207], a[108:111], a[176:179], v[204:207]
    buffer_load_dwordx4 v12, s[48:51], s65 offen  lds
    s_add_u32 m0, s73, 6336
    v_mfma_f32_16x16x32_bf16 v[236:239], a[108:111], a[180:183], v[236:239]
    ds_read_b64_tr_b16 a[146:147], v30 offset:640
    v_mfma_f32_16x16x32_bf16 v[80:83], a[112:115], a[160:163], v[80:83]
    ds_read_b64_tr_b16 a[148:149], v31 offset:160
    v_mfma_f32_16x16x32_bf16 v[112:115], a[112:115], a[164:167], v[112:115]
    v_mfma_f32_16x16x32_bf16 v[144:147], a[112:115], a[168:171], v[144:147]
    buffer_load_dwordx4 v13, s[48:51], s65 offen  lds
    s_add_u32 s71, s71, 1024
    s_and_b32 s71, s71, 0x3ffff
    v_mfma_f32_16x16x32_bf16 v[176:179], a[112:115], a[172:175], v[176:179]
    ds_read_b64_tr_b16 a[150:151], v31 offset:672
    ds_read_b64_tr_b16 a[152:153], v30 offset:192
    v_mfma_f32_16x16x32_bf16 v[208:211], a[112:115], a[176:179], v[208:211]
    v_mfma_f32_16x16x32_bf16 v[240:243], a[112:115], a[180:183], v[240:243]
    ds_read_b64_tr_b16 a[154:155], v30 offset:704
    v_mfma_f32_16x16x32_bf16 v[84:87], a[116:119], a[160:163], v[84:87]
    buffer_load_dwordx4 a[72:75], v0, s[52:55], s71 offen nt
    s_add_u32 s71, s71, 1024
    s_and_b32 s71, s71, 0x3ffff
    v_mfma_f32_16x16x32_bf16 v[116:119], a[116:119], a[164:167], v[116:119]
    ds_read_b64_tr_b16 a[156:157], v31 offset:224
    v_mfma_f32_16x16x32_bf16 v[148:151], a[116:119], a[168:171], v[148:151]
    ds_read_b64_tr_b16 a[158:159], v31 offset:736
    v_mfma_f32_16x16x32_bf16 v[180:183], a[116:119], a[172:175], v[180:183]
    v_mfma_f32_16x16x32_bf16 v[212:215], a[116:119], a[176:179], v[212:215]
    buffer_load_dwordx4 a[76:79], v0, s[52:55], s71 offen nt
    v_mfma_f32_16x16x32_bf16 v[244:247], a[116:119], a[180:183], v[244:247]
    v_mfma_f32_16x16x32_bf16 v[88:91], a[120:123], a[160:163], v[88:91]
    v_mfma_f32_16x16x32_bf16 v[120:123], a[120:123], a[164:167], v[120:123]
    v_mfma_f32_16x16x32_bf16 v[152:155], a[120:123], a[168:171], v[152:155]
    s_add_u32 s65, s65, 262144
    s_cmp_eq_u32 s65, 5242880
    v_mfma_f32_16x16x32_bf16 v[184:187], a[120:123], a[172:175], v[184:187]
    s_cselect_b32 s65, 0, s65
    s_add_u32 s73, s80, s69
    v_mfma_f32_16x16x32_bf16 v[216:219], a[120:123], a[176:179], v[216:219]
    s_mov_b32 s10, s80
    s_mov_b32 s80, s81
    v_mfma_f32_16x16x32_bf16 v[248:251], a[120:123], a[180:183], v[248:251]
    s_mov_b32 s81, s82
    s_mov_b32 s82, s10
    v_mfma_f32_16x16x32_bf16 v[92:95], a[124:127], a[160:163], v[92:95]
    v_add_u32 v30, s80, v26
    v_add_u32 v31, s80, v27
    v_mfma_f32_16x16x32_bf16 v[124:127], a[124:127], a[164:167], v[124:127]
    s_add_u32 s64, s64, 128
    s_cmp_eq_u32 s64, 1280
    v_mfma_f32_16x16x32_bf16 v[156:159], a[124:127], a[168:171], v[156:159]
    s_cselect_b32 s64, 0, s64
    s_add_u32 s74, s66, s70
    v_mfma_f32_16x16x32_bf16 v[188:191], a[124:127], a[172:175], v[188:191]
    s_mov_b32 s10, s66
    s_mov_b32 s66, s67
    v_mfma_f32_16x16x32_bf16 v[220:223], a[124:127], a[176:179], v[220:223]
    s_mov_b32 s67, s83
    s_mov_b32 s83, s10
    v_mfma_f32_16x16x32_bf16 v[252:255], a[124:127], a[180:183], v[252:255]
    v_add_u32 v14, s66, v28
    s_waitcnt vmcnt(11) lgkmcnt(0)
    s_barrier
    v_mfma_f32_16x16x32_bf16 v[64:67], a[128:131], a[192:195], v[64:67]
    s_add_u32 m0, s73, 0
    ds_read_b128 a[160:163], v14 offset:0
    v_mfma_f32_16x16x32_bf16 v[96:99], a[128:131], a[196:199], v[96:99]
    ds_read_b128 a[164:167], v14 offset:2048
    v_mfma_f32_16x16x32_bf16 v[128:131], a[128:131], a[200:203], v[128:131]
    v_mfma_f32_16x16x32_bf16 v[160:163], a[128:131], a[204:207], v[160:163]
    ds_read_b128 a[168:171], v14 offset:4096
    v_mfma_f32_16x16x32_bf16 v[192:195], a[128:131], a[208:211], v[192:195]
    ds_read_b128 a[172:175], v14 offset:6144
    v_mfma_f32_16x16x32_bf16 v[224:227], a[128:131], a[212:215], v[224:227]
    buffer_load_dwordx4 v10, s[48:51], s65 offen  lds
    s_add_u32 m0, s73, 2112
    v_mfma_f32_16x16x32_bf16 v[68:71], a[132:135], a[192:195], v[68:71]
    ds_read_b128 a[176:179], v14 offset:8192
    v_mfma_f32_16x16x32_bf16 v[100:103], a[132:135], a[196:199], v[100:103]
    ds_read_b128 a[180:183], v14 offset:10240
    v_mfma_f32_16x16x32_bf16 v[132:135], a[132:135], a[200:203], v[132:135]
    v_mfma_f32_16x16x32_bf16 v[164:167], a[132:135], a[204:207], v[164:167]
    ds_read_b64_tr_b16 a[96:97], v30 offset:0
    v_mfma_f32_16x16x32_bf16 v[196:199], a[132:135], a[208:211], v[196:199]
    buffer_load_dwordx4 v11, s[48:51], s65 offen  lds
    s_add_u32 m0, s73, 4224
    v_mfma_f32_16x16x32_bf16 v[228:231], a[132:135], a[212:215], v[228:231]
    ds_read_b64_tr_b16 a[98:99], v30 offset:512
    v_mfma_f32_16x16x32_bf16 v[72:75], a[136:139], a[192:195], v[72:75]
    ds_read_b64_tr_b16 a[100:101], v31 offset:32
    v_mfma_f32_16x16x32_bf16 v[104:107], a[136:139], a[196:199], v[104:107]
    ds_read_b64_tr_b16 a[102:103], v31 offset:544
    v_mfma_f32_16x16x32_bf16 v[136:139], a[136:139], a[200:203], v[136:139]
    v_mfma_f32_16x16x32_bf16 v[168:171], a[136:139], a[204:207], v[168:171]
    ds_read_b64_tr_b16 a[104:105], v30 offset:64
    v_mfma_f32_16x16x32_bf16 v[200:203], a[136:139], a[208:211], v[200:203]
    buffer_load_dwordx4 v12, s[48:51], s65 offen  lds
    s_add_u32 m0, s73, 6336
    v_mfma_f32_16x16x32_bf16 v[232:235], a[136:139], a[212:215], v[232:235]
    ds_read_b64_tr_b16 a[106:107], v30 offset:576
    v_mfma_f32_16x16x32_bf16 v[76:79], a[140:143], a[192:195], v[76:79]
    ds_read_b64_tr_b16 a[108:109], v31 offset:96
    v_mfma_f32_16x16x32_bf16 v[108:111], a[140:143], a[196:199], v[108:111]
    v_mfma_f32_16x16x32_bf16 v[140:143], a[140:143], a[200:203], v[140:143]
    ds_read_b64_tr_b16 a[110:111], v31 offset:608
    v_mfma_f32_16x16x32_bf16 v[172:175], a[140:143], a[204:207], v[172:175]
    buffer_load_dwordx4 v13, s[48:51], s65 offen  lds
    s_add_u32 s71, s71, 1024
    s_and_b32 s71, s71, 0x3ffff
    v_mfma_f32_16x16x32_bf16 v[204:207], a[140:143], a[208:211], v[204:207]
    ds_read_b64_tr_b16 a[112:113], v30 offset:128
    v_mfma_f32_16x16x32_bf16 v[236:239], a[140:143], a[212:215], v[236:239]
    ds_read_b64_tr_b16 a[114:115], v30 offset:640
    v_mfma_f32_16x16x32_bf16 v[80:83], a[144:147], a[192:195], v[80:83]
    ds_read_b64_tr_b16 a[116:117], v31 offset:160
    v_mfma_f32_16x16x32_bf16 v[112:115], a[144:147], a[196:199], v[112:115]
    v_mfma_f32_16x16x32_bf16 v[144:147], a[144:147], a[200:203], v[144:147]
    ds_read_b64_tr_b16 a[118:119], v31 offset:672
    v_mfma_f32_16x16x32_bf16 v[176:179], a[144:147], a[204:207], v[176:179]
    buffer_load_dwordx4 a[80:83], v0, s[52:55], s71 offen nt
    s_add_u32 s71, s71, 1024
    s_and_b32 s71, s71, 0x3ffff
    v_mfma_f32_16x16x32_bf16 v[208:211], a[144:147], a[208:211], v[208:211]
    ds_read_b64_tr_b16 a[120:121], v30 offset:192
    v_mfma_f32_16x16x32_bf16 v[240:243], a[144:147], a[212:215], v[240:243]
    ds_read_b64_tr_b16 a[122:123], v30 offset:704
    v_mfma_f32_16x16x32_bf16 v[84:87], a[148:151], a[192:195], v[84:87]
    ds_read_b64_tr_b16 a[124:125], v31 offset:224
    v_mfma_f32_16x16x32_bf16 v[116:119], a[148:151], a[196:199], v[116:119]
    v_mfma_f32_16x16x32_bf16 v[148:151], a[148:151], a[200:203], v[148:151]
    buffer_load_dwordx4 a[84:87], v0, s[52:55], s71 offen nt
    ds_read_b64_tr_b16 a[126:127], v31 offset:736
    v_mfma_f32_16x16x32_bf16 v[180:183], a[148:151], a[204:207], v[180:183]
    v_mfma_f32_16x16x32_bf16 v[212:215], a[148:151], a[208:211], v[212:215]
    v_mfma_f32_16x16x32_bf16 v[244:247], a[148:151], a[212:215], v[244:247]
    v_mfma_f32_16x16x32_bf16 v[88:91], a[152:155], a[192:195], v[88:91]
    v_mfma_f32_16x16x32_bf16 v[120:123], a[152:155], a[196:199], v[120:123]
    v_mfma_f32_16x16x32_bf16 v[152:155], a[152:155], a[200:203], v[152:155]
    s_add_u32 s65, s65, 262144
    s_cmp_eq_u32 s65, 5242880
    v_mfma_f32_16x16x32_bf16 v[184:187], a[152:155], a[204:207], v[184:187]
    s_cselect_b32 s65, 0, s65
    s_add_u32 s73, s80, s69
    v_mfma_f32_16x16x32_bf16 v[216:219], a[152:155], a[208:211], v[216:219]
    s_mov_b32 s10, s80
    s_mov_b32 s80, s81
    v_mfma_f32_16x16x32_bf16 v[248:251], a[152:155], a[212:215], v[248:251]
    s_mov_b32 s81, s82
    s_mov_b32 s82, s10
    v_mfma_f32_16x16x32_bf16 v[92:95], a[156:159], a[192:195], v[92:95]
    v_add_u32 v30, s80, v26
    v_add_u32 v31, s80, v27
    v_mfma_f32_16x16x32_bf16 v[124:127], a[156:159], a[196:199], v[124:127]
    v_add_u32 v14, s66, v29
    v_mfma_f32_16x16x32_bf16 v[156:159], a[156:159], a[200:203], v[156:159]
    v_mfma_f32_16x16x32_bf16 v[188:191], a[156:159], a[204:207], v[188:191]
    v_mfma_f32_16x16x32_bf16 v[220:223], a[156:159], a[208:211], v[220:223]
    v_mfma_f32_16x16x32_bf16 v[252:255], a[156:159], a[212:215], v[252:255]
    s_waitcnt vmcnt(8) lgkmcnt(0)
    s_barrier
    v_mfma_f32_16x16x32_bf16 v[64:67], a[96:99], a[160:163], v[64:67]
    s_add_u32 m0, s73, 0
    ds_read_b128 a[192:195], v14 offset:0
    v_mfma_f32_16x16x32_bf16 v[96:99], a[96:99], a[164:167], v[96:99]
    ds_read_b128 a[196:199], v14 offset:2048
    v_mfma_f32_16x16x32_bf16 v[128:131], a[96:99], a[168:171], v[128:131]
    v_mfma_f32_16x16x32_bf16 v[160:163], a[96:99], a[172:175], v[160:163]
    ds_read_b128 a[200:203], v14 offset:4096
    v_mfma_f32_16x16x32_bf16 v[192:195], a[96:99], a[176:179], v[192:195]
    ds_read_b128 a[204:207], v14 offset:6144
    v_mfma_f32_16x16x32_bf16 v[224:227], a[96:99], a[180:183], v[224:227]
    buffer_load_dwordx4 v10, s[48:51], s65 offen  lds
    s_add_u32 m0, s73, 2112
    v_mfma_f32_16x16x32_bf16 v[68:71], a[100:103], a[160:163], v[68:71]
    ds_read_b128 a[208:211], v14 offset:8192
    v_mfma_f32_16x16x32_bf16 v[100:103], a[100:103], a[164:167], v[100:103]
    ds_read_b128 a[212:215], v14 offset:10240
    v_mfma_f32_16x16x32_bf16 v[132:135], a[100:103], a[168:171], v[132:135]
    v_mfma_f32_16x16x32_bf16 v[164:167], a[100:103], a[172:175], v[164:167]
    ds_read_b64_tr_b16 a[128:129], v30 offset:0
    v_mfma_f32_16x16x32_bf16 v[196:199], a[100:103], a[176:179], v[196:199]
    buffer_load_dwordx4 v11, s[48:51], s65 offen  lds
    s_add_u32 m0, s73, 4224
    v_mfma_f32_16x16x32_bf16 v[228:231], a[100:103], a[180:183], v[228:231]
    ds_read_b64_tr_b16 a[130:131], v30 offset:512
    v_mfma_f32_16x16x32_bf16 v[72:75], a[104:107], a[160:163], v[72:75]
    ds_read_b64_tr_b16 a[132:133], v31 offset:32
    v_mfma_f32_16x16x32_bf16 v[104:107], a[104:107], a[164:167], v[104:107]
    ds_read_b64_tr_b16 a[134:135], v31 offset:544
    v_mfma_f32_16x16x32_bf16 v[136:139], a[104:107], a[168:171], v[136:139]
    v_mfma_f32_16x16x32_bf16 v[168:171], a[104:107], a[172:175], v[168:171]
    ds_read_b64_tr_b16 a[136:137], v30 offset:64
    v_mfma_f32_16x16x32_bf16 v[200:203], a[104:107], a[176:179], v[200:203]
    buffer_load_dwordx4 v12, s[48:51], s65 offen  lds
    s_add_u32 m0, s73, 6336
    v_mfma_f32_16x16x32_bf16 v[232:235], a[104:107], a[180:183], v[232:235]
    ds_read_b64_tr_b16 a[138:139], v30 offset:576
    v_mfma_f32_16x16x32_bf16 v[76:79], a[108:111], a[160:163], v[76:79]
    ds_read_b64_tr_b16 a[140:141], v31 offset:96
    v_mfma_f32_16x16x32_bf16 v[108:111], a[108:111], a[164:167], v[108:111]
    v_mfma_f32_16x16x32_bf16 v[140:143], a[108:111], a[168:171], v[140:143]
    ds_read_b64_tr_b16 a[142:143], v31 offset:608
    v_mfma_f32_16x16x32_bf16 v[172:175], a[108:111], a[172:175], v[172:175]
    buffer_load_dwordx4 v13, s[48:51], s65 offen  lds
    s_add_u32 s71, s71, 1024
    s_and_b32 s71, s71, 0x3ffff
    v_mfma_f32_16x16x32_bf16 v[204:207], a[108:111], a[176:179], v[204:207]
    ds_read_b64_tr_b16 a[144:145], v30 offset:128
    v_mfma_f32_16x16x32_bf16 v[236:239], a[108:111], a[180:183], v[236:239]
    ds_read_b64_tr_b16 a[146:147], v30 offset:640
    v_mfma_f32_16x16x32_bf16 v[80:83], a[112:115], a[160:163], v[80:83]
    ds_read_b64_tr_b16 a[148:149], v31 offset:160
    v_mfma_f32_16x16x32_bf16 v[112:115], a[112:115], a[164:167], v[112:115]
    v_mfma_f32_16x16x32_bf16 v[144:147], a[112:115], a[168:171], v[144:147]
    ds_read_b64_tr_b16 a[150:151], v31 offset:672
    v_mfma_f32_16x16x32_bf16 v[176:179], a[112:115], a[172:175], v[176:179]
    buffer_load_dwordx4 a[88:91], v0, s[52:55], s71 offen nt
    s_add_u32 s71, s71, 1024
    s_and_b32 s71, s71, 0x3ffff
    v_mfma_f32_16x16x32_bf16 v[208:211], a[112:115], a[176:179], v[208:211]
    ds_read_b64_tr_b16 a[152:153], v30 offset:192
    v_mfma_f32_16x16x32_bf16 v[240:243], a[112:115], a[180:183], v[240:243]
    ds_read_b64_tr_b16 a[154:155], v30 offset:704
    v_mfma_f32_16x16x32_bf16 v[84:87], a[116:119], a[160:163], v[84:87]
    ds_read_b64_tr_b16 a[156:157], v31 offset:224
    v_mfma_f32_16x16x32_bf16 v[116:119], a[116:119], a[164:167], v[116:119]
    v_mfma_f32_16x16x32_bf16 v[148:151], a[116:119], a[168:171], v[148:151]
    buffer_load_dwordx4 a[92:95], v0, s[52:55], s71 offen nt
    ds_read_b64_tr_b16 a[158:159], v31 offset:736
    v_mfma_f32_16x16x32_bf16 v[180:183], a[116:119], a[172:175], v[180:183]
    v_mfma_f32_16x16x32_bf16 v[212:215], a[116:119], a[176:179], v[212:215]
    v_mfma_f32_16x16x32_bf16 v[244:247], a[116:119], a[180:183], v[244:247]
    v_mfma_f32_16x16x32_bf16 v[88:91], a[120:123], a[160:163], v[88:91]
    v_mfma_f32_16x16x32_bf16 v[120:123], a[120:123], a[164:167], v[120:123]
    v_mfma_f32_16x16x32_bf16 v[152:155], a[120:123], a[168:171], v[152:155]
    s_mov_b32 s10, s80
    s_mov_b32 s80, s81
    v_mfma_f32_16x16x32_bf16 v[184:187], a[120:123], a[172:175], v[184:187]
    s_mov_b32 s81, s82
    s_mov_b32 s82, s10
    v_mfma_f32_16x16x32_bf16 v[216:219], a[120:123], a[176:179], v[216:219]
    v_add_u32 v30, s80, v26
    v_add_u32 v31, s80, v27
    v_mfma_f32_16x16x32_bf16 v[248:251], a[120:123], a[180:183], v[248:251]
    s_mov_b32 s10, s66
    s_mov_b32 s66, s67
    v_mfma_f32_16x16x32_bf16 v[92:95], a[124:127], a[160:163], v[92:95]
    s_mov_b32 s67, s83
    s_mov_b32 s83, s10
    v_mfma_f32_16x16x32_bf16 v[124:127], a[124:127], a[164:167], v[124:127]
    v_add_u32 v14, s66, v28
    s_add_u32 s10, s75, 33664
    v_mfma_f32_16x16x32_bf16 v[156:159], a[124:127], a[168:171], v[156:159]
    v_add_u32 v25, s10, v0
    v_mfma_f32_16x16x32_bf16 v[188:191], a[124:127], a[172:175], v[188:191]
    v_mfma_f32_16x16x32_bf16 v[220:223], a[124:127], a[176:179], v[220:223]
    v_mfma_f32_16x16x32_bf16 v[252:255], a[124:127], a[180:183], v[252:255]
    s_waitcnt vmcnt(8) lgkmcnt(0)
    s_barrier
    v_mfma_f32_16x16x32_bf16 v[64:67], a[128:131], a[192:195], v[64:67]
    ds_read_b128 a[160:163], v14 offset:0
    s_mul_i32 s10, s60, 320
    v_mfma_f32_16x16x32_bf16 v[96:99], a[128:131], a[196:199], v[96:99]
    ds_read_b128 a[164:167], v14 offset:2048
    v_add_u32 v9, s10, v1
    v_mfma_f32_16x16x32_bf16 v[128:131], a[128:131], a[200:203], v[128:131]
    ds_write_b128 v25, a[0:3] offset:0
    v_add_u32 v22, 0, v9
    v_mfma_f32_16x16x32_bf16 v[160:163], a[128:131], a[204:207], v[160:163]
    ds_read_b128 a[168:171], v14 offset:4096
    v_mfma_f32_16x16x32_bf16 v[192:195], a[128:131], a[208:211], v[192:195]
    ds_read_b128 a[172:175], v14 offset:6144
    v_mul_u32_u24 v23, 3277, v22
    v_mfma_f32_16x16x32_bf16 v[224:227], a[128:131], a[212:215], v[224:227]
    ds_write_b128 v25, a[4:7] offset:1056
    v_lshrrev_b32 v23, 16, v23
    v_mfma_f32_16x16x32_bf16 v[68:71], a[132:135], a[192:195], v[68:71]
    ds_read_b128 a[176:179], v14 offset:8192
    v_mfma_f32_16x16x32_bf16 v[100:103], a[132:135], a[196:199], v[100:103]
    ds_read_b128 a[180:183], v14 offset:10240
    v_mul_u32_u24 v24, 20, v23
    v_mfma_f32_16x16x32_bf16 v[132:135], a[132:135], a[200:203], v[132:135]
    ds_write_b128 v25, a[8:11] offset:2112
    v_sub_u32 v24, v22, v24
    v_mfma_f32_16x16x32_bf16 v[164:167], a[132:135], a[204:207], v[164:167]
    ds_read_b64_tr_b16 a[96:97], v30 offset:0
    v_bfe_u32 v22, v23, 2, 1
    v_mfma_f32_16x16x32_bf16 v[196:199], a[132:135], a[208:211], v[196:199]
    ds_read_b64_tr_b16 a[98:99], v30 offset:512
    v_mfma_f32_16x16x32_bf16 v[228:231], a[132:135], a[212:215], v[228:231]
    ds_write_b128 v25, a[12:15] offset:3168
    v_lshlrev_b32 v22, 1, v22
    v_mfma_f32_16x16x32_bf16 v[72:75], a[136:139], a[192:195], v[72:75]
    ds_read_b64_tr_b16 a[100:101], v31 offset:32
    v_xor_b32 v24, v24, v22
    v_mfma_f32_16x16x32_bf16 v[104:107], a[136:139], a[196:199], v[104:107]
    ds_read_b64_tr_b16 a[102:103], v31 offset:544
    v_mfma_f32_16x16x32_bf16 v[136:139], a[136:139], a[200:203], v[136:139]
    ds_write_b128 v25, a[16:19] offset:4224
    v_mul_u32_u24 v23, 1280, v23
    v_mfma_f32_16x16x32_bf16 v[168:171], a[136:139], a[204:207], v[168:171]
    ds_read_b64_tr_b16 a[104:105], v30 offset:64
    v_lshl_add_u32 v4, v24, 4, v23
    v_mfma_f32_16x16x32_bf16 v[200:203], a[136:139], a[208:211], v[200:203]
    v_mfma_f32_16x16x32_bf16 v[232:235], a[136:139], a[212:215], v[232:235]
    ds_write_b128 v25, a[20:23] offset:5280
    v_add_u32 v22, 64, v9
    v_mfma_f32_16x16x32_bf16 v[76:79], a[140:143], a[192:195], v[76:79]
    ds_read_b64_tr_b16 a[106:107], v30 offset:576
    ds_read_b64_tr_b16 a[108:109], v31 offset:96
    v_mfma_f32_16x16x32_bf16 v[108:111], a[140:143], a[196:199], v[108:111]
    v_mul_u32_u24 v23, 3277, v22
    v_lshrrev_b32 v23, 16, v23
    v_mfma_f32_16x16x32_bf16 v[140:143], a[140:143], a[200:203], v[140:143]
    ds_write_b128 v25, a[24:27] offset:6336
    v_mfma_f32_16x16x32_bf16 v[172:175], a[140:143], a[204:207], v[172:175]
    ds_read_b64_tr_b16 a[110:111], v31 offset:608
    ds_read_b64_tr_b16 a[112:113], v30 offset:128
    v_mfma_f32_16x16x32_bf16 v[204:207], a[140:143], a[208:211], v[204:207]
    v_mul_u32_u24 v24, 20, v23
    v_sub_u32 v24, v22, v24
    v_mfma_f32_16x16x32_bf16 v[236:239], a[140:143], a[212:215], v[236:239]
    ds_write_b128 v25, a[28:31] offset:7392
    s_lshl_b32 s11, s5, 2
    s_add_u32 s11, s11, s60
    s_mul_i32 s11, s11, 10240
    v_mul_u32_u24 v17, 160, v1
    v_mfma_f32_16x16x32_bf16 v[80:83], a[144:147], a[192:195], v[80:83]
    ds_read_b64_tr_b16 a[114:115], v30 offset:640
    ds_read_b64_tr_b16 a[116:117], v31 offset:160
    v_mfma_f32_16x16x32_bf16 v[112:115], a[144:147], a[196:199], v[112:115]
    v_bfe_u32 v22, v23, 2, 1
    v_lshlrev_b32 v22, 1, v22
    v_mfma_f32_16x16x32_bf16 v[144:147], a[144:147], a[200:203], v[144:147]
    buffer_load_dword a252, v17, s[92:95], s11 offen
    v_xor_b32 v24, v24, v22
    v_mfma_f32_16x16x32_bf16 v[176:179], a[144:147], a[204:207], v[176:179]
    ds_read_b64_tr_b16 a[118:119], v31 offset:672
    ds_read_b64_tr_b16 a[120:121], v30 offset:192
    v_mfma_f32_16x16x32_bf16 v[208:211], a[144:147], a[208:211], v[208:211]
    v_mul_u32_u24 v23, 1280, v23
    v_mfma_f32_16x16x32_bf16 v[240:243], a[144:147], a[212:215], v[240:243]
    buffer_load_dword a253, v17, s[92:95], s11 offen offset:80
    v_mov_b32 v32, s30
    v_mov_b32 v34, 0
    v_mov_b32 v35, 0
    v_add_u32 v33, 65536, v32
    v_mfma_f32_16x16x32_bf16 v[84:87], a[148:151], a[192:195], v[84:87]
    ds_read_b64_tr_b16 a[122:123], v30 offset:704
    ds_read_b64_tr_b16 a[124:125], v31 offset:224
    v_mfma_f32_16x16x32_bf16 v[116:119], a[148:151], a[196:199], v[116:119]
    v_lshl_add_u32 v5, v24, 4, v23
    v_add_u32 v22, 128, v9
    v_mfma_f32_16x16x32_bf16 v[148:151], a[148:151], a[200:203], v[148:151]
    global_store_dwordx2 v32, v[34:35], s[40:41] sc1
    v_mul_u32_u24 v23, 3277, v22
    v_mfma_f32_16x16x32_bf16 v[180:183], a[148:151], a[204:207], v[180:183]
    ds_read_b64_tr_b16 a[126:127], v31 offset:736
    v_mfma_f32_16x16x32_bf16 v[212:215], a[148:151], a[208:211], v[212:215]
    v_lshrrev_b32 v23, 16, v23
    v_mfma_f32_16x16x32_bf16 v[244:247], a[148:151], a[212:215], v[244:247]
    global_store_dwordx2 v33, v[34:35], s[40:41] sc1
    v_mul_u32_u24 v24, 20, v23
    v_mfma_f32_16x16x32_bf16 v[88:91], a[152:155], a[192:195], v[88:91]
    v_sub_u32 v24, v22, v24
    v_mfma_f32_16x16x32_bf16 v[120:123], a[152:155], a[196:199], v[120:123]
    v_mfma_f32_16x16x32_bf16 v[152:155], a[152:155], a[200:203], v[152:155]
    s_mov_b32 s10, s80
    s_mov_b32 s80, s81
    v_mfma_f32_16x16x32_bf16 v[184:187], a[152:155], a[204:207], v[184:187]
    s_mov_b32 s81, s82
    s_mov_b32 s82, s10
    v_mfma_f32_16x16x32_bf16 v[216:219], a[152:155], a[208:211], v[216:219]
    v_add_u32 v30, s80, v26
    v_add_u32 v31, s80, v27
    v_mfma_f32_16x16x32_bf16 v[248:251], a[152:155], a[212:215], v[248:251]
    v_add_u32 v14, s66, v29
    v_add_u32 v25, 33664, v25
    v_mfma_f32_16x16x32_bf16 v[92:95], a[156:159], a[192:195], v[92:95]
    v_bfe_u32 v22, v23, 2, 1
    v_lshlrev_b32 v22, 1, v22
    v_mfma_f32_16x16x32_bf16 v[124:127], a[156:159], a[196:199], v[124:127]
    v_xor_b32 v24, v24, v22
    v_mul_u32_u24 v23, 1280, v23
    v_mfma_f32_16x16x32_bf16 v[156:159], a[156:159], a[200:203], v[156:159]
    v_mfma_f32_16x16x32_bf16 v[188:191], a[156:159], a[204:207], v[188:191]
    v_mfma_f32_16x16x32_bf16 v[220:223], a[156:159], a[208:211], v[220:223]
    v_mfma_f32_16x16x32_bf16 v[252:255], a[156:159], a[212:215], v[252:255]
    s_waitcnt vmcnt(4) lgkmcnt(0)
    s_barrier
    v_mfma_f32_16x16x32_bf16 v[64:67], a[96:99], a[160:163], v[64:67]
    ds_read_b128 a[192:195], v14 offset:0
    v_lshl_add_u32 v6, v24, 4, v23
    v_mfma_f32_16x16x32_bf16 v[96:99], a[96:99], a[164:167], v[96:99]
    ds_read_b128 a[196:199], v14 offset:2048
    v_add_u32 v22, 192, v9
    v_mfma_f32_16x16x32_bf16 v[128:131], a[96:99], a[168:171], v[128:131]
    v_mul_u32_u24 v23, 3277, v22
    v_mfma_f32_16x16x32_bf16 v[160:163], a[96:99], a[172:175], v[160:163]
    ds_read_b128 a[200:203], v14 offset:4096
    v_mfma_f32_16x16x32_bf16 v[192:195], a[96:99], a[176:179], v[192:195]
    ds_write_b128 v25, a[32:35] offset:0
    v_lshrrev_b32 v23, 16, v23
    v_mfma_f32_16x16x32_bf16 v[224:227], a[96:99], a[180:183], v[224:227]
    ds_read_b128 a[204:207], v14 offset:6144
    v_mul_u32_u24 v24, 20, v23
    v_mfma_f32_16x16x32_bf16 v[68:71], a[100:103], a[160:163], v[68:71]
    ds_read_b128 a[208:211], v14 offset:8192
    v_mfma_f32_16x16x32_bf16 v[100:103], a[100:103], a[164:167], v[100:103]
    ds_read_b128 a[212:215], v14 offset:10240
    v_sub_u32 v24, v22, v24
    v_mfma_f32_16x16x32_bf16 v[132:135], a[100:103], a[168:171], v[132:135]
    ds_write_b128 v25, a[36:39] offset:1056
    v_bfe_u32 v22, v23, 2, 1
    v_mfma_f32_16x16x32_bf16 v[164:167], a[100:103], a[172:175], v[164:167]
    ds_read_b64_tr_b16 a[128:129], v30 offset:0
    v_lshlrev_b32 v22, 1, v22
    v_mfma_f32_16x16x32_bf16 v[196:199], a[100:103], a[176:179], v[196:199]
    ds_read_b64_tr_b16 a[130:131], v30 offset:512
    v_mfma_f32_16x16x32_bf16 v[228:231], a[100:103], a[180:183], v[228:231]
    v_xor_b32 v24, v24, v22
    v_mfma_f32_16x16x32_bf16 v[72:75], a[104:107], a[160:163], v[72:75]
    ds_write_b128 v25, a[40:43] offset:2112
    v_mul_u32_u24 v23, 1280, v23
    v_mfma_f32_16x16x32_bf16 v[104:107], a[104:107], a[164:167], v[104:107]
    ds_read_b64_tr_b16 a[132:133], v31 offset:32
    ds_read_b64_tr_b16 a[134:135], v31 offset:544
    v_mfma_f32_16x16x32_bf16 v[136:139], a[104:107], a[168:171], v[136:139]
    v_lshl_add_u32 v7, v24, 4, v23
    v_mfma_f32_16x16x32_bf16 v[168:171], a[104:107], a[172:175], v[168:171]
    ds_read_b64_tr_b16 a[136:137], v30 offset:64
    v_add_u32 v22, 256, v9
    v_mfma_f32_16x16x32_bf16 v[200:203], a[104:107], a[176:179], v[200:203]
    ds_write_b128 v25, a[44:47] offset:3168
    v_mfma_f32_16x16x32_bf16 v[232:235], a[104:107], a[180:183], v[232:235]
    ds_read_b64_tr_b16 a[138:139], v30 offset:576
    v_mul_u32_u24 v23, 3277, v22
    v_mfma_f32_16x16x32_bf16 v[76:79], a[108:111], a[160:163], v[76:79]
    ds_read_b64_tr_b16 a[140:141], v31 offset:96
    v_lshrrev_b32 v23, 16, v23
    v_mfma_f32_16x16x32_bf16 v[108:111], a[108:111], a[164:167], v[108:111]
    v_mul_u32_u24 v24, 20, v23
    v_mfma_f32_16x16x32_bf16 v[140:143], a[108:111], a[168:171], v[140:143]
    ds_read_b64_tr_b16 a[142:143], v31 offset:608
    v_mfma_f32_16x16x32_bf16 v[172:175], a[108:111], a[172:175], v[172:175]
    ds_write_b128 v25, a[48:51] offset:4224
    v_sub_u32 v24, v22, v24
    v_mfma_f32_16x16x32_bf16 v[204:207], a[108:111], a[176:179], v[204:207]
    ds_read_b64_tr_b16 a[144:145], v30 offset:128
    v_bfe_u32 v22, v23, 2, 1
    v_mfma_f32_16x16x32_bf16 v[236:239], a[108:111], a[180:183], v[236:239]
    ds_read_b64_tr_b16 a[146:147], v30 offset:640
    v_mfma_f32_16x16x32_bf16 v[80:83], a[112:115], a[160:163], v[80:83]
    ds_read_b64_tr_b16 a[148:149], v31 offset:160
    v_lshlrev_b32 v22, 1, v22
    v_mfma_f32_16x16x32_bf16 v[112:115], a[112:115], a[164:167], v[112:115]
    ds_write_b128 v25, a[52:55] offset:5280
    v_xor_b32 v24, v24, v22
    v_mfma_f32_16x16x32_bf16 v[144:147], a[112:115], a[168:171], v[144:147]
    ds_read_b64_tr_b16 a[150:151], v31 offset:672
    v_mul_u32_u24 v23, 1280, v23
    v_mfma_f32_16x16x32_bf16 v[176:179], a[112:115], a[172:175], v[176:179]
    ds_read_b64_tr_b16 a[152:153], v30 offset:192
    v_mfma_f32_16x16x32_bf16 v[208:211], a[112:115], a[176:179], v[208:211]
    v_lshl_add_u32 v8, v24, 4, v23
    v_mfma_f32_16x16x32_bf16 v[240:243], a[112:115], a[180:183], v[240:243]
    ds_write_b128 v25, a[56:59] offset:6336
    v_lshrrev_b32 v22, 2, v1
    v_mfma_f32_16x16x32_bf16 v[84:87], a[116:119], a[160:163], v[84:87]
    ds_read_b64_tr_b16 a[154:155], v30 offset:704
    ds_read_b64_tr_b16 a[156:157], v31 offset:224
    v_mfma_f32_16x16x32_bf16 v[116:119], a[116:119], a[164:167], v[116:119]
    v_mul_u32_u24 v23, 320, v22
    v_mfma_f32_16x16x32_bf16 v[148:151], a[116:119], a[168:171], v[148:151]
    ds_read_b64_tr_b16 a[158:159], v31 offset:736
    v_lshl_add_u32 v23, v20, 3, v23
    v_mfma_f32_16x16x32_bf16 v[180:183], a[116:119], a[172:175], v[180:183]
    ds_write_b128 v25, a[60:63] offset:7392
    v_mfma_f32_16x16x32_bf16 v[212:215], a[116:119], a[176:179], v[212:215]
    v_bfe_u32 v22, v1, 4, 1
    v_mfma_f32_16x16x32_bf16 v[244:247], a[116:119], a[180:183], v[244:247]
    v_lshl_add_u32 v9, v22, 5, v23
    v_mfma_f32_16x16x32_bf16 v[88:91], a[120:123], a[160:163], v[88:91]
    v_xor_b32 v22, 1, v22
    v_mfma_f32_16x16x32_bf16 v[120:123], a[120:123], a[164:167], v[120:123]
    v_mfma_f32_16x16x32_bf16 v[152:155], a[120:123], a[168:171], v[152:155]
    v_add_u32 v25, 33664, v25
    v_lshl_add_u32 v10, v22, 5, v23
    v_mfma_f32_16x16x32_bf16 v[184:187], a[120:123], a[172:175], v[184:187]
    v_add_u32 v11, 131072, v0
    v_mfma_f32_16x16x32_bf16 v[216:219], a[120:123], a[176:179], v[216:219]
    v_mfma_f32_16x16x32_bf16 v[248:251], a[120:123], a[180:183], v[248:251]
    v_add_u32 v12, 262144, v0
    v_mfma_f32_16x16x32_bf16 v[92:95], a[124:127], a[160:163], v[92:95]
    s_mul_i32 s70, s60, 5120
    v_mfma_f32_16x16x32_bf16 v[124:127], a[124:127], a[164:167], v[124:127]
    v_mfma_f32_16x16x32_bf16 v[156:159], a[124:127], a[168:171], v[156:159]
    v_mfma_f32_16x16x32_bf16 v[188:191], a[124:127], a[172:175], v[188:191]
    v_mfma_f32_16x16x32_bf16 v[220:223], a[124:127], a[176:179], v[220:223]
    v_mfma_f32_16x16x32_bf16 v[252:255], a[124:127], a[180:183], v[252:255]
    s_waitcnt lgkmcnt(0)
    s_barrier
    v_mfma_f32_16x16x32_bf16 v[64:67], a[128:131], a[192:195], v[64:67]
    ds_write_b128 v25, a[64:67] offset:0
    ds_write_b128 v25, a[68:71] offset:1056
    v_mfma_f32_16x16x32_bf16 v[68:71], a[132:135], a[192:195], v[68:71]
    ds_write_b128 v25, a[72:75] offset:2112
    ds_write_b128 v25, a[76:79] offset:3168
    v_mfma_f32_16x16x32_bf16 v[72:75], a[136:139], a[192:195], v[72:75]
    ds_write_b128 v25, a[80:83] offset:4224
    ds_write_b128 v25, a[84:87] offset:5280
    v_mfma_f32_16x16x32_bf16 v[76:79], a[140:143], a[192:195], v[76:79]
    ds_write_b128 v25, a[88:91] offset:6336
    ds_write_b128 v25, a[92:95] offset:7392
    v_mfma_f32_16x16x32_bf16 v[80:83], a[144:147], a[192:195], v[80:83]
    ds_read_b128 a[96:99], v2 offset:0
    ds_read_b128 a[100:103], v2 offset:64
    v_mfma_f32_16x16x32_bf16 v[84:87], a[148:151], a[192:195], v[84:87]
    ds_read_b128 a[104:107], v2 offset:128
    ds_read_b128 a[108:111], v2 offset:192
    v_mfma_f32_16x16x32_bf16 v[88:91], a[152:155], a[192:195], v[88:91]
    ds_read_b128 a[112:115], v2 offset:512
    ds_read_b128 a[116:119], v2 offset:576
    v_mfma_f32_16x16x32_bf16 v[92:95], a[156:159], a[192:195], v[92:95]
    ds_read_b128 a[120:123], v2 offset:640
    ds_read_b128 a[124:127], v2 offset:704
    v_mfma_f32_16x16x32_bf16 v[96:99], a[128:131], a[196:199], v[96:99]
    ds_read_b64_tr_b16 a[160:161], v3 offset:0
    ds_read_b64_tr_b16 a[162:163], v3 offset:512
    v_mfma_f32_16x16x32_bf16 v[100:103], a[132:135], a[196:199], v[100:103]
    ds_read_b64_tr_b16 a[164:165], v3 offset:32
    ds_read_b64_tr_b16 a[166:167], v3 offset:544
    v_mfma_f32_16x16x32_bf16 v[104:107], a[136:139], a[196:199], v[104:107]
    ds_read_b64_tr_b16 a[168:169], v3 offset:64
    ds_read_b64_tr_b16 a[170:171], v3 offset:576
    v_mfma_f32_16x16x32_bf16 v[108:111], a[140:143], a[196:199], v[108:111]
    ds_read_b64_tr_b16 a[172:173], v3 offset:96
    ds_read_b64_tr_b16 a[174:175], v3 offset:608
    v_mfma_f32_16x16x32_bf16 v[112:115], a[144:147], a[196:199], v[112:115]
    ds_read_b64_tr_b16 a[176:177], v3 offset:128
    ds_read_b64_tr_b16 a[178:179], v3 offset:640
    v_mfma_f32_16x16x32_bf16 v[116:119], a[148:151], a[196:199], v[116:119]
    ds_read_b64_tr_b16 a[180:181], v3 offset:160
    ds_read_b64_tr_b16 a[182:183], v3 offset:672
    v_mfma_f32_16x16x32_bf16 v[120:123], a[152:155], a[196:199], v[120:123]
    ds_read_b64_tr_b16 a[184:185], v3 offset:192
    ds_read_b64_tr_b16 a[186:187], v3 offset:704
    v_mfma_f32_16x16x32_bf16 v[124:127], a[156:159], a[196:199], v[124:127]
    ds_read_b64_tr_b16 a[188:189], v3 offset:224
    ds_read_b64_tr_b16 a[190:191], v3 offset:736
    s_add_u32 s73, s75, 67328
    s_mov_b32 s72, s75
    s_mov_b32 s74, 67328
    s_mov_b32 s68, 11
    v_mfma_f32_16x16x32_bf16 v[128:131], a[128:131], a[200:203], v[128:131]
    v_pk_mul_f32 v[64:65], v[64:65], s[76:77]
    v_pk_mul_f32 v[66:67], v[66:67], s[76:77]
    v_pk_mul_f32 v[68:69], v[68:69], s[76:77]
    v_pk_mul_f32 v[70:71], v[70:71], s[76:77]
    v_pk_mul_f32 v[72:73], v[72:73], s[76:77]
    v_pk_mul_f32 v[74:75], v[74:75], s[76:77]
    v_pk_mul_f32 v[76:77], v[76:77], s[76:77]
    v_mfma_f32_16x16x32_bf16 v[132:135], a[132:135], a[200:203], v[132:135]
    v_pk_mul_f32 v[78:79], v[78:79], s[76:77]
    v_pk_mul_f32 v[80:81], v[80:81], s[76:77]
    v_pk_mul_f32 v[82:83], v[82:83], s[76:77]
    v_pk_mul_f32 v[84:85], v[84:85], s[76:77]
    v_pk_mul_f32 v[86:87], v[86:87], s[76:77]
    v_pk_mul_f32 v[88:89], v[88:89], s[76:77]
    v_pk_mul_f32 v[90:91], v[90:91], s[76:77]
    v_mfma_f32_16x16x32_bf16 v[136:139], a[136:139], a[200:203], v[136:139]
    v_pk_mul_f32 v[92:93], v[92:93], s[76:77]
    v_pk_mul_f32 v[94:95], v[94:95], s[76:77]
    v_cvt_pk_bf16_f32 v64, v64, v65
    v_cvt_pk_bf16_f32 v65, v66, v67
    v_cvt_pk_bf16_f32 v66, v68, v69
    v_cvt_pk_bf16_f32 v67, v70, v71
    v_cvt_pk_bf16_f32 v72, v72, v73
    v_mfma_f32_16x16x32_bf16 v[140:143], a[140:143], a[200:203], v[140:143]
    v_cvt_pk_bf16_f32 v73, v74, v75
    v_cvt_pk_bf16_f32 v74, v76, v77
    v_cvt_pk_bf16_f32 v75, v78, v79
    v_cvt_pk_bf16_f32 v80, v80, v81
    v_cvt_pk_bf16_f32 v81, v82, v83
    v_cvt_pk_bf16_f32 v82, v84, v85
    v_cvt_pk_bf16_f32 v83, v86, v87
    v_mfma_f32_16x16x32_bf16 v[144:147], a[144:147], a[200:203], v[144:147]
    v_cvt_pk_bf16_f32 v88, v88, v89
    v_cvt_pk_bf16_f32 v89, v90, v91
    v_cvt_pk_bf16_f32 v90, v92, v93
    v_cvt_pk_bf16_f32 v91, v94, v95
    v_permlane16_swap_b32 v64, v66
    v_permlane16_swap_b32 v65, v67
    v_permlane16_swap_b32 v72, v74
    v_mfma_f32_16x16x32_bf16 v[148:151], a[148:151], a[200:203], v[148:151]
    v_permlane16_swap_b32 v73, v75
    v_permlane16_swap_b32 v80, v82
    v_permlane16_swap_b32 v81, v83
    v_permlane16_swap_b32 v88, v90
    v_permlane16_swap_b32 v89, v91
    v_accvgpr_write_b32 a0, v64
    v_accvgpr_write_b32 a1, v65
    v_mfma_f32_16x16x32_bf16 v[152:155], a[152:155], a[200:203], v[152:155]
    v_accvgpr_write_b32 a2, v66
    v_accvgpr_write_b32 a3, v67
    v_accvgpr_write_b32 a4, v72
    v_accvgpr_write_b32 a5, v73
    v_accvgpr_write_b32 a6, v74
    v_accvgpr_write_b32 a7, v75
    v_accvgpr_write_b32 a8, v80
    v_mfma_f32_16x16x32_bf16 v[156:159], a[156:159], a[200:203], v[156:159]
    v_accvgpr_write_b32 a9, v81
    v_accvgpr_write_b32 a10, v82
    v_accvgpr_write_b32 a11, v83
    v_accvgpr_write_b32 a12, v88
    v_accvgpr_write_b32 a13, v89
    v_accvgpr_write_b32 a14, v90
    v_accvgpr_write_b32 a15, v91
    s_waitcnt lgkmcnt(0)
    v_mfma_f32_16x16x32_bf16 v[160:163], a[128:131], a[204:207], v[160:163]
    v_pk_mul_f32 v[96:97], v[96:97], s[76:77]
    v_pk_mul_f32 v[98:99], v[98:99], s[76:77]
    v_pk_mul_f32 v[100:101], v[100:101], s[76:77]
    v_pk_mul_f32 v[102:103], v[102:103], s[76:77]
    v_pk_mul_f32 v[104:105], v[104:105], s[76:77]
    v_mfma_f32_16x16x32_bf16 v[164:167], a[132:135], a[204:207], v[164:167]
    v_pk_mul_f32 v[106:107], v[106:107], s[76:77]
    v_pk_mul_f32 v[108:109], v[108:109], s[76:77]
    v_pk_mul_f32 v[110:111], v[110:111], s[76:77]
    v_pk_mul_f32 v[112:113], v[112:113], s[76:77]
    v_pk_mul_f32 v[114:115], v[114:115], s[76:77]
    v_mfma_f32_16x16x32_bf16 v[168:171], a[136:139], a[204:207], v[168:171]
    v_pk_mul_f32 v[116:117], v[116:117], s[76:77]
    v_pk_mul_f32 v[118:119], v[118:119], s[76:77]
    v_pk_mul_f32 v[120:121], v[120:121], s[76:77]
    v_pk_mul_f32 v[122:123], v[122:123], s[76:77]
    v_mfma_f32_16x16x32_bf16 v[172:175], a[140:143], a[204:207], v[172:175]
    v_pk_mul_f32 v[124:125], v[124:125], s[76:77]
    v_pk_mul_f32 v[126:127], v[126:127], s[76:77]
    v_cvt_pk_bf16_f32 v96, v96, v97
    v_cvt_pk_bf16_f32 v97, v98, v99
    v_cvt_pk_bf16_f32 v98, v100, v101
    v_mfma_f32_16x16x32_bf16 v[176:179], a[144:147], a[204:207], v[176:179]
    v_cvt_pk_bf16_f32 v99, v102, v103
    v_cvt_pk_bf16_f32 v104, v104, v105
    v_cvt_pk_bf16_f32 v105, v106, v107
    v_cvt_pk_bf16_f32 v106, v108, v109
    v_cvt_pk_bf16_f32 v107, v110, v111
    v_mfma_f32_16x16x32_bf16 v[180:183], a[148:151], a[204:207], v[180:183]
    v_cvt_pk_bf16_f32 v112, v112, v113
    v_cvt_pk_bf16_f32 v113, v114, v115
    v_cvt_pk_bf16_f32 v114, v116, v117
    v_cvt_pk_bf16_f32 v115, v118, v119
    v_mfma_f32_16x16x32_bf16 v[184:187], a[152:155], a[204:207], v[184:187]
    v_cvt_pk_bf16_f32 v120, v120, v121
    v_cvt_pk_bf16_f32 v121, v122, v123
    v_cvt_pk_bf16_f32 v122, v124, v125
    v_cvt_pk_bf16_f32 v123, v126, v127
    v_permlane16_swap_b32 v96, v98
    v_mfma_f32_16x16x32_bf16 v[188:191], a[156:159], a[204:207], v[188:191]
    v_permlane16_swap_b32 v97, v99
    v_permlane16_swap_b32 v104, v106
    v_permlane16_swap_b32 v105, v107
    v_permlane16_swap_b32 v112, v114
    v_permlane16_swap_b32 v113, v115
    v_mfma_f32_16x16x32_bf16 v[40:43], a[96:99], a[0:3], 0
    v_permlane16_swap_b32 v120, v122
    v_permlane16_swap_b32 v121, v123
    v_accvgpr_write_b32 a16, v96
    v_accvgpr_write_b32 a17, v97
    v_mfma_f32_16x16x32_bf16 v[40:43], a[100:103], a[4:7], v[40:43]
    v_accvgpr_write_b32 a18, v98
    v_accvgpr_write_b32 a19, v99
    v_accvgpr_write_b32 a20, v104
    v_accvgpr_write_b32 a21, v105
    v_accvgpr_write_b32 a22, v106
    v_mfma_f32_16x16x32_bf16 v[40:43], a[104:107], a[8:11], v[40:43]
    v_accvgpr_write_b32 a23, v107
    v_accvgpr_write_b32 a24, v112
    v_accvgpr_write_b32 a25, v113
    v_accvgpr_write_b32 a26, v114
    v_accvgpr_write_b32 a27, v115
    v_mfma_f32_16x16x32_bf16 v[40:43], a[108:111], a[12:15], v[40:43]
    v_accvgpr_write_b32 a28, v120
    v_accvgpr_write_b32 a29, v121
    v_accvgpr_write_b32 a30, v122
    v_accvgpr_write_b32 a31, v123
    v_mfma_f32_16x16x32_bf16 v[192:195], a[128:131], a[208:211], v[192:195]
    v_pk_mul_f32 v[128:129], v[128:129], s[76:77]
    v_pk_mul_f32 v[130:131], v[130:131], s[76:77]
    v_pk_mul_f32 v[132:133], v[132:133], s[76:77]
    v_pk_mul_f32 v[134:135], v[134:135], s[76:77]
    v_pk_mul_f32 v[136:137], v[136:137], s[76:77]
    v_mfma_f32_16x16x32_bf16 v[196:199], a[132:135], a[208:211], v[196:199]
    v_pk_mul_f32 v[138:139], v[138:139], s[76:77]
    v_pk_mul_f32 v[140:141], v[140:141], s[76:77]
    v_pk_mul_f32 v[142:143], v[142:143], s[76:77]
    v_pk_mul_f32 v[144:145], v[144:145], s[76:77]
    v_pk_mul_f32 v[146:147], v[146:147], s[76:77]
    v_mfma_f32_16x16x32_bf16 v[200:203], a[136:139], a[208:211], v[200:203]
    v_pk_mul_f32 v[148:149], v[148:149], s[76:77]
    v_pk_mul_f32 v[150:151], v[150:151], s[76:77]
    v_pk_mul_f32 v[152:153], v[152:153], s[76:77]
    v_pk_mul_f32 v[154:155], v[154:155], s[76:77]
    v_mfma_f32_16x16x32_bf16 v[204:207], a[140:143], a[208:211], v[204:207]
    v_pk_mul_f32 v[156:157], v[156:157], s[76:77]
    v_pk_mul_f32 v[158:159], v[158:159], s[76:77]
    v_cvt_pk_bf16_f32 v128, v128, v129
    v_cvt_pk_bf16_f32 v129, v130, v131
    v_cvt_pk_bf16_f32 v130, v132, v133
    v_mfma_f32_16x16x32_bf16 v[208:211], a[144:147], a[208:211], v[208:211]
    v_cvt_pk_bf16_f32 v131, v134, v135
    v_cvt_pk_bf16_f32 v136, v136, v137
    v_cvt_pk_bf16_f32 v137, v138, v139
    v_cvt_pk_bf16_f32 v138, v140, v141
    v_cvt_pk_bf16_f32 v139, v142, v143
    v_mfma_f32_16x16x32_bf16 v[212:215], a[148:151], a[208:211], v[212:215]
    v_cvt_pk_bf16_f32 v144, v144, v145
    v_cvt_pk_bf16_f32 v145, v146, v147
    v_cvt_pk_bf16_f32 v146, v148, v149
    v_cvt_pk_bf16_f32 v147, v150, v151
    v_mfma_f32_16x16x32_bf16 v[216:219], a[152:155], a[208:211], v[216:219]
    v_max3_f32 v40, v40, v41, v42
    v_cvt_pk_bf16_f32 v152, v152, v153
    v_cvt_pk_bf16_f32 v153, v154, v155
    v_cvt_pk_bf16_f32 v154, v156, v157
    v_max_f32 v40, v40, v43
    v_cvt_pk_bf16_f32 v155, v158, v159
    v_permlane16_swap_b32 v128, v130
    v_mfma_f32_16x16x32_bf16 v[220:223], a[156:159], a[208:211], v[220:223]
    v_mov_b32 v41, v40
    v_permlane16_swap_b32 v129, v131
    v_permlane16_swap_b32 v136, v138
    v_permlane16_swap_b32 v40, v41
    v_permlane16_swap_b32 v137, v139
    v_permlane16_swap_b32 v144, v146
    v_permlane16_swap_b32 v145, v147
    v_mfma_f32_16x16x32_bf16 v[44:47], a[96:99], a[16:19], 0
    v_max_f32 v40, v40, v41
    v_permlane16_swap_b32 v152, v154
    v_permlane16_swap_b32 v153, v155
    v_mov_b32 v41, v40
    v_accvgpr_write_b32 a32, v128
    v_accvgpr_write_b32 a33, v129
    v_mfma_f32_16x16x32_bf16 v[44:47], a[100:103], a[20:23], v[44:47]
    v_permlane32_swap_b32 v40, v41
    v_accvgpr_write_b32 a34, v130
    v_accvgpr_write_b32 a35, v131
    v_accvgpr_write_b32 a36, v136
    v_max_f32 v40, v40, v41
    v_accvgpr_write_b32 a37, v137
    v_accvgpr_write_b32 a38, v138
    v_mfma_f32_16x16x32_bf16 v[44:47], a[104:107], a[24:27], v[44:47]
    v_sub_f32 v43, 0, v40
    v_accvgpr_write_b32 a39, v139
    v_accvgpr_write_b32 a40, v144
    v_sub_f32 v42, 0, v40
    v_accvgpr_write_b32 a41, v145
    v_accvgpr_write_b32 a42, v146
    v_accvgpr_write_b32 a43, v147
    v_mfma_f32_16x16x32_bf16 v[44:47], a[108:111], a[28:31], v[44:47]
    v_sub_f32 v41, 0, v40
    v_accvgpr_write_b32 a44, v152
    v_accvgpr_write_b32 a45, v153
    v_sub_f32 v40, 0, v40
    v_accvgpr_write_b32 a46, v154
    v_accvgpr_write_b32 a47, v155
    v_mfma_f32_16x16x32_bf16 v[224:227], a[128:131], a[212:215], v[224:227]
    v_pk_mul_f32 v[160:161], v[160:161], s[76:77]
    v_pk_mul_f32 v[162:163], v[162:163], s[76:77]
    v_pk_mul_f32 v[164:165], v[164:165], s[76:77]
    v_pk_mul_f32 v[166:167], v[166:167], s[76:77]
    v_pk_mul_f32 v[168:169], v[168:169], s[76:77]
    v_mfma_f32_16x16x32_bf16 v[228:231], a[132:135], a[212:215], v[228:231]
    v_pk_mul_f32 v[170:171], v[170:171], s[76:77]
    v_pk_mul_f32 v[172:173], v[172:173], s[76:77]
    v_pk_mul_f32 v[174:175], v[174:175], s[76:77]
    v_pk_mul_f32 v[176:177], v[176:177], s[76:77]
    v_pk_mul_f32 v[178:179], v[178:179], s[76:77]
    v_mfma_f32_16x16x32_bf16 v[232:235], a[136:139], a[212:215], v[232:235]
    v_pk_mul_f32 v[180:181], v[180:181], s[76:77]
    v_pk_mul_f32 v[182:183], v[182:183], s[76:77]
    v_pk_mul_f32 v[184:185], v[184:185], s[76:77]
    v_pk_mul_f32 v[186:187], v[186:187], s[76:77]
    v_mfma_f32_16x16x32_bf16 v[236:239], a[140:143], a[212:215], v[236:239]
    v_pk_mul_f32 v[188:189], v[188:189], s[76:77]
    v_pk_mul_f32 v[190:191], v[190:191], s[76:77]
    v_cvt_pk_bf16_f32 v160, v160, v161
    v_cvt_pk_bf16_f32 v161, v162, v163
    v_cvt_pk_bf16_f32 v162, v164, v165
    v_mfma_f32_16x16x32_bf16 v[240:243], a[144:147], a[212:215], v[240:243]
    v_cvt_pk_bf16_f32 v163, v166, v167
    v_cvt_pk_bf16_f32 v168, v168, v169
    v_cvt_pk_bf16_f32 v169, v170, v171
    v_cvt_pk_bf16_f32 v170, v172, v173
    v_cvt_pk_bf16_f32 v171, v174, v175
    v_mfma_f32_16x16x32_bf16 v[244:247], a[148:151], a[212:215], v[244:247]
    v_cvt_pk_bf16_f32 v176, v176, v177
    v_cvt_pk_bf16_f32 v177, v178, v179
    v_cvt_pk_bf16_f32 v178, v180, v181
    v_cvt_pk_bf16_f32 v179, v182, v183
    v_mfma_f32_16x16x32_bf16 v[248:251], a[152:155], a[212:215], v[248:251]
    v_max3_f32 v44, v44, v45, v46
    v_cvt_pk_bf16_f32 v184, v184, v185
    v_cvt_pk_bf16_f32 v185, v186, v187
    v_cvt_pk_bf16_f32 v186, v188, v189
    v_max_f32 v44, v44, v47
    v_cvt_pk_bf16_f32 v187, v190, v191
    v_permlane16_swap_b32 v160, v162
    v_mfma_f32_16x16x32_bf16 v[252:255], a[156:159], a[212:215], v[252:255]
    v_mov_b32 v45, v44
    v_permlane16_swap_b32 v161, v163
    v_permlane16_swap_b32 v168, v170
    v_permlane16_swap_b32 v44, v45
    v_permlane16_swap_b32 v169, v171
    v_permlane16_swap_b32 v176, v178
    v_permlane16_swap_b32 v177, v179
    v_mfma_f32_16x16x32_bf16 v[48:51], a[96:99], a[32:35], 0
    v_max_f32 v44, v44, v45
    v_permlane16_swap_b32 v184, v186
    v_permlane16_swap_b32 v185, v187
    v_mov_b32 v45, v44
    v_accvgpr_write_b32 a48, v160
    v_accvgpr_write_b32 a49, v161
    v_mfma_f32_16x16x32_bf16 v[48:51], a[100:103], a[36:39], v[48:51]
    v_permlane32_swap_b32 v44, v45
    v_accvgpr_write_b32 a50, v162
    v_accvgpr_write_b32 a51, v163
    v_accvgpr_write_b32 a52, v168
    v_max_f32 v44, v44, v45
    v_accvgpr_write_b32 a53, v169
    v_accvgpr_write_b32 a54, v170
    v_mfma_f32_16x16x32_bf16 v[48:51], a[104:107], a[40:43], v[48:51]
    v_sub_f32 v47, 0, v44
    v_accvgpr_write_b32 a55, v171
    v_accvgpr_write_b32 a56, v176
    v_sub_f32 v46, 0, v44
    v_accvgpr_write_b32 a57, v177
    v_accvgpr_write_b32 a58, v178
    v_accvgpr_write_b32 a59, v179
    v_mfma_f32_16x16x32_bf16 v[48:51], a[108:111], a[44:47], v[48:51]
    v_sub_f32 v45, 0, v44
    v_accvgpr_write_b32 a60, v184
    v_accvgpr_write_b32 a61, v185
    v_sub_f32 v44, 0, v44
    v_accvgpr_write_b32 a62, v186
    v_accvgpr_write_b32 a63, v187
    v_mfma_f32_16x16x32_bf16 v[52:55], a[96:99], a[48:51], 0
    v_pk_mul_f32 v[192:193], v[192:193], s[76:77]
    v_pk_mul_f32 v[194:195], v[194:195], s[76:77]
    v_pk_mul_f32 v[196:197], v[196:197], s[76:77]
    v_pk_mul_f32 v[198:199], v[198:199], s[76:77]
    v_pk_mul_f32 v[200:201], v[200:201], s[76:77]
    v_pk_mul_f32 v[202:203], v[202:203], s[76:77]
    v_pk_mul_f32 v[204:205], v[204:205], s[76:77]
    v_mfma_f32_16x16x32_bf16 v[52:55], a[100:103], a[52:55], v[52:55]
    v_pk_mul_f32 v[206:207], v[206:207], s[76:77]
    v_pk_mul_f32 v[208:209], v[208:209], s[76:77]
    v_pk_mul_f32 v[210:211], v[210:211], s[76:77]
    v_pk_mul_f32 v[212:213], v[212:213], s[76:77]
    v_pk_mul_f32 v[214:215], v[214:215], s[76:77]
    v_pk_mul_f32 v[216:217], v[216:217], s[76:77]
    v_pk_mul_f32 v[218:219], v[218:219], s[76:77]
    v_mfma_f32_16x16x32_bf16 v[52:55], a[104:107], a[56:59], v[52:55]
    v_pk_mul_f32 v[220:221], v[220:221], s[76:77]
    v_pk_mul_f32 v[222:223], v[222:223], s[76:77]
    v_cvt_pk_bf16_f32 v192, v192, v193
    v_cvt_pk_bf16_f32 v193, v194, v195
    v_cvt_pk_bf16_f32 v194, v196, v197
    v_cvt_pk_bf16_f32 v195, v198, v199
    v_cvt_pk_bf16_f32 v200, v200, v201
    v_mfma_f32_16x16x32_bf16 v[52:55], a[108:111], a[60:63], v[52:55]
    v_cvt_pk_bf16_f32 v201, v202, v203
    v_cvt_pk_bf16_f32 v202, v204, v205
    v_cvt_pk_bf16_f32 v203, v206, v207
    v_cvt_pk_bf16_f32 v208, v208, v209
    v_cvt_pk_bf16_f32 v209, v210, v211
    v_cvt_pk_bf16_f32 v210, v212, v213
    v_cvt_pk_bf16_f32 v211, v214, v215
    v_max3_f32 v48, v48, v49, v50
    v_cvt_pk_bf16_f32 v216, v216, v217
    v_cvt_pk_bf16_f32 v217, v218, v219
    v_cvt_pk_bf16_f32 v218, v220, v221
    v_max_f32 v48, v48, v51
    v_cvt_pk_bf16_f32 v219, v222, v223
    v_permlane16_swap_b32 v192, v194
    v_mov_b32 v49, v48
    v_permlane16_swap_b32 v193, v195
    v_permlane16_swap_b32 v200, v202
    v_permlane16_swap_b32 v48, v49
    v_permlane16_swap_b32 v201, v203
    v_permlane16_swap_b32 v208, v210
    v_permlane16_swap_b32 v209, v211
    v_max_f32 v48, v48, v49
    v_permlane16_swap_b32 v216, v218
    v_permlane16_swap_b32 v217, v219
    v_mov_b32 v49, v48
    v_accvgpr_write_b32 a64, v192
    v_accvgpr_write_b32 a65, v193
    v_permlane32_swap_b32 v48, v49
    v_accvgpr_write_b32 a66, v194
    v_accvgpr_write_b32 a67, v195
    v_accvgpr_write_b32 a68, v200
    v_max_f32 v48, v48, v49
    v_accvgpr_write_b32 a69, v201
    v_accvgpr_write_b32 a70, v202
    v_sub_f32 v51, 0, v48
    v_accvgpr_write_b32 a71, v203
    v_accvgpr_write_b32 a72, v208
    v_sub_f32 v50, 0, v48
    v_accvgpr_write_b32 a73, v209
    v_accvgpr_write_b32 a74, v210
    v_accvgpr_write_b32 a75, v211
    v_sub_f32 v49, 0, v48
    v_accvgpr_write_b32 a76, v216
    v_accvgpr_write_b32 a77, v217
    v_sub_f32 v48, 0, v48
    v_accvgpr_write_b32 a78, v218
    v_accvgpr_write_b32 a79, v219
    v_mfma_f32_16x16x32_bf16 v[56:59], a[96:99], a[64:67], 0
    v_max3_f32 v52, v52, v53, v54
    v_pk_mul_f32 v[224:225], v[224:225], s[76:77]
    v_pk_mul_f32 v[226:227], v[226:227], s[76:77]
    v_pk_mul_f32 v[228:229], v[228:229], s[76:77]
    v_pk_mul_f32 v[230:231], v[230:231], s[76:77]
    v_pk_mul_f32 v[232:233], v[232:233], s[76:77]
    v_max_f32 v52, v52, v55
    v_pk_mul_f32 v[234:235], v[234:235], s[76:77]
    v_pk_mul_f32 v[236:237], v[236:237], s[76:77]
    v_mfma_f32_16x16x32_bf16 v[56:59], a[100:103], a[68:71], v[56:59]
    v_pk_mul_f32 v[238:239], v[238:239], s[76:77]
    v_pk_mul_f32 v[240:241], v[240:241], s[76:77]
    v_pk_mul_f32 v[242:243], v[242:243], s[76:77]
    v_mov_b32 v53, v52
    v_pk_mul_f32 v[244:245], v[244:245], s[76:77]
    v_pk_mul_f32 v[246:247], v[246:247], s[76:77]
    v_pk_mul_f32 v[248:249], v[248:249], s[76:77]
    v_pk_mul_f32 v[250:251], v[250:251], s[76:77]
    v_mfma_f32_16x16x32_bf16 v[56:59], a[104:107], a[72:75], v[56:59]
    v_permlane16_swap_b32 v52, v53
    v_pk_mul_f32 v[252:253], v[252:253], s[76:77]
    v_pk_mul_f32 v[254:255], v[254:255], s[76:77]
    v_cvt_pk_bf16_f32 v224, v224, v225
    v_cvt_pk_bf16_f32 v225, v226, v227
    v_cvt_pk_bf16_f32 v226, v228, v229
    v_max_f32 v52, v52, v53
    v_cvt_pk_bf16_f32 v227, v230, v231
    v_cvt_pk_bf16_f32 v232, v232, v233
    v_mfma_f32_16x16x32_bf16 v[56:59], a[108:111], a[76:79], v[56:59]
    v_cvt_pk_bf16_f32 v233, v234, v235
    v_cvt_pk_bf16_f32 v234, v236, v237
    v_cvt_pk_bf16_f32 v235, v238, v239
    v_mov_b32 v53, v52
    v_cvt_pk_bf16_f32 v240, v240, v241
    v_cvt_pk_bf16_f32 v241, v242, v243
    v_cvt_pk_bf16_f32 v242, v244, v245
    v_cvt_pk_bf16_f32 v243, v246, v247
    v_permlane32_swap_b32 v52, v53
    v_cvt_pk_bf16_f32 v248, v248, v249
    v_cvt_pk_bf16_f32 v249, v250, v251
    v_cvt_pk_bf16_f32 v250, v252, v253
    v_cvt_pk_bf16_f32 v251, v254, v255
    v_permlane16_swap_b32 v224, v226
    v_max_f32 v52, v52, v53
    v_permlane16_swap_b32 v225, v227
    v_permlane16_swap_b32 v232, v234
    v_permlane16_swap_b32 v233, v235
    v_permlane16_swap_b32 v240, v242
    v_permlane16_swap_b32 v241, v243
    v_sub_f32 v55, 0, v52
    v_permlane16_swap_b32 v248, v250
    v_permlane16_swap_b32 v249, v251
    v_accvgpr_write_b32 a80, v224
    v_accvgpr_write_b32 a81, v225
    v_sub_f32 v54, 0, v52
    v_accvgpr_write_b32 a82, v226
    v_accvgpr_write_b32 a83, v227
    v_accvgpr_write_b32 a84, v232
    v_accvgpr_write_b32 a85, v233
    v_accvgpr_write_b32 a86, v234
    v_sub_f32 v53, 0, v52
    v_accvgpr_write_b32 a87, v235
    v_accvgpr_write_b32 a88, v240
    v_accvgpr_write_b32 a89, v241
    v_accvgpr_write_b32 a90, v242
    v_accvgpr_write_b32 a91, v243
    v_sub_f32 v52, 0, v52
    v_accvgpr_write_b32 a92, v248
    v_accvgpr_write_b32 a93, v249
    v_accvgpr_write_b32 a94, v250
    v_accvgpr_write_b32 a95, v251
    v_mfma_f32_16x16x32_bf16 v[60:63], a[96:99], a[80:83], 0
    v_mfma_f32_16x16x32_bf16 v[60:63], a[100:103], a[84:87], v[60:63]
    v_mfma_f32_16x16x32_bf16 v[60:63], a[104:107], a[88:91], v[60:63]
    v_mfma_f32_16x16x32_bf16 v[60:63], a[108:111], a[92:95], v[60:63]
    v_max3_f32 v56, v56, v57, v58
    v_max_f32 v56, v56, v59
    v_mov_b32 v57, v56
    s_nop 1
    v_permlane16_swap_b32 v56, v57
    v_max_f32 v56, v56, v57
    v_mov_b32 v57, v56
    s_nop 1
    v_permlane32_swap_b32 v56, v57
    v_max_f32 v56, v56, v57
    v_sub_f32 v59, 0, v56
    v_sub_f32 v58, 0, v56
    v_sub_f32 v57, 0, v56
    v_sub_f32 v56, 0, v56
    v_max3_f32 v60, v60, v61, v62
    v_max_f32 v60, v60, v63
    v_mov_b32 v61, v60
    s_nop 1
    v_permlane16_swap_b32 v60, v61
    v_max_f32 v60, v60, v61
    v_mov_b32 v61, v60
    s_nop 1
    v_permlane32_swap_b32 v60, v61
    v_max_f32 v60, v60, v61
    v_sub_f32 v63, 0, v60
    v_sub_f32 v62, 0, v60
    v_sub_f32 v61, 0, v60
    v_sub_f32 v60, 0, v60
L_W0:
    s_barrier
    v_mfma_f32_16x16x32_bf16 v[16:19], a[96:99], a[0:3], v[40:43]
    v_mfma_f32_16x16x32_bf16 v[16:19], a[100:103], a[4:7], v[16:19]
    v_mfma_f32_16x16x32_bf16 v[16:19], a[104:107], a[8:11], v[16:19]
    v_mfma_f32_16x16x32_bf16 v[16:19], a[108:111], a[12:15], v[16:19]
    s_add_u32 s71, s71, 1024
    s_and_b32 s71, s71, 0x3ffff
    v_mfma_f32_16x16x32_bf16 v[20:23], a[112:115], a[0:3], v[40:43]
    v_mfma_f32_16x16x32_bf16 v[20:23], a[116:119], a[4:7], v[20:23]
    v_mfma_f32_16x16x32_bf16 v[20:23], a[120:123], a[8:11], v[20:23]
    v_mfma_f32_16x16x32_bf16 v[20:23], a[124:127], a[12:15], v[20:23]
    ds_read_b128 a[128:131], v2 offset:33664
    ds_read_b128 a[132:135], v2 offset:33728
    s_add_u32 m0, s75, 0
    v_exp_f32 v16, v16
    buffer_load_dwordx4 v0, s[52:55], s71 offen nt lds
    s_add_u32 m0, s75, 1056
    v_exp_f32 v17, v17
    ds_read_b128 a[136:139], v2 offset:33792
    ds_read_b128 a[140:143], v2 offset:33856
    v_exp_f32 v18, v18
    s_add_u32 s71, s71, 1024
    s_and_b32 s71, s71, 0x3ffff
    v_exp_f32 v19, v19
    buffer_load_dwordx4 v0, s[52:55], s71 offen nt lds
    s_add_u32 m0, s75, 2112
    v_mfma_f32_16x16x32_bf16 v[24:27], a[96:99], a[16:19], v[44:47]
    v_exp_f32 v20, v20
    v_mfma_f32_16x16x32_bf16 v[24:27], a[100:103], a[20:23], v[24:27]
    v_cvt_pk_bf16_f32 v32, v16, v17
    v_cvt_pk_bf16_f32 v33, v18, v19
    v_mfma_f32_16x16x32_bf16 v[24:27], a[104:107], a[24:27], v[24:27]
    v_exp_f32 v21, v21
    v_mfma_f32_16x16x32_bf16 v[24:27], a[108:111], a[28:31], v[24:27]
    ds_read_b128 a[144:147], v2 offset:34176
    ds_read_b128 a[148:151], v2 offset:34240
    v_mfma_f32_16x16x32_bf16 v[28:31], a[112:115], a[16:19], v[44:47]
    v_exp_f32 v22, v22
    v_mfma_f32_16x16x32_bf16 v[28:31], a[116:119], a[20:23], v[28:31]
    v_cvt_pk_bf16_f32 v34, v20, v21
    v_mfma_f32_16x16x32_bf16 v[28:31], a[120:123], a[24:27], v[28:31]
    v_exp_f32 v23, v23
    v_mfma_f32_16x16x32_bf16 v[28:31], a[124:127], a[28:31], v[28:31]
    ds_read_b128 a[152:155], v2 offset:34304
    ds_read_b128 a[156:159], v2 offset:34368
    v_cvt_pk_bf16_f32 v35, v22, v23
    v_exp_f32 v24, v24
    s_add_u32 s71, s71, 1024
    s_and_b32 s71, s71, 0x3ffff
    v_exp_f32 v25, v25
    buffer_load_dwordx4 v0, s[52:55], s71 offen nt lds
    v_exp_f32 v26, v26
    v_exp_f32 v27, v27
    v_mfma_f32_16x16x32_bf16 v[16:19], a[96:99], a[32:35], v[48:51]
    v_exp_f32 v28, v28
    v_mfma_f32_16x16x32_bf16 v[16:19], a[100:103], a[36:39], v[16:19]
    v_cvt_pk_bf16_f32 v36, v24, v25
    v_cvt_pk_bf16_f32 v37, v26, v27
    v_mfma_f32_16x16x32_bf16 v[16:19], a[104:107], a[40:43], v[16:19]
    v_exp_f32 v29, v29
    v_mfma_f32_16x16x32_bf16 v[16:19], a[108:111], a[44:47], v[16:19]
    ds_read_b64_tr_b16 a[192:193], v3 offset:33664
    ds_read_b64_tr_b16 a[194:195], v3 offset:34176
    v_mfma_f32_16x16x32_bf16 v[20:23], a[112:115], a[32:35], v[48:51]
    v_exp_f32 v30, v30
    v_mfma_f32_16x16x32_bf16 v[20:23], a[116:119], a[36:39], v[20:23]
    v_cvt_pk_bf16_f32 v38, v28, v29
    v_mfma_f32_16x16x32_bf16 v[20:23], a[120:123], a[40:43], v[20:23]
    v_exp_f32 v31, v31
    v_mfma_f32_16x16x32_bf16 v[20:23], a[124:127], a[44:47], v[20:23]
    ds_read_b64_tr_b16 a[196:197], v3 offset:33696
    ds_read_b64_tr_b16 a[198:199], v3 offset:34208
    v_mfma_f32_16x16x32_bf16 v[64:67], a[160:163], v[32:35], 0
    v_cvt_pk_bf16_f32 v39, v30, v31
    v_mfma_f32_16x16x32_bf16 v[68:71], a[164:167], v[32:35], 0
    v_exp_f32 v16, v16
    v_mfma_f32_16x16x32_bf16 v[72:75], a[168:171], v[32:35], 0
    v_mfma_f32_16x16x32_bf16 v[76:79], a[172:175], v[32:35], 0
    v_exp_f32 v17, v17
    v_mfma_f32_16x16x32_bf16 v[80:83], a[176:179], v[32:35], 0
    v_add_u32 v2, s74, v2
    v_mfma_f32_16x16x32_bf16 v[84:87], a[180:183], v[32:35], 0
    v_exp_f32 v18, v18
    v_mfma_f32_16x16x32_bf16 v[88:91], a[184:187], v[32:35], 0
    v_mfma_f32_16x16x32_bf16 v[92:95], a[188:191], v[32:35], 0
    v_exp_f32 v19, v19
    v_mfma_f32_16x16x32_bf16 a[224:227], a[248:251], v[32:35], 0
    s_add_u32 m0, s75, 3168
    v_mfma_f32_16x16x32_bf16 v[24:27], a[96:99], a[48:51], v[52:55]
    v_exp_f32 v20, v20
    v_mfma_f32_16x16x32_bf16 v[24:27], a[100:103], a[52:55], v[24:27]
    v_cvt_pk_bf16_f32 v32, v16, v17
    v_cvt_pk_bf16_f32 v33, v18, v19
    v_mfma_f32_16x16x32_bf16 v[24:27], a[104:107], a[56:59], v[24:27]
    v_exp_f32 v21, v21
    v_mfma_f32_16x16x32_bf16 v[24:27], a[108:111], a[60:63], v[24:27]
    ds_read_b64_tr_b16 a[200:201], v3 offset:33728
    ds_read_b64_tr_b16 a[202:203], v3 offset:34240
    v_mfma_f32_16x16x32_bf16 v[28:31], a[112:115], a[48:51], v[52:55]
    v_exp_f32 v22, v22
    v_mfma_f32_16x16x32_bf16 v[28:31], a[116:119], a[52:55], v[28:31]
    v_cvt_pk_bf16_f32 v34, v20, v21
    s_add_u32 s71, s71, 1024
    s_and_b32 s71, s71, 0x3ffff
    v_mfma_f32_16x16x32_bf16 v[28:31], a[120:123], a[56:59], v[28:31]
    v_exp_f32 v23, v23
    v_mfma_f32_16x16x32_bf16 v[28:31], a[124:127], a[60:63], v[28:31]
    ds_read_b64_tr_b16 a[204:205], v3 offset:33760
    ds_read_b64_tr_b16 a[206:207], v3 offset:34272
    v_mfma_f32_16x16x32_bf16 v[96:99], a[160:163], v[36:39], 0
    v_cvt_pk_bf16_f32 v35, v22, v23
    v_mfma_f32_16x16x32_bf16 v[100:103], a[164:167], v[36:39], 0
    v_exp_f32 v24, v24
    v_mfma_f32_16x16x32_bf16 v[104:107], a[168:171], v[36:39], 0
    buffer_load_dwordx4 v0, s[52:55], s71 offen nt lds
    s_add_u32 m0, s75, 4224
    v_mfma_f32_16x16x32_bf16 v[108:111], a[172:175], v[36:39], 0
    v_exp_f32 v25, v25
    v_mfma_f32_16x16x32_bf16 v[112:115], a[176:179], v[36:39], 0
    s_add_u32 s71, s71, 1024
    s_and_b32 s71, s71, 0x3ffff
    v_mfma_f32_16x16x32_bf16 v[116:119], a[180:183], v[36:39], 0
    v_exp_f32 v26, v26
    v_mfma_f32_16x16x32_bf16 v[120:123], a[184:187], v[36:39], 0
    v_mfma_f32_16x16x32_bf16 v[124:127], a[188:191], v[36:39], 0
    v_exp_f32 v27, v27
    v_mfma_f32_16x16x32_bf16 a[228:231], a[248:251], v[36:39], 0
    buffer_load_dwordx4 v0, s[52:55], s71 offen nt lds
    s_add_u32 m0, s75, 5280
    v_mfma_f32_16x16x32_bf16 v[16:19], a[96:99], a[64:67], v[56:59]
    v_exp_f32 v28, v28
    v_mfma_f32_16x16x32_bf16 v[16:19], a[100:103], a[68:71], v[16:19]
    v_cvt_pk_bf16_f32 v36, v24, v25
    v_cvt_pk_bf16_f32 v37, v26, v27
    v_mfma_f32_16x16x32_bf16 v[16:19], a[104:107], a[72:75], v[16:19]
    v_exp_f32 v29, v29
    v_mfma_f32_16x16x32_bf16 v[16:19], a[108:111], a[76:79], v[16:19]
    ds_read_b64_tr_b16 a[208:209], v3 offset:33792
    ds_read_b64_tr_b16 a[210:211], v3 offset:34304
    v_mfma_f32_16x16x32_bf16 v[20:23], a[112:115], a[64:67], v[56:59]
    v_exp_f32 v30, v30
    v_mfma_f32_16x16x32_bf16 v[20:23], a[116:119], a[68:71], v[20:23]
    v_cvt_pk_bf16_f32 v38, v28, v29
    v_mfma_f32_16x16x32_bf16 v[20:23], a[120:123], a[72:75], v[20:23]
    v_exp_f32 v31, v31
    v_mfma_f32_16x16x32_bf16 v[20:23], a[124:127], a[76:79], v[20:23]
    ds_read_b64_tr_b16 a[212:213], v3 offset:33824
    ds_read_b64_tr_b16 a[214:215], v3 offset:34336
    v_mfma_f32_16x16x32_bf16 v[128:131], a[160:163], v[32:35], 0
    v_cvt_pk_bf16_f32 v39, v30, v31
    v_mfma_f32_16x16x32_bf16 v[132:135], a[164:167], v[32:35], 0
    v_exp_f32 v16, v16
    v_mfma_f32_16x16x32_bf16 v[136:139], a[168:171], v[32:35], 0
    s_add_u32 s71, s71, 1024
    s_and_b32 s71, s71, 0x3ffff
    v_mfma_f32_16x16x32_bf16 v[140:143], a[172:175], v[32:35], 0
    v_exp_f32 v17, v17
    v_mfma_f32_16x16x32_bf16 v[144:147], a[176:179], v[32:35], 0
    buffer_load_dwordx4 v0, s[52:55], s71 offen nt lds
    v_mfma_f32_16x16x32_bf16 v[148:151], a[180:183], v[32:35], 0
    v_exp_f32 v18, v18
    v_mfma_f32_16x16x32_bf16 v[152:155], a[184:187], v[32:35], 0
    v_mfma_f32_16x16x32_bf16 v[156:159], a[188:191], v[32:35], 0
    v_exp_f32 v19, v19
    v_mfma_f32_16x16x32_bf16 a[232:235], a[248:251], v[32:35], 0
    v_mfma_f32_16x16x32_bf16 v[24:27], a[96:99], a[80:83], v[60:63]
    v_exp_f32 v20, v20
    v_mfma_f32_16x16x32_bf16 v[24:27], a[100:103], a[84:87], v[24:27]
    v_cvt_pk_bf16_f32 v32, v16, v17
    v_cvt_pk_bf16_f32 v33, v18, v19
    v_mfma_f32_16x16x32_bf16 v[24:27], a[104:107], a[88:91], v[24:27]
    v_exp_f32 v21, v21
    v_mfma_f32_16x16x32_bf16 v[24:27], a[108:111], a[92:95], v[24:27]
    ds_read_b64_tr_b16 a[216:217], v3 offset:33856
    ds_read_b64_tr_b16 a[218:219], v3 offset:34368
    v_mfma_f32_16x16x32_bf16 v[28:31], a[112:115], a[80:83], v[60:63]
    v_exp_f32 v22, v22
    v_mfma_f32_16x16x32_bf16 v[28:31], a[116:119], a[84:87], v[28:31]
    v_cvt_pk_bf16_f32 v34, v20, v21
    v_mfma_f32_16x16x32_bf16 v[28:31], a[120:123], a[88:91], v[28:31]
    v_exp_f32 v23, v23
    v_mfma_f32_16x16x32_bf16 v[28:31], a[124:127], a[92:95], v[28:31]
    ds_read_b64_tr_b16 a[220:221], v3 offset:33888
    ds_read_b64_tr_b16 a[222:223], v3 offset:34400
    v_mfma_f32_16x16x32_bf16 v[160:163], a[160:163], v[36:39], 0
    v_cvt_pk_bf16_f32 v35, v22, v23
    v_mfma_f32_16x16x32_bf16 v[164:167], a[164:167], v[36:39], 0
    v_exp_f32 v24, v24
    v_mfma_f32_16x16x32_bf16 v[168:171], a[168:171], v[36:39], 0
    v_mfma_f32_16x16x32_bf16 v[172:175], a[172:175], v[36:39], 0
    v_exp_f32 v25, v25
    v_mfma_f32_16x16x32_bf16 v[176:179], a[176:179], v[36:39], 0
    v_mfma_f32_16x16x32_bf16 v[180:183], a[180:183], v[36:39], 0
    v_exp_f32 v26, v26
    v_mfma_f32_16x16x32_bf16 v[184:187], a[184:187], v[36:39], 0
    v_add_u32 v3, s74, v3
    v_mfma_f32_16x16x32_bf16 v[188:191], a[188:191], v[36:39], 0
    v_exp_f32 v27, v27
    v_mfma_f32_16x16x32_bf16 a[236:239], a[248:251], v[36:39], 0
    s_waitcnt vmcnt(2) lgkmcnt(0)
    s_barrier
    v_mfma_f32_16x16x32_bf16 v[16:19], a[128:131], a[0:3], v[40:43]
    v_exp_f32 v28, v28
    v_mfma_f32_16x16x32_bf16 v[16:19], a[132:135], a[4:7], v[16:19]
    v_cvt_pk_bf16_f32 v36, v24, v25
    v_cvt_pk_bf16_f32 v37, v26, v27
    v_mfma_f32_16x16x32_bf16 v[16:19], a[136:139], a[8:11], v[16:19]
    v_exp_f32 v29, v29
    v_mfma_f32_16x16x32_bf16 v[16:19], a[140:143], a[12:15], v[16:19]
    s_add_u32 s71, s71, 1024
    s_and_b32 s71, s71, 0x3ffff
    v_mfma_f32_16x16x32_bf16 v[20:23], a[144:147], a[0:3], v[40:43]
    v_exp_f32 v30, v30
    v_mfma_f32_16x16x32_bf16 v[20:23], a[148:151], a[4:7], v[20:23]
    v_cvt_pk_bf16_f32 v38, v28, v29
    v_mfma_f32_16x16x32_bf16 v[20:23], a[152:155], a[8:11], v[20:23]
    v_exp_f32 v31, v31
    v_mfma_f32_16x16x32_bf16 v[20:23], a[156:159], a[12:15], v[20:23]
    ds_read_b128 a[96:99], v2 offset:0
    ds_read_b128 a[100:103], v2 offset:64
    v_mfma_f32_16x16x32_bf16 v[192:195], a[160:163], v[32:35], 0
    v_cvt_pk_bf16_f32 v39, v30, v31
    s_add_u32 m0, s75, 6336
    v_mfma_f32_16x16x32_bf16 v[196:199], a[164:167], v[32:35], 0
    v_exp_f32 v16, v16
    v_mfma_f32_16x16x32_bf16 v[200:203], a[168:171], v[32:35], 0
    buffer_load_dwordx4 v0, s[52:55], s71 offen nt lds
    s_add_u32 m0, s75, 7392
    v_mfma_f32_16x16x32_bf16 v[204:207], a[172:175], v[32:35], 0
    v_exp_f32 v17, v17
    v_mfma_f32_16x16x32_bf16 v[208:211], a[176:179], v[32:35], 0
    ds_read_b128 a[104:107], v2 offset:128
    ds_read_b128 a[108:111], v2 offset:192
    v_mfma_f32_16x16x32_bf16 v[212:215], a[180:183], v[32:35], 0
    v_exp_f32 v18, v18
    v_mfma_f32_16x16x32_bf16 v[216:219], a[184:187], v[32:35], 0
    s_add_u32 s71, s71, 1024
    s_and_b32 s71, s71, 0x3ffff
    v_mfma_f32_16x16x32_bf16 v[220:223], a[188:191], v[32:35], 0
    v_exp_f32 v19, v19
    v_mfma_f32_16x16x32_bf16 a[240:243], a[248:251], v[32:35], 0
    buffer_load_dwordx4 v0, s[52:55], s71 offen nt lds
    s_add_u32 m0, s75, 33664
    v_mfma_f32_16x16x32_bf16 v[24:27], a[128:131], a[16:19], v[44:47]
    v_exp_f32 v20, v20
    v_mfma_f32_16x16x32_bf16 v[24:27], a[132:135], a[20:23], v[24:27]
    v_cvt_pk_bf16_f32 v32, v16, v17
    v_cvt_pk_bf16_f32 v33, v18, v19
    v_mfma_f32_16x16x32_bf16 v[24:27], a[136:139], a[24:27], v[24:27]
    v_exp_f32 v21, v21
    v_mfma_f32_16x16x32_bf16 v[24:27], a[140:143], a[28:31], v[24:27]
    ds_read_b128 a[112:115], v2 offset:512
    ds_read_b128 a[116:119], v2 offset:576
    v_mfma_f32_16x16x32_bf16 v[28:31], a[144:147], a[16:19], v[44:47]
    v_exp_f32 v22, v22
    v_mfma_f32_16x16x32_bf16 v[28:31], a[148:151], a[20:23], v[28:31]
    v_cvt_pk_bf16_f32 v34, v20, v21
    v_mfma_f32_16x16x32_bf16 v[28:31], a[152:155], a[24:27], v[28:31]
    v_exp_f32 v23, v23
    v_mfma_f32_16x16x32_bf16 v[28:31], a[156:159], a[28:31], v[28:31]
    ds_read_b128 a[120:123], v2 offset:640
    ds_read_b128 a[124:127], v2 offset:704
    v_mfma_f32_16x16x32_bf16 v[224:227], a[160:163], v[36:39], 0
    v_cvt_pk_bf16_f32 v35, v22, v23
    v_mfma_f32_16x16x32_bf16 v[228:231], a[164:167], v[36:39], 0
    v_exp_f32 v24, v24
    v_mfma_f32_16x16x32_bf16 v[232:235], a[168:171], v[36:39], 0
    s_add_u32 s71, s71, 1024
    s_and_b32 s71, s71, 0x3ffff
    v_mfma_f32_16x16x32_bf16 v[236:239], a[172:175], v[36:39], 0
    v_exp_f32 v25, v25
    v_mfma_f32_16x16x32_bf16 v[240:243], a[176:179], v[36:39], 0
    buffer_load_dwordx4 v0, s[52:55], s71 offen nt lds
    v_mfma_f32_16x16x32_bf16 v[244:247], a[180:183], v[36:39], 0
    v_exp_f32 v26, v26
    v_mfma_f32_16x16x32_bf16 v[248:251], a[184:187], v[36:39], 0
    v_mfma_f32_16x16x32_bf16 v[252:255], a[188:191], v[36:39], 0
    v_exp_f32 v27, v27
    v_mfma_f32_16x16x32_bf16 a[244:247], a[248:251], v[36:39], 0
    v_mfma_f32_16x16x32_bf16 v[16:19], a[128:131], a[32:35], v[48:51]
    v_exp_f32 v28, v28
    v_mfma_f32_16x16x32_bf16 v[16:19], a[132:135], a[36:39], v[16:19]
    v_cvt_pk_bf16_f32 v36, v24, v25
    v_cvt_pk_bf16_f32 v37, v26, v27
    v_mfma_f32_16x16x32_bf16 v[16:19], a[136:139], a[40:43], v[16:19]
    v_exp_f32 v29, v29
    v_mfma_f32_16x16x32_bf16 v[16:19], a[140:143], a[44:47], v[16:19]
    ds_read_b64_tr_b16 a[160:161], v3 offset:0
    ds_read_b64_tr_b16 a[162:163], v3 offset:512
    v_mfma_f32_16x16x32_bf16 v[20:23], a[144:147], a[32:35], v[48:51]
    v_exp_f32 v30, v30
    v_mfma_f32_16x16x32_bf16 v[20:23], a[148:151], a[36:39], v[20:23]
    v_cvt_pk_bf16_f32 v38, v28, v29
    v_mfma_f32_16x16x32_bf16 v[20:23], a[152:155], a[40:43], v[20:23]
    v_exp_f32 v31, v31
    v_mfma_f32_16x16x32_bf16 v[20:23], a[156:159], a[44:47], v[20:23]
    ds_read_b64_tr_b16 a[164:165], v3 offset:32
    ds_read_b64_tr_b16 a[166:167], v3 offset:544
    v_mfma_f32_16x16x32_bf16 v[64:67], a[192:195], v[32:35], v[64:67]
    v_cvt_pk_bf16_f32 v39, v30, v31
    v_mfma_f32_16x16x32_bf16 v[68:71], a[196:199], v[32:35], v[68:71]
    v_exp_f32 v16, v16
    v_mfma_f32_16x16x32_bf16 v[72:75], a[200:203], v[32:35], v[72:75]
    v_mfma_f32_16x16x32_bf16 v[76:79], a[204:207], v[32:35], v[76:79]
    v_exp_f32 v17, v17
    v_mfma_f32_16x16x32_bf16 v[80:83], a[208:211], v[32:35], v[80:83]
    v_mfma_f32_16x16x32_bf16 v[84:87], a[212:215], v[32:35], v[84:87]
    v_exp_f32 v18, v18
    v_mfma_f32_16x16x32_bf16 v[88:91], a[216:219], v[32:35], v[88:91]
    v_mfma_f32_16x16x32_bf16 v[92:95], a[220:223], v[32:35], v[92:95]
    v_exp_f32 v19, v19
    v_mfma_f32_16x16x32_bf16 a[224:227], a[248:251], v[32:35], a[224:227]
    s_add_u32 m0, s75, 34720
    v_mfma_f32_16x16x32_bf16 v[24:27], a[128:131], a[48:51], v[52:55]
    v_exp_f32 v20, v20
    v_mfma_f32_16x16x32_bf16 v[24:27], a[132:135], a[52:55], v[24:27]
    v_cvt_pk_bf16_f32 v32, v16, v17
    v_cvt_pk_bf16_f32 v33, v18, v19
    v_mfma_f32_16x16x32_bf16 v[24:27], a[136:139], a[56:59], v[24:27]
    v_exp_f32 v21, v21
    v_mfma_f32_16x16x32_bf16 v[24:27], a[140:143], a[60:63], v[24:27]
    ds_read_b64_tr_b16 a[168:169], v3 offset:64
    ds_read_b64_tr_b16 a[170:171], v3 offset:576
    v_mfma_f32_16x16x32_bf16 v[28:31], a[144:147], a[48:51], v[52:55]
    v_exp_f32 v22, v22
    v_mfma_f32_16x16x32_bf16 v[28:31], a[148:151], a[52:55], v[28:31]
    v_cvt_pk_bf16_f32 v34, v20, v21
    s_add_u32 s71, s71, 1024
    s_and_b32 s71, s71, 0x3ffff
    v_mfma_f32_16x16x32_bf16 v[28:31], a[152:155], a[56:59], v[28:31]
    v_exp_f32 v23, v23
    v_mfma_f32_16x16x32_bf16 v[28:31], a[156:159], a[60:63], v[28:31]
    ds_read_b64_tr_b16 a[172:173], v3 offset:96
    ds_read_b64_tr_b16 a[174:175], v3 offset:608
    v_mfma_f32_16x16x32_bf16 v[96:99], a[192:195], v[36:39], v[96:99]
    v_cvt_pk_bf16_f32 v35, v22, v23
    v_mfma_f32_16x16x32_bf16 v[100:103], a[196:199], v[36:39], v[100:103]
    v_exp_f32 v24, v24
    v_mfma_f32_16x16x32_bf16 v[104:107], a[200:203], v[36:39], v[104:107]
    buffer_load_dwordx4 v0, s[52:55], s71 offen nt lds
    s_add_u32 m0, s75, 35776
    v_mfma_f32_16x16x32_bf16 v[108:111], a[204:207], v[36:39], v[108:111]
    v_exp_f32 v25, v25
    v_mfma_f32_16x16x32_bf16 v[112:115], a[208:211], v[36:39], v[112:115]
    s_add_u32 s71, s71, 1024
    s_and_b32 s71, s71, 0x3ffff
    v_mfma_f32_16x16x32_bf16 v[116:119], a[212:215], v[36:39], v[116:119]
    v_exp_f32 v26, v26
    v_mfma_f32_16x16x32_bf16 v[120:123], a[216:219], v[36:39], v[120:123]
    v_mfma_f32_16x16x32_bf16 v[124:127], a[220:223], v[36:39], v[124:127]
    v_exp_f32 v27, v27
    v_mfma_f32_16x16x32_bf16 a[228:231], a[248:251], v[36:39], a[228:231]
    buffer_load_dwordx4 v0, s[52:55], s71 offen nt lds
    s_add_u32 m0, s75, 36832
    v_mfma_f32_16x16x32_bf16 v[16:19], a[128:131], a[64:67], v[56:59]
    v_exp_f32 v28, v28
    v_mfma_f32_16x16x32_bf16 v[16:19], a[132:135], a[68:71], v[16:19]
    v_cvt_pk_bf16_f32 v36, v24, v25
    v_cvt_pk_bf16_f32 v37, v26, v27
    v_mfma_f32_16x16x32_bf16 v[16:19], a[136:139], a[72:75], v[16:19]
    v_exp_f32 v29, v29
    v_mfma_f32_16x16x32_bf16 v[16:19], a[140:143], a[76:79], v[16:19]
    ds_read_b64_tr_b16 a[176:177], v3 offset:128
    ds_read_b64_tr_b16 a[178:179], v3 offset:640
    v_mfma_f32_16x16x32_bf16 v[20:23], a[144:147], a[64:67], v[56:59]
    v_exp_f32 v30, v30
    v_mfma_f32_16x16x32_bf16 v[20:23], a[148:151], a[68:71], v[20:23]
    v_cvt_pk_bf16_f32 v38, v28, v29
    v_mfma_f32_16x16x32_bf16 v[20:23], a[152:155], a[72:75], v[20:23]
    v_exp_f32 v31, v31
    v_mfma_f32_16x16x32_bf16 v[20:23], a[156:159], a[76:79], v[20:23]
    ds_read_b64_tr_b16 a[180:181], v3 offset:160
    ds_read_b64_tr_b16 a[182:183], v3 offset:672
    v_mfma_f32_16x16x32_bf16 v[128:131], a[192:195], v[32:35], v[128:131]
    v_cvt_pk_bf16_f32 v39, v30, v31
    v_mfma_f32_16x16x32_bf16 v[132:135], a[196:199], v[32:35], v[132:135]
    v_exp_f32 v16, v16
    v_mfma_f32_16x16x32_bf16 v[136:139], a[200:203], v[32:35], v[136:139]
    s_add_u32 s71, s71, 1024
    s_and_b32 s71, s71, 0x3ffff
    v_mfma_f32_16x16x32_bf16 v[140:143], a[204:207], v[32:35], v[140:143]
    v_exp_f32 v17, v17
    v_mfma_f32_16x16x32_bf16 v[144:147], a[208:211], v[32:35], v[144:147]
    buffer_load_dwordx4 v0, s[52:55], s71 offen nt lds
    v_mfma_f32_16x16x32_bf16 v[148:151], a[212:215], v[32:35], v[148:151]
    v_exp_f32 v18, v18
    v_mfma_f32_16x16x32_bf16 v[152:155], a[216:219], v[32:35], v[152:155]
    v_mfma_f32_16x16x32_bf16 v[156:159], a[220:223], v[32:35], v[156:159]
    v_exp_f32 v19, v19
    v_mfma_f32_16x16x32_bf16 a[232:235], a[248:251], v[32:35], a[232:235]
    v_mfma_f32_16x16x32_bf16 v[24:27], a[128:131], a[80:83], v[60:63]
    v_exp_f32 v20, v20
    v_mfma_f32_16x16x32_bf16 v[24:27], a[132:135], a[84:87], v[24:27]
    v_cvt_pk_bf16_f32 v32, v16, v17
    v_cvt_pk_bf16_f32 v33, v18, v19
    v_mfma_f32_16x16x32_bf16 v[24:27], a[136:139], a[88:91], v[24:27]
    v_exp_f32 v21, v21
    v_mfma_f32_16x16x32_bf16 v[24:27], a[140:143], a[92:95], v[24:27]
    ds_read_b64_tr_b16 a[184:185], v3 offset:192
    ds_read_b64_tr_b16 a[186:187], v3 offset:704
    v_mfma_f32_16x16x32_bf16 v[28:31], a[144:147], a[80:83], v[60:63]
    v_exp_f32 v22, v22
    v_mfma_f32_16x16x32_bf16 v[28:31], a[148:151], a[84:87], v[28:31]
    v_cvt_pk_bf16_f32 v34, v20, v21
    v_mfma_f32_16x16x32_bf16 v[28:31], a[152:155], a[88:91], v[28:31]
    v_exp_f32 v23, v23
    v_mfma_f32_16x16x32_bf16 v[28:31], a[156:159], a[92:95], v[28:31]
    ds_read_b64_tr_b16 a[188:189], v3 offset:224
    ds_read_b64_tr_b16 a[190:191], v3 offset:736
    v_mfma_f32_16x16x32_bf16 v[160:163], a[192:195], v[36:39], v[160:163]
    v_cvt_pk_bf16_f32 v35, v22, v23
    v_mfma_f32_16x16x32_bf16 v[164:167], a[196:199], v[36:39], v[164:167]
    v_exp_f32 v24, v24
    v_mfma_f32_16x16x32_bf16 v[168:171], a[200:203], v[36:39], v[168:171]
    v_mfma_f32_16x16x32_bf16 v[172:175], a[204:207], v[36:39], v[172:175]
    v_exp_f32 v25, v25
    v_mfma_f32_16x16x32_bf16 v[176:179], a[208:211], v[36:39], v[176:179]
    v_mfma_f32_16x16x32_bf16 v[180:183], a[212:215], v[36:39], v[180:183]
    v_exp_f32 v26, v26
    v_mfma_f32_16x16x32_bf16 v[184:187], a[216:219], v[36:39], v[184:187]
    s_sub_u32 s74, 0, s74
    v_mfma_f32_16x16x32_bf16 v[188:191], a[220:223], v[36:39], v[188:191]
    v_exp_f32 v27, v27
    v_mfma_f32_16x16x32_bf16 a[236:239], a[248:251], v[36:39], a[236:239]
    s_waitcnt vmcnt(2) lgkmcnt(0)
L_LOOP:
    s_barrier
    v_mfma_f32_16x16x32_bf16 v[16:19], a[96:99], a[0:3], v[40:43]
    v_exp_f32 v28, v28
    v_mfma_f32_16x16x32_bf16 v[16:19], a[100:103], a[4:7], v[16:19]
    v_cvt_pk_bf16_f32 v36, v24, v25
    v_cvt_pk_bf16_f32 v37, v26, v27
    v_mfma_f32_16x16x32_bf16 v[16:19], a[104:107], a[8:11], v[16:19]
    v_exp_f32 v29, v29
    v_mfma_f32_16x16x32_bf16 v[16:19], a[108:111], a[12:15], v[16:19]
    s_add_u32 s71, s71, 1024
    s_and_b32 s71, s71, 0x3ffff
    v_mfma_f32_16x16x32_bf16 v[20:23], a[112:115], a[0:3], v[40:43]
    v_exp_f32 v30, v30
    v_mfma_f32_16x16x32_bf16 v[20:23], a[116:119], a[4:7], v[20:23]
    v_cvt_pk_bf16_f32 v38, v28, v29
    v_mfma_f32_16x16x32_bf16 v[20:23], a[120:123], a[8:11], v[20:23]
    v_exp_f32 v31, v31
    v_mfma_f32_16x16x32_bf16 v[20:23], a[124:127], a[12:15], v[20:23]
    ds_read_b128 a[128:131], v2 offset:33664
    ds_read_b128 a[132:135], v2 offset:33728
    v_mfma_f32_16x16x32_bf16 v[192:195], a[192:195], v[32:35], v[192:195]
    v_cvt_pk_bf16_f32 v39, v30, v31
    s_add_u32 m0, s72, 37888
    v_mfma_f32_16x16x32_bf16 v[196:199], a[196:199], v[32:35], v[196:199]
    v_exp_f32 v16, v16
    v_mfma_f32_16x16x32_bf16 v[200:203], a[200:203], v[32:35], v[200:203]
    buffer_load_dwordx4 v0, s[52:55], s71 offen nt lds
    s_add_u32 m0, s72, 38944
    v_mfma_f32_16x16x32_bf16 v[204:207], a[204:207], v[32:35], v[204:207]
    v_exp_f32 v17, v17
    v_mfma_f32_16x16x32_bf16 v[208:211], a[208:211], v[32:35], v[208:211]
    ds_read_b128 a[136:139], v2 offset:33792
    ds_read_b128 a[140:143], v2 offset:33856
    v_mfma_f32_16x16x32_bf16 v[212:215], a[212:215], v[32:35], v[212:215]
    v_exp_f32 v18, v18
    v_mfma_f32_16x16x32_bf16 v[216:219], a[216:219], v[32:35], v[216:219]
    s_add_u32 s71, s71, 1024
    s_and_b32 s71, s71, 0x3ffff
    v_mfma_f32_16x16x32_bf16 v[220:223], a[220:223], v[32:35], v[220:223]
    v_exp_f32 v19, v19
    v_mfma_f32_16x16x32_bf16 a[240:243], a[248:251], v[32:35], a[240:243]
    buffer_load_dwordx4 v0, s[52:55], s71 offen nt lds
    s_add_u32 m0, s72, 40000
    v_mfma_f32_16x16x32_bf16 v[24:27], a[96:99], a[16:19], v[44:47]
    v_exp_f32 v20, v20
    v_mfma_f32_16x16x32_bf16 v[24:27], a[100:103], a[20:23], v[24:27]
    v_cvt_pk_bf16_f32 v32, v16, v17
    v_cvt_pk_bf16_f32 v33, v18, v19
    v_mfma_f32_16x16x32_bf16 v[24:27], a[104:107], a[24:27], v[24:27]
    v_exp_f32 v21, v21
    v_mfma_f32_16x16x32_bf16 v[24:27], a[108:111], a[28:31], v[24:27]
    ds_read_b128 a[144:147], v2 offset:34176
    ds_read_b128 a[148:151], v2 offset:34240
    v_mfma_f32_16x16x32_bf16 v[28:31], a[112:115], a[16:19], v[44:47]
    v_exp_f32 v22, v22
    v_mfma_f32_16x16x32_bf16 v[28:31], a[116:119], a[20:23], v[28:31]
    v_cvt_pk_bf16_f32 v34, v20, v21
    v_mfma_f32_16x16x32_bf16 v[28:31], a[120:123], a[24:27], v[28:31]
    v_exp_f32 v23, v23
    v_mfma_f32_16x16x32_bf16 v[28:31], a[124:127], a[28:31], v[28:31]
    ds_read_b128 a[152:155], v2 offset:34304
    ds_read_b128 a[156:159], v2 offset:34368
    v_mfma_f32_16x16x32_bf16 v[224:227], a[192:195], v[36:39], v[224:227]
    v_cvt_pk_bf16_f32 v35, v22, v23
    v_mfma_f32_16x16x32_bf16 v[228:231], a[196:199], v[36:39], v[228:231]
    v_exp_f32 v24, v24
    v_mfma_f32_16x16x32_bf16 v[232:235], a[200:203], v[36:39], v[232:235]
    s_add_u32 s71, s71, 1024
    s_and_b32 s71, s71, 0x3ffff
    v_mfma_f32_16x16x32_bf16 v[236:239], a[204:207], v[36:39], v[236:239]
    v_exp_f32 v25, v25
    v_mfma_f32_16x16x32_bf16 v[240:243], a[208:211], v[36:39], v[240:243]
    buffer_load_dwordx4 v0, s[52:55], s71 offen nt lds
    s_add_u32 m0, s72, 41056
    v_mfma_f32_16x16x32_bf16 v[244:247], a[212:215], v[36:39], v[244:247]
    v_exp_f32 v26, v26
    v_mfma_f32_16x16x32_bf16 v[248:251], a[216:219], v[36:39], v[248:251]
    s_add_u32 s71, s71, 1024
    s_and_b32 s71, s71, 0x3ffff
    v_mfma_f32_16x16x32_bf16 v[252:255], a[220:223], v[36:39], v[252:255]
    v_exp_f32 v27, v27
    v_mfma_f32_16x16x32_bf16 a[244:247], a[248:251], v[36:39], a[244:247]
    s_lshr_b32 s43, s43, 1
    v_mfma_f32_16x16x32_bf16 v[16:19], a[96:99], a[32:35], v[48:51]
    v_exp_f32 v28, v28
    v_mfma_f32_16x16x32_bf16 v[16:19], a[100:103], a[36:39], v[16:19]
    v_cvt_pk_bf16_f32 v36, v24, v25
    v_cvt_pk_bf16_f32 v37, v26, v27
    v_mfma_f32_16x16x32_bf16 v[16:19], a[104:107], a[40:43], v[16:19]
    v_exp_f32 v29, v29
    v_mfma_f32_16x16x32_bf16 v[16:19], a[108:111], a[44:47], v[16:19]
    ds_read_b64_tr_b16 a[192:193], v3 offset:33664
    ds_read_b64_tr_b16 a[194:195], v3 offset:34176
    v_mfma_f32_16x16x32_bf16 v[20:23], a[112:115], a[32:35], v[48:51]
    v_exp_f32 v30, v30
    v_mfma_f32_16x16x32_bf16 v[20:23], a[116:119], a[36:39], v[20:23]
    v_cvt_pk_bf16_f32 v38, v28, v29
    v_mfma_f32_16x16x32_bf16 v[20:23], a[120:123], a[40:43], v[20:23]
    v_exp_f32 v31, v31
    v_mfma_f32_16x16x32_bf16 v[20:23], a[124:127], a[44:47], v[20:23]
    ds_read_b64_tr_b16 a[196:197], v3 offset:33696
    ds_read_b64_tr_b16 a[198:199], v3 offset:34208
    v_mfma_f32_16x16x32_bf16 v[64:67], a[160:163], v[32:35], v[64:67]
    v_cvt_pk_bf16_f32 v39, v30, v31
    v_mfma_f32_16x16x32_bf16 v[68:71], a[164:167], v[32:35], v[68:71]
    v_exp_f32 v16, v16
    v_mfma_f32_16x16x32_bf16 v[72:75], a[168:171], v[32:35], v[72:75]
    v_mfma_f32_16x16x32_bf16 v[76:79], a[172:175], v[32:35], v[76:79]
    v_exp_f32 v17, v17
    v_mfma_f32_16x16x32_bf16 v[80:83], a[176:179], v[32:35], v[80:83]
    v_add_u32 v2, s74, v2
    v_mfma_f32_16x16x32_bf16 v[84:87], a[180:183], v[32:35], v[84:87]
    v_exp_f32 v18, v18
    v_mfma_f32_16x16x32_bf16 v[88:91], a[184:187], v[32:35], v[88:91]
    v_mfma_f32_16x16x32_bf16 v[92:95], a[188:191], v[32:35], v[92:95]
    v_exp_f32 v19, v19
    v_mfma_f32_16x16x32_bf16 a[224:227], a[248:251], v[32:35], a[224:227]
    buffer_load_dwordx4 v0, s[52:55], s71 offen nt lds
    s_add_u32 m0, s73, 0
    v_mfma_f32_16x16x32_bf16 v[24:27], a[96:99], a[48:51], v[52:55]
    v_exp_f32 v20, v20
    v_mfma_f32_16x16x32_bf16 v[24:27], a[100:103], a[52:55], v[24:27]
    v_cvt_pk_bf16_f32 v32, v16, v17
    v_cvt_pk_bf16_f32 v33, v18, v19
    v_mfma_f32_16x16x32_bf16 v[24:27], a[104:107], a[56:59], v[24:27]
    v_exp_f32 v21, v21
    v_mfma_f32_16x16x32_bf16 v[24:27], a[108:111], a[60:63], v[24:27]
    ds_read_b64_tr_b16 a[200:201], v3 offset:33728
    ds_read_b64_tr_b16 a[202:203], v3 offset:34240
    v_mfma_f32_16x16x32_bf16 v[28:31], a[112:115], a[48:51], v[52:55]
    v_exp_f32 v22, v22
    v_mfma_f32_16x16x32_bf16 v[28:31], a[116:119], a[52:55], v[28:31]
    v_cvt_pk_bf16_f32 v34, v20, v21
    s_add_u32 s71, s71, 1024
    s_and_b32 s71, s71, 0x3ffff
    v_mfma_f32_16x16x32_bf16 v[28:31], a[120:123], a[56:59], v[28:31]
    v_exp_f32 v23, v23
    v_mfma_f32_16x16x32_bf16 v[28:31], a[124:127], a[60:63], v[28:31]
    ds_read_b64_tr_b16 a[204:205], v3 offset:33760
    ds_read_b64_tr_b16 a[206:207], v3 offset:34272
    v_mfma_f32_16x16x32_bf16 v[96:99], a[160:163], v[36:39], v[96:99]
    v_cvt_pk_bf16_f32 v35, v22, v23
    v_mfma_f32_16x16x32_bf16 v[100:103], a[164:167], v[36:39], v[100:103]
    v_exp_f32 v24, v24
    v_mfma_f32_16x16x32_bf16 v[104:107], a[168:171], v[36:39], v[104:107]
    buffer_load_dwordx4 v0, s[52:55], s71 offen nt lds
    s_add_u32 m0, s73, 1056
    v_mfma_f32_16x16x32_bf16 v[108:111], a[172:175], v[36:39], v[108:111]
    v_exp_f32 v25, v25
    v_mfma_f32_16x16x32_bf16 v[112:115], a[176:179], v[36:39], v[112:115]
    s_add_u32 s71, s71, 1024
    s_and_b32 s71, s71, 0x3ffff
    v_mfma_f32_16x16x32_bf16 v[116:119], a[180:183], v[36:39], v[116:119]
    v_exp_f32 v26, v26
    v_mfma_f32_16x16x32_bf16 v[120:123], a[184:187], v[36:39], v[120:123]
    v_mfma_f32_16x16x32_bf16 v[124:127], a[188:191], v[36:39], v[124:127]
    v_exp_f32 v27, v27
    v_mfma_f32_16x16x32_bf16 a[228:231], a[248:251], v[36:39], a[228:231]
    buffer_load_dwordx4 v0, s[52:55], s71 offen nt lds
    s_add_u32 m0, s73, 2112
    v_mfma_f32_16x16x32_bf16 v[16:19], a[96:99], a[64:67], v[56:59]
    v_exp_f32 v28, v28
    v_mfma_f32_16x16x32_bf16 v[16:19], a[100:103], a[68:71], v[16:19]
    v_cvt_pk_bf16_f32 v36, v24, v25
    v_cvt_pk_bf16_f32 v37, v26, v27
    v_mfma_f32_16x16x32_bf16 v[16:19], a[104:107], a[72:75], v[16:19]
    v_exp_f32 v29, v29
    v_mfma_f32_16x16x32_bf16 v[16:19], a[108:111], a[76:79], v[16:19]
    ds_read_b64_tr_b16 a[208:209], v3 offset:33792
    ds_read_b64_tr_b16 a[210:211], v3 offset:34304
    v_mfma_f32_16x16x32_bf16 v[20:23], a[112:115], a[64:67], v[56:59]
    v_exp_f32 v30, v30
    v_mfma_f32_16x16x32_bf16 v[20:23], a[116:119], a[68:71], v[20:23]
    v_cvt_pk_bf16_f32 v38, v28, v29
    v_mfma_f32_16x16x32_bf16 v[20:23], a[120:123], a[72:75], v[20:23]
    v_exp_f32 v31, v31
    v_mfma_f32_16x16x32_bf16 v[20:23], a[124:127], a[76:79], v[20:23]
    ds_read_b64_tr_b16 a[212:213], v3 offset:33824
    ds_read_b64_tr_b16 a[214:215], v3 offset:34336
    v_mfma_f32_16x16x32_bf16 v[128:131], a[160:163], v[32:35], v[128:131]
    v_cvt_pk_bf16_f32 v39, v30, v31
    v_mfma_f32_16x16x32_bf16 v[132:135], a[164:167], v[32:35], v[132:135]
    v_exp_f32 v16, v16
    v_mfma_f32_16x16x32_bf16 v[136:139], a[168:171], v[32:35], v[136:139]
    s_add_u32 s71, s71, 1024
    s_and_b32 s71, s71, 0x3ffff
    v_mfma_f32_16x16x32_bf16 v[140:143], a[172:175], v[32:35], v[140:143]
    v_exp_f32 v17, v17
    v_mfma_f32_16x16x32_bf16 v[144:147], a[176:179], v[32:35], v[144:147]
    buffer_load_dwordx4 v0, s[52:55], s71 offen nt lds
    s_add_u32 m0, s73, 3168
    v_mfma_f32_16x16x32_bf16 v[148:151], a[180:183], v[32:35], v[148:151]
    v_exp_f32 v18, v18
    v_mfma_f32_16x16x32_bf16 v[152:155], a[184:187], v[32:35], v[152:155]
    s_add_u32 s71, s71, 1024
    s_and_b32 s71, s71, 0x3ffff
    v_mfma_f32_16x16x32_bf16 v[156:159], a[188:191], v[32:35], v[156:159]
    v_exp_f32 v19, v19
    v_mfma_f32_16x16x32_bf16 a[232:235], a[248:251], v[32:35], a[232:235]
    v_mfma_f32_16x16x32_bf16 v[24:27], a[96:99], a[80:83], v[60:63]
    v_exp_f32 v20, v20
    v_mfma_f32_16x16x32_bf16 v[24:27], a[100:103], a[84:87], v[24:27]
    v_cvt_pk_bf16_f32 v32, v16, v17
    v_cvt_pk_bf16_f32 v33, v18, v19
    v_mfma_f32_16x16x32_bf16 v[24:27], a[104:107], a[88:91], v[24:27]
    v_exp_f32 v21, v21
    v_mfma_f32_16x16x32_bf16 v[24:27], a[108:111], a[92:95], v[24:27]
    ds_read_b64_tr_b16 a[216:217], v3 offset:33856
    ds_read_b64_tr_b16 a[218:219], v3 offset:34368
    v_mfma_f32_16x16x32_bf16 v[28:31], a[112:115], a[80:83], v[60:63]
    v_exp_f32 v22, v22
    v_mfma_f32_16x16x32_bf16 v[28:31], a[116:119], a[84:87], v[28:31]
    v_cvt_pk_bf16_f32 v34, v20, v21
    v_mfma_f32_16x16x32_bf16 v[28:31], a[120:123], a[88:91], v[28:31]
    v_exp_f32 v23, v23
    v_mfma_f32_16x16x32_bf16 v[28:31], a[124:127], a[92:95], v[28:31]
    ds_read_b64_tr_b16 a[220:221], v3 offset:33888
    ds_read_b64_tr_b16 a[222:223], v3 offset:34400
    v_mfma_f32_16x16x32_bf16 v[160:163], a[160:163], v[36:39], v[160:163]
    v_cvt_pk_bf16_f32 v35, v22, v23
    v_mfma_f32_16x16x32_bf16 v[164:167], a[164:167], v[36:39], v[164:167]
    v_exp_f32 v24, v24
    v_mfma_f32_16x16x32_bf16 v[168:171], a[168:171], v[36:39], v[168:171]
    buffer_load_dwordx4 v0, s[52:55], s71 offen nt lds
    v_mfma_f32_16x16x32_bf16 v[172:175], a[172:175], v[36:39], v[172:175]
    v_exp_f32 v25, v25
    v_mfma_f32_16x16x32_bf16 v[176:179], a[176:179], v[36:39], v[176:179]
    v_mfma_f32_16x16x32_bf16 v[180:183], a[180:183], v[36:39], v[180:183]
    v_exp_f32 v26, v26
    v_mfma_f32_16x16x32_bf16 v[184:187], a[184:187], v[36:39], v[184:187]
    v_add_u32 v3, s74, v3
    v_mfma_f32_16x16x32_bf16 v[188:191], a[188:191], v[36:39], v[188:191]
    v_exp_f32 v27, v27
    v_mfma_f32_16x16x32_bf16 a[236:239], a[248:251], v[36:39], a[236:239]
    s_bitcmp0_b32 s43, 0
    s_waitcnt vmcnt(4) lgkmcnt(0)
    s_cbranch_scc1 L_LX0
    s_waitcnt vmcnt(2)
L_LX0:
    s_barrier
    v_mfma_f32_16x16x32_bf16 v[16:19], a[128:131], a[0:3], v[40:43]
    v_exp_f32 v28, v28
    v_mfma_f32_16x16x32_bf16 v[16:19], a[132:135], a[4:7], v[16:19]
    v_cvt_pk_bf16_f32 v36, v24, v25
    v_cvt_pk_bf16_f32 v37, v26, v27
    v_mfma_f32_16x16x32_bf16 v[16:19], a[136:139], a[8:11], v[16:19]
    v_exp_f32 v29, v29
    v_mfma_f32_16x16x32_bf16 v[16:19], a[140:143], a[12:15], v[16:19]
    s_add_u32 s71, s71, 1024
    s_and_b32 s71, s71, 0x3ffff
    v_mfma_f32_16x16x32_bf16 v[20:23], a[144:147], a[0:3], v[40:43]
    v_exp_f32 v30, v30
    v_mfma_f32_16x16x32_bf16 v[20:23], a[148:151], a[4:7], v[20:23]
    v_cvt_pk_bf16_f32 v38, v28, v29
    v_mfma_f32_16x16x32_bf16 v[20:23], a[152:155], a[8:11], v[20:23]
    v_exp_f32 v31, v31
    v_mfma_f32_16x16x32_bf16 v[20:23], a[156:159], a[12:15], v[20:23]
    ds_read_b128 a[96:99], v2 offset:0
    ds_read_b128 a[100:103], v2 offset:64
    v_mfma_f32_16x16x32_bf16 v[192:195], a[160:163], v[32:35], v[192:195]
    v_cvt_pk_bf16_f32 v39, v30, v31
    s_add_u32 m0, s73, 4224
    v_mfma_f32_16x16x32_bf16 v[196:199], a[164:167], v[32:35], v[196:199]
    v_exp_f32 v16, v16
    v_mfma_f32_16x16x32_bf16 v[200:203], a[168:171], v[32:35], v[200:203]
    buffer_load_dwordx4 v0, s[52:55], s71 offen nt lds
    s_add_u32 m0, s73, 5280
    v_mfma_f32_16x16x32_bf16 v[204:207], a[172:175], v[32:35], v[204:207]
    v_exp_f32 v17, v17
    v_mfma_f32_16x16x32_bf16 v[208:211], a[176:179], v[32:35], v[208:211]
    ds_read_b128 a[104:107], v2 offset:128
    ds_read_b128 a[108:111], v2 offset:192
    v_mfma_f32_16x16x32_bf16 v[212:215], a[180:183], v[32:35], v[212:215]
    v_exp_f32 v18, v18
    v_mfma_f32_16x16x32_bf16 v[216:219], a[184:187], v[32:35], v[216:219]
    s_add_u32 s71, s71, 1024
    s_and_b32 s71, s71, 0x3ffff
    v_mfma_f32_16x16x32_bf16 v[220:223], a[188:191], v[32:35], v[220:223]
    v_exp_f32 v19, v19
    v_mfma_f32_16x16x32_bf16 a[240:243], a[248:251], v[32:35], a[240:243]
    buffer_load_dwordx4 v0, s[52:55], s71 offen nt lds
    s_add_u32 m0, s73, 6336
    v_mfma_f32_16x16x32_bf16 v[24:27], a[128:131], a[16:19], v[44:47]
    v_exp_f32 v20, v20
    v_mfma_f32_16x16x32_bf16 v[24:27], a[132:135], a[20:23], v[24:27]
    v_cvt_pk_bf16_f32 v32, v16, v17
    v_cvt_pk_bf16_f32 v33, v18, v19
    v_mfma_f32_16x16x32_bf16 v[24:27], a[136:139], a[24:27], v[24:27]
    v_exp_f32 v21, v21
    v_mfma_f32_16x16x32_bf16 v[24:27], a[140:143], a[28:31], v[24:27]
    ds_read_b128 a[112:115], v2 offset:512
    ds_read_b128 a[116:119], v2 offset:576
    v_mfma_f32_16x16x32_bf16 v[28:31], a[144:147], a[16:19], v[44:47]
    v_exp_f32 v22, v22
    v_mfma_f32_16x16x32_bf16 v[28:31], a[148:151], a[20:23], v[28:31]
    v_cvt_pk_bf16_f32 v34, v20, v21
    v_mfma_f32_16x16x32_bf16 v[28:31], a[152:155], a[24:27], v[28:31]
    v_exp_f32 v23, v23
    v_mfma_f32_16x16x32_bf16 v[28:31], a[156:159], a[28:31], v[28:31]
    ds_read_b128 a[120:123], v2 offset:640
    ds_read_b128 a[124:127], v2 offset:704
    v_mfma_f32_16x16x32_bf16 v[224:227], a[160:163], v[36:39], v[224:227]
    v_cvt_pk_bf16_f32 v35, v22, v23
    v_mfma_f32_16x16x32_bf16 v[228:231], a[164:167], v[36:39], v[228:231]
    v_exp_f32 v24, v24
    v_mfma_f32_16x16x32_bf16 v[232:235], a[168:171], v[36:39], v[232:235]
    s_add_u32 s71, s71, 1024
    s_and_b32 s71, s71, 0x3ffff
    v_mfma_f32_16x16x32_bf16 v[236:239], a[172:175], v[36:39], v[236:239]
    v_exp_f32 v25, v25
    v_mfma_f32_16x16x32_bf16 v[240:243], a[176:179], v[36:39], v[240:243]
    buffer_load_dwordx4 v0, s[52:55], s71 offen nt lds
    s_add_u32 m0, s73, 7392
    v_mfma_f32_16x16x32_bf16 v[244:247], a[180:183], v[36:39], v[244:247]
    v_exp_f32 v26, v26
    v_mfma_f32_16x16x32_bf16 v[248:251], a[184:187], v[36:39], v[248:251]
    s_add_u32 s71, s71, 1024
    s_and_b32 s71, s71, 0x3ffff
    v_mfma_f32_16x16x32_bf16 v[252:255], a[188:191], v[36:39], v[252:255]
    v_exp_f32 v27, v27
    v_mfma_f32_16x16x32_bf16 a[244:247], a[248:251], v[36:39], a[244:247]
    s_lshr_b32 s43, s43, 1
    v_mfma_f32_16x16x32_bf16 v[16:19], a[128:131], a[32:35], v[48:51]
    v_exp_f32 v28, v28
    v_mfma_f32_16x16x32_bf16 v[16:19], a[132:135], a[36:39], v[16:19]
    v_cvt_pk_bf16_f32 v36, v24, v25
    v_cvt_pk_bf16_f32 v37, v26, v27
    v_mfma_f32_16x16x32_bf16 v[16:19], a[136:139], a[40:43], v[16:19]
    v_exp_f32 v29, v29
    v_mfma_f32_16x16x32_bf16 v[16:19], a[140:143], a[44:47], v[16:19]
    ds_read_b64_tr_b16 a[160:161], v3 offset:0
    ds_read_b64_tr_b16 a[162:163], v3 offset:512
    v_mfma_f32_16x16x32_bf16 v[20:23], a[144:147], a[32:35], v[48:51]
    v_exp_f32 v30, v30
    v_mfma_f32_16x16x32_bf16 v[20:23], a[148:151], a[36:39], v[20:23]
    v_cvt_pk_bf16_f32 v38, v28, v29
    v_mfma_f32_16x16x32_bf16 v[20:23], a[152:155], a[40:43], v[20:23]
    v_exp_f32 v31, v31
    v_mfma_f32_16x16x32_bf16 v[20:23], a[156:159], a[44:47], v[20:23]
    ds_read_b64_tr_b16 a[164:165], v3 offset:32
    ds_read_b64_tr_b16 a[166:167], v3 offset:544
    v_mfma_f32_16x16x32_bf16 v[64:67], a[192:195], v[32:35], v[64:67]
    v_cvt_pk_bf16_f32 v39, v30, v31
    v_mfma_f32_16x16x32_bf16 v[68:71], a[196:199], v[32:35], v[68:71]
    v_exp_f32 v16, v16
    v_mfma_f32_16x16x32_bf16 v[72:75], a[200:203], v[32:35], v[72:75]
    v_mfma_f32_16x16x32_bf16 v[76:79], a[204:207], v[32:35], v[76:79]
    v_exp_f32 v17, v17
    v_mfma_f32_16x16x32_bf16 v[80:83], a[208:211], v[32:35], v[80:83]
    v_mfma_f32_16x16x32_bf16 v[84:87], a[212:215], v[32:35], v[84:87]
    v_exp_f32 v18, v18
    v_mfma_f32_16x16x32_bf16 v[88:91], a[216:219], v[32:35], v[88:91]
    v_mfma_f32_16x16x32_bf16 v[92:95], a[220:223], v[32:35], v[92:95]
    v_exp_f32 v19, v19
    v_mfma_f32_16x16x32_bf16 a[224:227], a[248:251], v[32:35], a[224:227]
    buffer_load_dwordx4 v0, s[52:55], s71 offen nt lds
    s_add_u32 m0, s73, 33664
    v_mfma_f32_16x16x32_bf16 v[24:27], a[128:131], a[48:51], v[52:55]
    v_exp_f32 v20, v20
    v_mfma_f32_16x16x32_bf16 v[24:27], a[132:135], a[52:55], v[24:27]
    v_cvt_pk_bf16_f32 v32, v16, v17
    v_cvt_pk_bf16_f32 v33, v18, v19
    v_mfma_f32_16x16x32_bf16 v[24:27], a[136:139], a[56:59], v[24:27]
    v_exp_f32 v21, v21
    v_mfma_f32_16x16x32_bf16 v[24:27], a[140:143], a[60:63], v[24:27]
    ds_read_b64_tr_b16 a[168:169], v3 offset:64
    ds_read_b64_tr_b16 a[170:171], v3 offset:576
    v_mfma_f32_16x16x32_bf16 v[28:31], a[144:147], a[48:51], v[52:55]
    v_exp_f32 v22, v22
    v_mfma_f32_16x16x32_bf16 v[28:31], a[148:151], a[52:55], v[28:31]
    v_cvt_pk_bf16_f32 v34, v20, v21
    s_add_u32 s71, s71, 1024
    s_and_b32 s71, s71, 0x3ffff
    v_mfma_f32_16x16x32_bf16 v[28:31], a[152:155], a[56:59], v[28:31]
    v_exp_f32 v23, v23
    v_mfma_f32_16x16x32_bf16 v[28:31], a[156:159], a[60:63], v[28:31]
    ds_read_b64_tr_b16 a[172:173], v3 offset:96
    ds_read_b64_tr_b16 a[174:175], v3 offset:608
    v_mfma_f32_16x16x32_bf16 v[96:99], a[192:195], v[36:39], v[96:99]
    v_cvt_pk_bf16_f32 v35, v22, v23
    v_mfma_f32_16x16x32_bf16 v[100:103], a[196:199], v[36:39], v[100:103]
    v_exp_f32 v24, v24
    v_mfma_f32_16x16x32_bf16 v[104:107], a[200:203], v[36:39], v[104:107]
    buffer_load_dwordx4 v0, s[52:55], s71 offen nt lds
    s_add_u32 m0, s73, 34720
    v_mfma_f32_16x16x32_bf16 v[108:111], a[204:207], v[36:39], v[108:111]
    v_exp_f32 v25, v25
    v_mfma_f32_16x16x32_bf16 v[112:115], a[208:211], v[36:39], v[112:115]
    s_add_u32 s71, s71, 1024
    s_and_b32 s71, s71, 0x3ffff
    v_mfma_f32_16x16x32_bf16 v[116:119], a[212:215], v[36:39], v[116:119]
    v_exp_f32 v26, v26
    v_mfma_f32_16x16x32_bf16 v[120:123], a[216:219], v[36:39], v[120:123]
    v_mfma_f32_16x16x32_bf16 v[124:127], a[220:223], v[36:39], v[124:127]
    v_exp_f32 v27, v27
    v_mfma_f32_16x16x32_bf16 a[228:231], a[248:251], v[36:39], a[228:231]
    buffer_load_dwordx4 v0, s[52:55], s71 offen nt lds
    s_add_u32 m0, s73, 35776
    v_mfma_f32_16x16x32_bf16 v[16:19], a[128:131], a[64:67], v[56:59]
    v_exp_f32 v28, v28
    v_mfma_f32_16x16x32_bf16 v[16:19], a[132:135], a[68:71], v[16:19]
    v_cvt_pk_bf16_f32 v36, v24, v25
    v_cvt_pk_bf16_f32 v37, v26, v27
    v_mfma_f32_16x16x32_bf16 v[16:19], a[136:139], a[72:75], v[16:19]
    v_exp_f32 v29, v29
    v_mfma_f32_16x16x32_bf16 v[16:19], a[140:143], a[76:79], v[16:19]
    ds_read_b64_tr_b16 a[176:177], v3 offset:128
    ds_read_b64_tr_b16 a[178:179], v3 offset:640
    v_mfma_f32_16x16x32_bf16 v[20:23], a[144:147], a[64:67], v[56:59]
    v_exp_f32 v30, v30
    v_mfma_f32_16x16x32_bf16 v[20:23], a[148:151], a[68:71], v[20:23]
    v_cvt_pk_bf16_f32 v38, v28, v29
    v_mfma_f32_16x16x32_bf16 v[20:23], a[152:155], a[72:75], v[20:23]
    v_exp_f32 v31, v31
    v_mfma_f32_16x16x32_bf16 v[20:23], a[156:159], a[76:79], v[20:23]
    ds_read_b64_tr_b16 a[180:181], v3 offset:160
    ds_read_b64_tr_b16 a[182:183], v3 offset:672
    v_mfma_f32_16x16x32_bf16 v[128:131], a[192:195], v[32:35], v[128:131]
    v_cvt_pk_bf16_f32 v39, v30, v31
    v_mfma_f32_16x16x32_bf16 v[132:135], a[196:199], v[32:35], v[132:135]
    v_exp_f32 v16, v16
    v_mfma_f32_16x16x32_bf16 v[136:139], a[200:203], v[32:35], v[136:139]
    s_add_u32 s71, s71, 1024
    s_and_b32 s71, s71, 0x3ffff
    v_mfma_f32_16x16x32_bf16 v[140:143], a[204:207], v[32:35], v[140:143]
    v_exp_f32 v17, v17
    v_mfma_f32_16x16x32_bf16 v[144:147], a[208:211], v[32:35], v[144:147]
    buffer_load_dwordx4 v0, s[52:55], s71 offen nt lds
    s_add_u32 m0, s73, 36832
    v_mfma_f32_16x16x32_bf16 v[148:151], a[212:215], v[32:35], v[148:151]
    v_exp_f32 v18, v18
    v_mfma_f32_16x16x32_bf16 v[152:155], a[216:219], v[32:35], v[152:155]
    s_add_u32 s71, s71, 1024
    s_and_b32 s71, s71, 0x3ffff
    v_mfma_f32_16x16x32_bf16 v[156:159], a[220:223], v[32:35], v[156:159]
    v_exp_f32 v19, v19
    v_mfma_f32_16x16x32_bf16 a[232:235], a[248:251], v[32:35], a[232:235]
    v_mfma_f32_16x16x32_bf16 v[24:27], a[128:131], a[80:83], v[60:63]
    v_exp_f32 v20, v20
    v_mfma_f32_16x16x32_bf16 v[24:27], a[132:135], a[84:87], v[24:27]
    v_cvt_pk_bf16_f32 v32, v16, v17
    v_cvt_pk_bf16_f32 v33, v18, v19
    v_mfma_f32_16x16x32_bf16 v[24:27], a[136:139], a[88:91], v[24:27]
    v_exp_f32 v21, v21
    v_mfma_f32_16x16x32_bf16 v[24:27], a[140:143], a[92:95], v[24:27]
    ds_read_b64_tr_b16 a[184:185], v3 offset:192
    ds_read_b64_tr_b16 a[186:187], v3 offset:704
    v_mfma_f32_16x16x32_bf16 v[28:31], a[144:147], a[80:83], v[60:63]
    v_exp_f32 v22, v22
    v_mfma_f32_16x16x32_bf16 v[28:31], a[148:151], a[84:87], v[28:31]
    v_cvt_pk_bf16_f32 v34, v20, v21
    v_mfma_f32_16x16x32_bf16 v[28:31], a[152:155], a[88:91], v[28:31]
    v_exp_f32 v23, v23
    v_mfma_f32_16x16x32_bf16 v[28:31], a[156:159], a[92:95], v[28:31]
    ds_read_b64_tr_b16 a[188:189], v3 offset:224
    ds_read_b64_tr_b16 a[190:191], v3 offset:736
    v_mfma_f32_16x16x32_bf16 v[160:163], a[192:195], v[36:39], v[160:163]
    v_cvt_pk_bf16_f32 v35, v22, v23
    v_mfma_f32_16x16x32_bf16 v[164:167], a[196:199], v[36:39], v[164:167]
    v_exp_f32 v24, v24
    v_mfma_f32_16x16x32_bf16 v[168:171], a[200:203], v[36:39], v[168:171]
    buffer_load_dwordx4 v0, s[52:55], s71 offen nt lds
    v_mfma_f32_16x16x32_bf16 v[172:175], a[204:207], v[36:39], v[172:175]
    v_exp_f32 v25, v25
    v_mfma_f32_16x16x32_bf16 v[176:179], a[208:211], v[36:39], v[176:179]
    v_mfma_f32_16x16x32_bf16 v[180:183], a[212:215], v[36:39], v[180:183]
    v_exp_f32 v26, v26
    v_mfma_f32_16x16x32_bf16 v[184:187], a[216:219], v[36:39], v[184:187]
    s_sub_u32 s74, 0, s74
    v_mfma_f32_16x16x32_bf16 v[188:191], a[220:223], v[36:39], v[188:191]
    v_exp_f32 v27, v27
    v_mfma_f32_16x16x32_bf16 a[236:239], a[248:251], v[36:39], a[236:239]
    s_mov_b32 s72, s73
    s_sub_u32 s73, s73, s74
    s_bitcmp0_b32 s43, 0
    s_waitcnt vmcnt(4) lgkmcnt(0)
    s_cbranch_scc1 L_LX1
    s_waitcnt vmcnt(2)
L_LX1:
    s_sub_u32 s68, s68, 1
    s_cbranch_scc0 L_LOOP
    s_barrier
    v_mfma_f32_16x16x32_bf16 v[16:19], a[96:99], a[0:3], v[40:43]
    v_exp_f32 v28, v28
    v_mfma_f32_16x16x32_bf16 v[16:19], a[100:103], a[4:7], v[16:19]
    v_cvt_pk_bf16_f32 v36, v24, v25
    v_cvt_pk_bf16_f32 v37, v26, v27
    v_mfma_f32_16x16x32_bf16 v[16:19], a[104:107], a[8:11], v[16:19]
    v_exp_f32 v29, v29
    v_mfma_f32_16x16x32_bf16 v[16:19], a[108:111], a[12:15], v[16:19]
    s_add_u32 s71, s71, 1024
    s_and_b32 s71, s71, 0x3ffff
    v_mfma_f32_16x16x32_bf16 v[20:23], a[112:115], a[0:3], v[40:43]
    v_exp_f32 v30, v30
    v_mfma_f32_16x16x32_bf16 v[20:23], a[116:119], a[4:7], v[20:23]
    v_cvt_pk_bf16_f32 v38, v28, v29
    v_mfma_f32_16x16x32_bf16 v[20:23], a[120:123], a[8:11], v[20:23]
    v_exp_f32 v31, v31
    v_mfma_f32_16x16x32_bf16 v[20:23], a[124:127], a[12:15], v[20:23]
    ds_read_b128 a[128:131], v2 offset:33664
    ds_read_b128 a[132:135], v2 offset:33728
    v_mfma_f32_16x16x32_bf16 v[192:195], a[192:195], v[32:35], v[192:195]
    v_cvt_pk_bf16_f32 v39, v30, v31
    s_add_u32 m0, s75, 37888
    v_mfma_f32_16x16x32_bf16 v[196:199], a[196:199], v[32:35], v[196:199]
    v_exp_f32 v16, v16
    v_mfma_f32_16x16x32_bf16 v[200:203], a[200:203], v[32:35], v[200:203]
    buffer_load_dwordx4 v0, s[52:55], s71 offen nt lds
    s_add_u32 m0, s75, 38944
    v_mfma_f32_16x16x32_bf16 v[204:207], a[204:207], v[32:35], v[204:207]
    v_exp_f32 v17, v17
    v_mfma_f32_16x16x32_bf16 v[208:211], a[208:211], v[32:35], v[208:211]
    ds_read_b128 a[136:139], v2 offset:33792
    ds_read_b128 a[140:143], v2 offset:33856
    v_mfma_f32_16x16x32_bf16 v[212:215], a[212:215], v[32:35], v[212:215]
    v_exp_f32 v18, v18
    v_mfma_f32_16x16x32_bf16 v[216:219], a[216:219], v[32:35], v[216:219]
    s_add_u32 s71, s71, 1024
    s_and_b32 s71, s71, 0x3ffff
    v_mfma_f32_16x16x32_bf16 v[220:223], a[220:223], v[32:35], v[220:223]
    v_exp_f32 v19, v19
    v_mfma_f32_16x16x32_bf16 a[240:243], a[248:251], v[32:35], a[240:243]
    buffer_load_dwordx4 v0, s[52:55], s71 offen nt lds
    s_add_u32 m0, s75, 40000
    v_mfma_f32_16x16x32_bf16 v[24:27], a[96:99], a[16:19], v[44:47]
    v_exp_f32 v20, v20
    v_mfma_f32_16x16x32_bf16 v[24:27], a[100:103], a[20:23], v[24:27]
    v_cvt_pk_bf16_f32 v32, v16, v17
    v_cvt_pk_bf16_f32 v33, v18, v19
    v_mfma_f32_16x16x32_bf16 v[24:27], a[104:107], a[24:27], v[24:27]
    v_exp_f32 v21, v21
    v_mfma_f32_16x16x32_bf16 v[24:27], a[108:111], a[28:31], v[24:27]
    ds_read_b128 a[144:147], v2 offset:34176
    ds_read_b128 a[148:151], v2 offset:34240
    v_mfma_f32_16x16x32_bf16 v[28:31], a[112:115], a[16:19], v[44:47]
    v_exp_f32 v22, v22
    v_mfma_f32_16x16x32_bf16 v[28:31], a[116:119], a[20:23], v[28:31]
    v_cvt_pk_bf16_f32 v34, v20, v21
    v_mfma_f32_16x16x32_bf16 v[28:31], a[120:123], a[24:27], v[28:31]
    v_exp_f32 v23, v23
    v_mfma_f32_16x16x32_bf16 v[28:31], a[124:127], a[28:31], v[28:31]
    ds_read_b128 a[152:155], v2 offset:34304
    ds_read_b128 a[156:159], v2 offset:34368
    v_mfma_f32_16x16x32_bf16 v[224:227], a[192:195], v[36:39], v[224:227]
    v_cvt_pk_bf16_f32 v35, v22, v23
    v_mfma_f32_16x16x32_bf16 v[228:231], a[196:199], v[36:39], v[228:231]
    v_exp_f32 v24, v24
    v_mfma_f32_16x16x32_bf16 v[232:235], a[200:203], v[36:39], v[232:235]
    s_add_u32 s71, s71, 1024
    s_and_b32 s71, s71, 0x3ffff
    v_mfma_f32_16x16x32_bf16 v[236:239], a[204:207], v[36:39], v[236:239]
    v_exp_f32 v25, v25
    v_mfma_f32_16x16x32_bf16 v[240:243], a[208:211], v[36:39], v[240:243]
    buffer_load_dwordx4 v0, s[52:55], s71 offen nt lds
    s_add_u32 m0, s75, 41056
    v_mfma_f32_16x16x32_bf16 v[244:247], a[212:215], v[36:39], v[244:247]
    v_exp_f32 v26, v26
    v_mfma_f32_16x16x32_bf16 v[248:251], a[216:219], v[36:39], v[248:251]
    s_add_u32 s71, s71, 1024
    s_and_b32 s71, s71, 0x3ffff
    v_mfma_f32_16x16x32_bf16 v[252:255], a[220:223], v[36:39], v[252:255]
    v_exp_f32 v27, v27
    v_mfma_f32_16x16x32_bf16 a[244:247], a[248:251], v[36:39], a[244:247]
    v_mfma_f32_16x16x32_bf16 v[16:19], a[96:99], a[32:35], v[48:51]
    v_exp_f32 v28, v28
    v_mfma_f32_16x16x32_bf16 v[16:19], a[100:103], a[36:39], v[16:19]
    v_cvt_pk_bf16_f32 v36, v24, v25
    v_cvt_pk_bf16_f32 v37, v26, v27
    v_mfma_f32_16x16x32_bf16 v[16:19], a[104:107], a[40:43], v[16:19]
    v_exp_f32 v29, v29
    v_mfma_f32_16x16x32_bf16 v[16:19], a[108:111], a[44:47], v[16:19]
    ds_read_b64_tr_b16 a[192:193], v3 offset:33664
    ds_read_b64_tr_b16 a[194:195], v3 offset:34176
    v_mfma_f32_16x16x32_bf16 v[20:23], a[112:115], a[32:35], v[48:51]
    v_exp_f32 v30, v30
    v_mfma_f32_16x16x32_bf16 v[20:23], a[116:119], a[36:39], v[20:23]
    v_cvt_pk_bf16_f32 v38, v28, v29
    v_mfma_f32_16x16x32_bf16 v[20:23], a[120:123], a[40:43], v[20:23]
    v_exp_f32 v31, v31
    v_mfma_f32_16x16x32_bf16 v[20:23], a[124:127], a[44:47], v[20:23]
    ds_read_b64_tr_b16 a[196:197], v3 offset:33696
    ds_read_b64_tr_b16 a[198:199], v3 offset:34208
    v_mfma_f32_16x16x32_bf16 v[64:67], a[160:163], v[32:35], v[64:67]
    v_cvt_pk_bf16_f32 v39, v30, v31
    v_mfma_f32_16x16x32_bf16 v[68:71], a[164:167], v[32:35], v[68:71]
    v_exp_f32 v16, v16
    v_mfma_f32_16x16x32_bf16 v[72:75], a[168:171], v[32:35], v[72:75]
    v_mfma_f32_16x16x32_bf16 v[76:79], a[172:175], v[32:35], v[76:79]
    v_exp_f32 v17, v17
    v_mfma_f32_16x16x32_bf16 v[80:83], a[176:179], v[32:35], v[80:83]
    v_add_u32 v2, s74, v2
    v_mfma_f32_16x16x32_bf16 v[84:87], a[180:183], v[32:35], v[84:87]
    v_exp_f32 v18, v18
    v_mfma_f32_16x16x32_bf16 v[88:91], a[184:187], v[32:35], v[88:91]
    v_mfma_f32_16x16x32_bf16 v[92:95], a[188:191], v[32:35], v[92:95]
    v_exp_f32 v19, v19
    v_mfma_f32_16x16x32_bf16 a[224:227], a[248:251], v[32:35], a[224:227]
    buffer_load_dwordx4 v0, s[52:55], s71 offen nt lds
    s_add_u32 m0, s75, 67328
    v_mfma_f32_16x16x32_bf16 v[24:27], a[96:99], a[48:51], v[52:55]
    v_exp_f32 v20, v20
    v_mfma_f32_16x16x32_bf16 v[24:27], a[100:103], a[52:55], v[24:27]
    v_cvt_pk_bf16_f32 v32, v16, v17
    v_cvt_pk_bf16_f32 v33, v18, v19
    v_mfma_f32_16x16x32_bf16 v[24:27], a[104:107], a[56:59], v[24:27]
    v_exp_f32 v21, v21
    v_mfma_f32_16x16x32_bf16 v[24:27], a[108:111], a[60:63], v[24:27]
    ds_read_b64_tr_b16 a[200:201], v3 offset:33728
    ds_read_b64_tr_b16 a[202:203], v3 offset:34240
    v_mfma_f32_16x16x32_bf16 v[28:31], a[112:115], a[48:51], v[52:55]
    v_exp_f32 v22, v22
    v_mfma_f32_16x16x32_bf16 v[28:31], a[116:119], a[52:55], v[28:31]
    v_cvt_pk_bf16_f32 v34, v20, v21
    s_add_u32 s71, s71, 1024
    s_and_b32 s71, s71, 0x3ffff
    v_mfma_f32_16x16x32_bf16 v[28:31], a[120:123], a[56:59], v[28:31]
    v_exp_f32 v23, v23
    v_mfma_f32_16x16x32_bf16 v[28:31], a[124:127], a[60:63], v[28:31]
    ds_read_b64_tr_b16 a[204:205], v3 offset:33760
    ds_read_b64_tr_b16 a[206:207], v3 offset:34272
    v_mfma_f32_16x16x32_bf16 v[96:99], a[160:163], v[36:39], v[96:99]
    v_cvt_pk_bf16_f32 v35, v22, v23
    v_mfma_f32_16x16x32_bf16 v[100:103], a[164:167], v[36:39], v[100:103]
    v_exp_f32 v24, v24
    v_mfma_f32_16x16x32_bf16 v[104:107], a[168:171], v[36:39], v[104:107]
    buffer_load_dwordx4 v0, s[52:55], s71 offen nt lds
    s_add_u32 m0, s75, 68384
    v_mfma_f32_16x16x32_bf16 v[108:111], a[172:175], v[36:39], v[108:111]
    v_exp_f32 v25, v25
    v_mfma_f32_16x16x32_bf16 v[112:115], a[176:179], v[36:39], v[112:115]
    s_add_u32 s71, s71, 1024
    s_and_b32 s71, s71, 0x3ffff
    v_mfma_f32_16x16x32_bf16 v[116:119], a[180:183], v[36:39], v[116:119]
    v_exp_f32 v26, v26
    v_mfma_f32_16x16x32_bf16 v[120:123], a[184:187], v[36:39], v[120:123]
    v_mfma_f32_16x16x32_bf16 v[124:127], a[188:191], v[36:39], v[124:127]
    v_exp_f32 v27, v27
    v_mfma_f32_16x16x32_bf16 a[228:231], a[248:251], v[36:39], a[228:231]
    buffer_load_dwordx4 v0, s[52:55], s71 offen nt lds
    s_add_u32 m0, s75, 69440
    v_mfma_f32_16x16x32_bf16 v[16:19], a[96:99], a[64:67], v[56:59]
    v_exp_f32 v28, v28
    v_mfma_f32_16x16x32_bf16 v[16:19], a[100:103], a[68:71], v[16:19]
    v_cvt_pk_bf16_f32 v36, v24, v25
    v_cvt_pk_bf16_f32 v37, v26, v27
    v_mfma_f32_16x16x32_bf16 v[16:19], a[104:107], a[72:75], v[16:19]
    v_exp_f32 v29, v29
    v_mfma_f32_16x16x32_bf16 v[16:19], a[108:111], a[76:79], v[16:19]
    ds_read_b64_tr_b16 a[208:209], v3 offset:33792
    ds_read_b64_tr_b16 a[210:211], v3 offset:34304
    v_mfma_f32_16x16x32_bf16 v[20:23], a[112:115], a[64:67], v[56:59]
    v_exp_f32 v30, v30
    v_mfma_f32_16x16x32_bf16 v[20:23], a[116:119], a[68:71], v[20:23]
    v_cvt_pk_bf16_f32 v38, v28, v29
    v_mfma_f32_16x16x32_bf16 v[20:23], a[120:123], a[72:75], v[20:23]
    v_exp_f32 v31, v31
    v_mfma_f32_16x16x32_bf16 v[20:23], a[124:127], a[76:79], v[20:23]
    ds_read_b64_tr_b16 a[212:213], v3 offset:33824
    ds_read_b64_tr_b16 a[214:215], v3 offset:34336
    v_mfma_f32_16x16x32_bf16 v[128:131], a[160:163], v[32:35], v[128:131]
    v_cvt_pk_bf16_f32 v39, v30, v31
    v_mfma_f32_16x16x32_bf16 v[132:135], a[164:167], v[32:35], v[132:135]
    v_exp_f32 v16, v16
    v_mfma_f32_16x16x32_bf16 v[136:139], a[168:171], v[32:35], v[136:139]
    s_add_u32 s71, s71, 1024
    s_and_b32 s71, s71, 0x3ffff
    v_mfma_f32_16x16x32_bf16 v[140:143], a[172:175], v[32:35], v[140:143]
    v_exp_f32 v17, v17
    v_mfma_f32_16x16x32_bf16 v[144:147], a[176:179], v[32:35], v[144:147]
    buffer_load_dwordx4 v0, s[52:55], s71 offen nt lds
    v_mfma_f32_16x16x32_bf16 v[148:151], a[180:183], v[32:35], v[148:151]
    v_exp_f32 v18, v18
    v_mfma_f32_16x16x32_bf16 v[152:155], a[184:187], v[32:35], v[152:155]
    v_mfma_f32_16x16x32_bf16 v[156:159], a[188:191], v[32:35], v[156:159]
    v_exp_f32 v19, v19
    v_mfma_f32_16x16x32_bf16 a[232:235], a[248:251], v[32:35], a[232:235]
    v_mfma_f32_16x16x32_bf16 v[24:27], a[96:99], a[80:83], v[60:63]
    v_exp_f32 v20, v20
    v_mfma_f32_16x16x32_bf16 v[24:27], a[100:103], a[84:87], v[24:27]
    v_cvt_pk_bf16_f32 v32, v16, v17
    v_cvt_pk_bf16_f32 v33, v18, v19
    v_mfma_f32_16x16x32_bf16 v[24:27], a[104:107], a[88:91], v[24:27]
    v_exp_f32 v21, v21
    v_mfma_f32_16x16x32_bf16 v[24:27], a[108:111], a[92:95], v[24:27]
    ds_read_b64_tr_b16 a[216:217], v3 offset:33856
    ds_read_b64_tr_b16 a[218:219], v3 offset:34368
    v_mfma_f32_16x16x32_bf16 v[28:31], a[112:115], a[80:83], v[60:63]
    v_exp_f32 v22, v22
    v_mfma_f32_16x16x32_bf16 v[28:31], a[116:119], a[84:87], v[28:31]
    v_cvt_pk_bf16_f32 v34, v20, v21
    v_mfma_f32_16x16x32_bf16 v[28:31], a[120:123], a[88:91], v[28:31]
    v_exp_f32 v23, v23
    v_mfma_f32_16x16x32_bf16 v[28:31], a[124:127], a[92:95], v[28:31]
    ds_read_b64_tr_b16 a[220:221], v3 offset:33888
    ds_read_b64_tr_b16 a[222:223], v3 offset:34400
    v_mfma_f32_16x16x32_bf16 v[160:163], a[160:163], v[36:39], v[160:163]
    v_cvt_pk_bf16_f32 v35, v22, v23
    v_mfma_f32_16x16x32_bf16 v[164:167], a[164:167], v[36:39], v[164:167]
    v_exp_f32 v24, v24
    v_mfma_f32_16x16x32_bf16 v[168:171], a[168:171], v[36:39], v[168:171]
    v_mfma_f32_16x16x32_bf16 v[172:175], a[172:175], v[36:39], v[172:175]
    v_exp_f32 v25, v25
    v_mfma_f32_16x16x32_bf16 v[176:179], a[176:179], v[36:39], v[176:179]
    v_mfma_f32_16x16x32_bf16 v[180:183], a[180:183], v[36:39], v[180:183]
    v_exp_f32 v26, v26
    v_mfma_f32_16x16x32_bf16 v[184:187], a[184:187], v[36:39], v[184:187]
    v_add_u32 v3, s74, v3
    v_mfma_f32_16x16x32_bf16 v[188:191], a[188:191], v[36:39], v[188:191]
    v_exp_f32 v27, v27
    v_mfma_f32_16x16x32_bf16 a[236:239], a[248:251], v[36:39], a[236:239]
    s_waitcnt vmcnt(3) lgkmcnt(0)
    s_barrier
    v_mfma_f32_16x16x32_bf16 v[16:19], a[128:131], a[0:3], v[40:43]
    v_exp_f32 v28, v28
    v_mfma_f32_16x16x32_bf16 v[16:19], a[132:135], a[4:7], v[16:19]
    v_cvt_pk_bf16_f32 v36, v24, v25
    v_cvt_pk_bf16_f32 v37, v26, v27
    v_mfma_f32_16x16x32_bf16 v[16:19], a[136:139], a[8:11], v[16:19]
    v_exp_f32 v29, v29
    v_mfma_f32_16x16x32_bf16 v[16:19], a[140:143], a[12:15], v[16:19]
    s_add_u32 s71, s71, 1024
    s_and_b32 s71, s71, 0x3ffff
    v_mfma_f32_16x16x32_bf16 v[20:23], a[144:147], a[0:3], v[40:43]
    v_exp_f32 v30, v30
    v_mfma_f32_16x16x32_bf16 v[20:23], a[148:151], a[4:7], v[20:23]
    v_cvt_pk_bf16_f32 v38, v28, v29
    v_mfma_f32_16x16x32_bf16 v[20:23], a[152:155], a[8:11], v[20:23]
    v_exp_f32 v31, v31
    v_mfma_f32_16x16x32_bf16 v[20:23], a[156:159], a[12:15], v[20:23]
    ds_read_b128 a[96:99], v2 offset:0
    ds_read_b128 a[100:103], v2 offset:64
    v_mfma_f32_16x16x32_bf16 v[192:195], a[160:163], v[32:35], v[192:195]
    v_cvt_pk_bf16_f32 v39, v30, v31
    s_add_u32 m0, s75, 70496
    v_mfma_f32_16x16x32_bf16 v[196:199], a[164:167], v[32:35], v[196:199]
    v_exp_f32 v16, v16
    v_mfma_f32_16x16x32_bf16 v[200:203], a[168:171], v[32:35], v[200:203]
    buffer_load_dwordx4 v0, s[52:55], s71 offen nt lds
    s_add_u32 m0, s75, 71552
    v_mfma_f32_16x16x32_bf16 v[204:207], a[172:175], v[32:35], v[204:207]
    v_exp_f32 v17, v17
    v_mfma_f32_16x16x32_bf16 v[208:211], a[176:179], v[32:35], v[208:211]
    ds_read_b128 a[104:107], v2 offset:128
    ds_read_b128 a[108:111], v2 offset:192
    v_mfma_f32_16x16x32_bf16 v[212:215], a[180:183], v[32:35], v[212:215]
    v_exp_f32 v18, v18
    v_mfma_f32_16x16x32_bf16 v[216:219], a[184:187], v[32:35], v[216:219]
    s_add_u32 s71, s71, 1024
    s_and_b32 s71, s71, 0x3ffff
    v_mfma_f32_16x16x32_bf16 v[220:223], a[188:191], v[32:35], v[220:223]
    v_exp_f32 v19, v19
    v_mfma_f32_16x16x32_bf16 a[240:243], a[248:251], v[32:35], a[240:243]
    buffer_load_dwordx4 v0, s[52:55], s71 offen nt lds
    s_add_u32 m0, s75, 72608
    v_mfma_f32_16x16x32_bf16 v[24:27], a[128:131], a[16:19], v[44:47]
    v_exp_f32 v20, v20
    v_mfma_f32_16x16x32_bf16 v[24:27], a[132:135], a[20:23], v[24:27]
    v_cvt_pk_bf16_f32 v32, v16, v17
    v_cvt_pk_bf16_f32 v33, v18, v19
    v_mfma_f32_16x16x32_bf16 v[24:27], a[136:139], a[24:27], v[24:27]
    v_exp_f32 v21, v21
    v_mfma_f32_16x16x32_bf16 v[24:27], a[140:143], a[28:31], v[24:27]
    ds_read_b128 a[112:115], v2 offset:512
    ds_read_b128 a[116:119], v2 offset:576
    v_mfma_f32_16x16x32_bf16 v[28:31], a[144:147], a[16:19], v[44:47]
    v_exp_f32 v22, v22
    v_mfma_f32_16x16x32_bf16 v[28:31], a[148:151], a[20:23], v[28:31]
    v_cvt_pk_bf16_f32 v34, v20, v21
    v_mfma_f32_16x16x32_bf16 v[28:31], a[152:155], a[24:27], v[28:31]
    v_exp_f32 v23, v23
    v_mfma_f32_16x16x32_bf16 v[28:31], a[156:159], a[28:31], v[28:31]
    ds_read_b128 a[120:123], v2 offset:640
    ds_read_b128 a[124:127], v2 offset:704
    v_mfma_f32_16x16x32_bf16 v[224:227], a[160:163], v[36:39], v[224:227]
    v_cvt_pk_bf16_f32 v35, v22, v23
    v_mfma_f32_16x16x32_bf16 v[228:231], a[164:167], v[36:39], v[228:231]
    v_exp_f32 v24, v24
    v_mfma_f32_16x16x32_bf16 v[232:235], a[168:171], v[36:39], v[232:235]
    s_add_u32 s71, s71, 1024
    s_and_b32 s71, s71, 0x3ffff
    v_mfma_f32_16x16x32_bf16 v[236:239], a[172:175], v[36:39], v[236:239]
    v_exp_f32 v25, v25
    v_mfma_f32_16x16x32_bf16 v[240:243], a[176:179], v[36:39], v[240:243]
    buffer_load_dwordx4 v0, s[52:55], s71 offen nt lds
    s_add_u32 m0, s75, 73664
    v_mfma_f32_16x16x32_bf16 v[244:247], a[180:183], v[36:39], v[244:247]
    v_exp_f32 v26, v26
    v_mfma_f32_16x16x32_bf16 v[248:251], a[184:187], v[36:39], v[248:251]
    s_add_u32 s71, s71, 1024
    s_and_b32 s71, s71, 0x3ffff
    v_mfma_f32_16x16x32_bf16 v[252:255], a[188:191], v[36:39], v[252:255]
    v_exp_f32 v27, v27
    v_mfma_f32_16x16x32_bf16 a[244:247], a[248:251], v[36:39], a[244:247]
    v_mfma_f32_16x16x32_bf16 v[16:19], a[128:131], a[32:35], v[48:51]
    v_exp_f32 v28, v28
    v_mfma_f32_16x16x32_bf16 v[16:19], a[132:135], a[36:39], v[16:19]
    v_cvt_pk_bf16_f32 v36, v24, v25
    v_cvt_pk_bf16_f32 v37, v26, v27
    v_mfma_f32_16x16x32_bf16 v[16:19], a[136:139], a[40:43], v[16:19]
    v_exp_f32 v29, v29
    v_mfma_f32_16x16x32_bf16 v[16:19], a[140:143], a[44:47], v[16:19]
    ds_read_b64_tr_b16 a[160:161], v3 offset:0
    ds_read_b64_tr_b16 a[162:163], v3 offset:512
    v_mfma_f32_16x16x32_bf16 v[20:23], a[144:147], a[32:35], v[48:51]
    v_exp_f32 v30, v30
    v_mfma_f32_16x16x32_bf16 v[20:23], a[148:151], a[36:39], v[20:23]
    v_cvt_pk_bf16_f32 v38, v28, v29
    v_mfma_f32_16x16x32_bf16 v[20:23], a[152:155], a[40:43], v[20:23]
    v_exp_f32 v31, v31
    v_mfma_f32_16x16x32_bf16 v[20:23], a[156:159], a[44:47], v[20:23]
    ds_read_b64_tr_b16 a[164:165], v3 offset:32
    ds_read_b64_tr_b16 a[166:167], v3 offset:544
    v_mfma_f32_16x16x32_bf16 v[64:67], a[192:195], v[32:35], v[64:67]
    v_cvt_pk_bf16_f32 v39, v30, v31
    v_mfma_f32_16x16x32_bf16 v[68:71], a[196:199], v[32:35], v[68:71]
    v_exp_f32 v16, v16
    v_mfma_f32_16x16x32_bf16 v[72:75], a[200:203], v[32:35], v[72:75]
    v_mfma_f32_16x16x32_bf16 v[76:79], a[204:207], v[32:35], v[76:79]
    v_exp_f32 v17, v17
    v_mfma_f32_16x16x32_bf16 v[80:83], a[208:211], v[32:35], v[80:83]
    v_mfma_f32_16x16x32_bf16 v[84:87], a[212:215], v[32:35], v[84:87]
    v_exp_f32 v18, v18
    v_mfma_f32_16x16x32_bf16 v[88:91], a[216:219], v[32:35], v[88:91]
    v_mfma_f32_16x16x32_bf16 v[92:95], a[220:223], v[32:35], v[92:95]
    v_exp_f32 v19, v19
    v_mfma_f32_16x16x32_bf16 a[224:227], a[248:251], v[32:35], a[224:227]
    buffer_load_dwordx4 v0, s[52:55], s71 offen nt lds
    s_add_u32 m0, s75, 74720
    v_mfma_f32_16x16x32_bf16 v[24:27], a[128:131], a[48:51], v[52:55]
    v_exp_f32 v20, v20
    v_mfma_f32_16x16x32_bf16 v[24:27], a[132:135], a[52:55], v[24:27]
    v_cvt_pk_bf16_f32 v32, v16, v17
    v_cvt_pk_bf16_f32 v33, v18, v19
    v_mfma_f32_16x16x32_bf16 v[24:27], a[136:139], a[56:59], v[24:27]
    v_exp_f32 v21, v21
    v_mfma_f32_16x16x32_bf16 v[24:27], a[140:143], a[60:63], v[24:27]
    ds_read_b64_tr_b16 a[168:169], v3 offset:64
    ds_read_b64_tr_b16 a[170:171], v3 offset:576
    v_mfma_f32_16x16x32_bf16 v[28:31], a[144:147], a[48:51], v[52:55]
    v_exp_f32 v22, v22
    v_mfma_f32_16x16x32_bf16 v[28:31], a[148:151], a[52:55], v[28:31]
    v_cvt_pk_bf16_f32 v34, v20, v21
    s_add_u32 s71, s71, 1024
    s_and_b32 s71, s71, 0x3ffff
    v_mfma_f32_16x16x32_bf16 v[28:31], a[152:155], a[56:59], v[28:31]
    v_exp_f32 v23, v23
    v_mfma_f32_16x16x32_bf16 v[28:31], a[156:159], a[60:63], v[28:31]
    ds_read_b64_tr_b16 a[172:173], v3 offset:96
    ds_read_b64_tr_b16 a[174:175], v3 offset:608
    v_mfma_f32_16x16x32_bf16 v[96:99], a[192:195], v[36:39], v[96:99]
    v_cvt_pk_bf16_f32 v35, v22, v23
    v_mfma_f32_16x16x32_bf16 v[100:103], a[196:199], v[36:39], v[100:103]
    v_exp_f32 v24, v24
    v_mfma_f32_16x16x32_bf16 v[104:107], a[200:203], v[36:39], v[104:107]
    buffer_load_dwordx4 v0, s[52:55], s71 offen nt lds
    s_add_u32 m0, s75, 100992
    v_mfma_f32_16x16x32_bf16 v[108:111], a[204:207], v[36:39], v[108:111]
    v_exp_f32 v25, v25
    v_mfma_f32_16x16x32_bf16 v[112:115], a[208:211], v[36:39], v[112:115]
    s_add_u32 s71, s71, 1024
    s_and_b32 s71, s71, 0x3ffff
    v_mfma_f32_16x16x32_bf16 v[116:119], a[212:215], v[36:39], v[116:119]
    v_exp_f32 v26, v26
    v_mfma_f32_16x16x32_bf16 v[120:123], a[216:219], v[36:39], v[120:123]
    v_mfma_f32_16x16x32_bf16 v[124:127], a[220:223], v[36:39], v[124:127]
    v_exp_f32 v27, v27
    v_mfma_f32_16x16x32_bf16 a[228:231], a[248:251], v[36:39], a[228:231]
    buffer_load_dwordx4 v0, s[52:55], s71 offen nt lds
    s_add_u32 m0, s75, 102048
    v_mfma_f32_16x16x32_bf16 v[16:19], a[128:131], a[64:67], v[56:59]
    v_exp_f32 v28, v28
    v_mfma_f32_16x16x32_bf16 v[16:19], a[132:135], a[68:71], v[16:19]
    v_cvt_pk_bf16_f32 v36, v24, v25
    v_cvt_pk_bf16_f32 v37, v26, v27
    v_mfma_f32_16x16x32_bf16 v[16:19], a[136:139], a[72:75], v[16:19]
    v_exp_f32 v29, v29
    v_mfma_f32_16x16x32_bf16 v[16:19], a[140:143], a[76:79], v[16:19]
    ds_read_b64_tr_b16 a[176:177], v3 offset:128
    ds_read_b64_tr_b16 a[178:179], v3 offset:640
    v_mfma_f32_16x16x32_bf16 v[20:23], a[144:147], a[64:67], v[56:59]
    v_exp_f32 v30, v30
    v_mfma_f32_16x16x32_bf16 v[20:23], a[148:151], a[68:71], v[20:23]
    v_cvt_pk_bf16_f32 v38, v28, v29
    v_mfma_f32_16x16x32_bf16 v[20:23], a[152:155], a[72:75], v[20:23]
    v_exp_f32 v31, v31
    v_mfma_f32_16x16x32_bf16 v[20:23], a[156:159], a[76:79], v[20:23]
    ds_read_b64_tr_b16 a[180:181], v3 offset:160
    ds_read_b64_tr_b16 a[182:183], v3 offset:672
    v_mfma_f32_16x16x32_bf16 v[128:131], a[192:195], v[32:35], v[128:131]
    v_cvt_pk_bf16_f32 v39, v30, v31
    v_mfma_f32_16x16x32_bf16 v[132:135], a[196:199], v[32:35], v[132:135]
    v_exp_f32 v16, v16
    v_mfma_f32_16x16x32_bf16 v[136:139], a[200:203], v[32:35], v[136:139]
    s_add_u32 s71, s71, 1024
    s_and_b32 s71, s71, 0x3ffff
    v_mfma_f32_16x16x32_bf16 v[140:143], a[204:207], v[32:35], v[140:143]
    v_exp_f32 v17, v17
    v_mfma_f32_16x16x32_bf16 v[144:147], a[208:211], v[32:35], v[144:147]
    buffer_load_dwordx4 v0, s[52:55], s71 offen nt lds
    v_mfma_f32_16x16x32_bf16 v[148:151], a[212:215], v[32:35], v[148:151]
    v_exp_f32 v18, v18
    v_mfma_f32_16x16x32_bf16 v[152:155], a[216:219], v[32:35], v[152:155]
    v_mfma_f32_16x16x32_bf16 v[156:159], a[220:223], v[32:35], v[156:159]
    v_exp_f32 v19, v19
    v_mfma_f32_16x16x32_bf16 a[232:235], a[248:251], v[32:35], a[232:235]
    v_mfma_f32_16x16x32_bf16 v[24:27], a[128:131], a[80:83], v[60:63]
    v_exp_f32 v20, v20
    v_mfma_f32_16x16x32_bf16 v[24:27], a[132:135], a[84:87], v[24:27]
    v_cvt_pk_bf16_f32 v32, v16, v17
    v_cvt_pk_bf16_f32 v33, v18, v19
    v_mfma_f32_16x16x32_bf16 v[24:27], a[136:139], a[88:91], v[24:27]
    v_exp_f32 v21, v21
    v_mfma_f32_16x16x32_bf16 v[24:27], a[140:143], a[92:95], v[24:27]
    ds_read_b64_tr_b16 a[184:185], v3 offset:192
    ds_read_b64_tr_b16 a[186:187], v3 offset:704
    v_mfma_f32_16x16x32_bf16 v[28:31], a[144:147], a[80:83], v[60:63]
    v_exp_f32 v22, v22
    v_mfma_f32_16x16x32_bf16 v[28:31], a[148:151], a[84:87], v[28:31]
    v_cvt_pk_bf16_f32 v34, v20, v21
    v_mfma_f32_16x16x32_bf16 v[28:31], a[152:155], a[88:91], v[28:31]
    v_exp_f32 v23, v23
    v_mfma_f32_16x16x32_bf16 v[28:31], a[156:159], a[92:95], v[28:31]
    ds_read_b64_tr_b16 a[188:189], v3 offset:224
    ds_read_b64_tr_b16 a[190:191], v3 offset:736
    v_mfma_f32_16x16x32_bf16 v[160:163], a[192:195], v[36:39], v[160:163]
    v_cvt_pk_bf16_f32 v35, v22, v23
    v_mfma_f32_16x16x32_bf16 v[164:167], a[196:199], v[36:39], v[164:167]
    v_exp_f32 v24, v24
    v_mfma_f32_16x16x32_bf16 v[168:171], a[200:203], v[36:39], v[168:171]
    v_mfma_f32_16x16x32_bf16 v[172:175], a[204:207], v[36:39], v[172:175]
    v_exp_f32 v25, v25
    v_mfma_f32_16x16x32_bf16 v[176:179], a[208:211], v[36:39], v[176:179]
    v_mfma_f32_16x16x32_bf16 v[180:183], a[212:215], v[36:39], v[180:183]
    v_exp_f32 v26, v26
    v_mfma_f32_16x16x32_bf16 v[184:187], a[216:219], v[36:39], v[184:187]
    s_sub_u32 s74, 0, s74
    v_mfma_f32_16x16x32_bf16 v[188:191], a[220:223], v[36:39], v[188:191]
    v_exp_f32 v27, v27
    v_mfma_f32_16x16x32_bf16 a[236:239], a[248:251], v[36:39], a[236:239]
    s_waitcnt vmcnt(10) lgkmcnt(0)
    s_barrier
    v_mfma_f32_16x16x32_bf16 v[16:19], a[96:99], a[0:3], v[40:43]
    v_exp_f32 v28, v28
    v_mfma_f32_16x16x32_bf16 v[16:19], a[100:103], a[4:7], v[16:19]
    v_cvt_pk_bf16_f32 v36, v24, v25
    v_cvt_pk_bf16_f32 v37, v26, v27
    v_mfma_f32_16x16x32_bf16 v[16:19], a[104:107], a[8:11], v[16:19]
    v_exp_f32 v29, v29
    v_mfma_f32_16x16x32_bf16 v[16:19], a[108:111], a[12:15], v[16:19]
    s_add_u32 s71, s71, 1024
    s_and_b32 s71, s71, 0x3ffff
    v_mfma_f32_16x16x32_bf16 v[20:23], a[112:115], a[0:3], v[40:43]
    v_exp_f32 v30, v30
    v_mfma_f32_16x16x32_bf16 v[20:23], a[116:119], a[4:7], v[20:23]
    v_cvt_pk_bf16_f32 v38, v28, v29
    v_mfma_f32_16x16x32_bf16 v[20:23], a[120:123], a[8:11], v[20:23]
    v_exp_f32 v31, v31
    v_mfma_f32_16x16x32_bf16 v[20:23], a[124:127], a[12:15], v[20:23]
    ds_read_b128 a[128:131], v2 offset:33664
    ds_read_b128 a[132:135], v2 offset:33728
    v_mfma_f32_16x16x32_bf16 v[192:195], a[192:195], v[32:35], v[192:195]
    v_cvt_pk_bf16_f32 v39, v30, v31
    s_add_u32 m0, s75, 103104
    v_mfma_f32_16x16x32_bf16 v[196:199], a[196:199], v[32:35], v[196:199]
    v_exp_f32 v16, v16
    v_mfma_f32_16x16x32_bf16 v[200:203], a[200:203], v[32:35], v[200:203]
    buffer_load_dwordx4 v0, s[52:55], s71 offen nt lds
    s_add_u32 m0, s75, 104160
    v_mfma_f32_16x16x32_bf16 v[204:207], a[204:207], v[32:35], v[204:207]
    v_exp_f32 v17, v17
    v_mfma_f32_16x16x32_bf16 v[208:211], a[208:211], v[32:35], v[208:211]
    ds_read_b128 a[136:139], v2 offset:33792
    ds_read_b128 a[140:143], v2 offset:33856
    v_mfma_f32_16x16x32_bf16 v[212:215], a[212:215], v[32:35], v[212:215]
    v_exp_f32 v18, v18
    v_mfma_f32_16x16x32_bf16 v[216:219], a[216:219], v[32:35], v[216:219]
    s_add_u32 s71, s71, 1024
    s_and_b32 s71, s71, 0x3ffff
    v_mfma_f32_16x16x32_bf16 v[220:223], a[220:223], v[32:35], v[220:223]
    v_exp_f32 v19, v19
    v_mfma_f32_16x16x32_bf16 a[240:243], a[248:251], v[32:35], a[240:243]
    buffer_load_dwordx4 v0, s[52:55], s71 offen nt lds
    s_add_u32 m0, s75, 105216
    v_mfma_f32_16x16x32_bf16 v[24:27], a[96:99], a[16:19], v[44:47]
    v_exp_f32 v20, v20
    v_mfma_f32_16x16x32_bf16 v[24:27], a[100:103], a[20:23], v[24:27]
    v_cvt_pk_bf16_f32 v32, v16, v17
    v_cvt_pk_bf16_f32 v33, v18, v19
    v_mfma_f32_16x16x32_bf16 v[24:27], a[104:107], a[24:27], v[24:27]
    v_exp_f32 v21, v21
    v_mfma_f32_16x16x32_bf16 v[24:27], a[108:111], a[28:31], v[24:27]
    ds_read_b128 a[144:147], v2 offset:34176
    ds_read_b128 a[148:151], v2 offset:34240
    v_mfma_f32_16x16x32_bf16 v[28:31], a[112:115], a[16:19], v[44:47]
    v_exp_f32 v22, v22
    v_mfma_f32_16x16x32_bf16 v[28:31], a[116:119], a[20:23], v[28:31]
    v_cvt_pk_bf16_f32 v34, v20, v21
    v_mfma_f32_16x16x32_bf16 v[28:31], a[120:123], a[24:27], v[28:31]
    v_exp_f32 v23, v23
    v_mfma_f32_16x16x32_bf16 v[28:31], a[124:127], a[28:31], v[28:31]
    ds_read_b128 a[152:155], v2 offset:34304
    ds_read_b128 a[156:159], v2 offset:34368
    v_mfma_f32_16x16x32_bf16 v[224:227], a[192:195], v[36:39], v[224:227]
    v_cvt_pk_bf16_f32 v35, v22, v23
    v_mfma_f32_16x16x32_bf16 v[228:231], a[196:199], v[36:39], v[228:231]
    v_exp_f32 v24, v24
    v_mfma_f32_16x16x32_bf16 v[232:235], a[200:203], v[36:39], v[232:235]
    s_add_u32 s71, s71, 1024
    s_and_b32 s71, s71, 0x3ffff
    v_mfma_f32_16x16x32_bf16 v[236:239], a[204:207], v[36:39], v[236:239]
    v_exp_f32 v25, v25
    v_mfma_f32_16x16x32_bf16 v[240:243], a[208:211], v[36:39], v[240:243]
    buffer_load_dwordx4 v0, s[52:55], s71 offen nt lds
    v_mfma_f32_16x16x32_bf16 v[244:247], a[212:215], v[36:39], v[244:247]
    v_exp_f32 v26, v26
    v_mfma_f32_16x16x32_bf16 v[248:251], a[216:219], v[36:39], v[248:251]
    v_mfma_f32_16x16x32_bf16 v[252:255], a[220:223], v[36:39], v[252:255]
    v_exp_f32 v27, v27
    v_mfma_f32_16x16x32_bf16 a[244:247], a[248:251], v[36:39], a[244:247]
    v_mfma_f32_16x16x32_bf16 v[16:19], a[96:99], a[32:35], v[48:51]
    v_exp_f32 v28, v28
    v_mfma_f32_16x16x32_bf16 v[16:19], a[100:103], a[36:39], v[16:19]
    v_cvt_pk_bf16_f32 v36, v24, v25
    v_cvt_pk_bf16_f32 v37, v26, v27
    v_mfma_f32_16x16x32_bf16 v[16:19], a[104:107], a[40:43], v[16:19]
    v_exp_f32 v29, v29
    v_mfma_f32_16x16x32_bf16 v[16:19], a[108:111], a[44:47], v[16:19]
    ds_read_b64_tr_b16 a[192:193], v3 offset:33664
    ds_read_b64_tr_b16 a[194:195], v3 offset:34176
    v_mfma_f32_16x16x32_bf16 v[20:23], a[112:115], a[32:35], v[48:51]
    v_exp_f32 v30, v30
    v_mfma_f32_16x16x32_bf16 v[20:23], a[116:119], a[36:39], v[20:23]
    v_cvt_pk_bf16_f32 v38, v28, v29
    v_mfma_f32_16x16x32_bf16 v[20:23], a[120:123], a[40:43], v[20:23]
    v_exp_f32 v31, v31
    v_mfma_f32_16x16x32_bf16 v[20:23], a[124:127], a[44:47], v[20:23]
    ds_read_b64_tr_b16 a[196:197], v3 offset:33696
    ds_read_b64_tr_b16 a[198:199], v3 offset:34208
    v_mfma_f32_16x16x32_bf16 v[64:67], a[160:163], v[32:35], v[64:67]
    v_cvt_pk_bf16_f32 v39, v30, v31
    v_mfma_f32_16x16x32_bf16 v[68:71], a[164:167], v[32:35], v[68:71]
    v_exp_f32 v16, v16
    v_mfma_f32_16x16x32_bf16 v[72:75], a[168:171], v[32:35], v[72:75]
    v_mfma_f32_16x16x32_bf16 v[76:79], a[172:175], v[32:35], v[76:79]
    v_exp_f32 v17, v17
    v_mfma_f32_16x16x32_bf16 v[80:83], a[176:179], v[32:35], v[80:83]
    v_add_u32 v2, s74, v2
    v_mfma_f32_16x16x32_bf16 v[84:87], a[180:183], v[32:35], v[84:87]
    v_exp_f32 v18, v18
    v_mfma_f32_16x16x32_bf16 v[88:91], a[184:187], v[32:35], v[88:91]
    v_mfma_f32_16x16x32_bf16 v[92:95], a[188:191], v[32:35], v[92:95]
    v_exp_f32 v19, v19
    v_mfma_f32_16x16x32_bf16 a[224:227], a[248:251], v[32:35], a[224:227]
    s_add_u32 m0, s75, 106272
    v_mfma_f32_16x16x32_bf16 v[24:27], a[96:99], a[48:51], v[52:55]
    v_exp_f32 v20, v20
    v_mfma_f32_16x16x32_bf16 v[24:27], a[100:103], a[52:55], v[24:27]
    v_cvt_pk_bf16_f32 v32, v16, v17
    v_cvt_pk_bf16_f32 v33, v18, v19
    v_mfma_f32_16x16x32_bf16 v[24:27], a[104:107], a[56:59], v[24:27]
    v_exp_f32 v21, v21
    v_mfma_f32_16x16x32_bf16 v[24:27], a[108:111], a[60:63], v[24:27]
    ds_read_b64_tr_b16 a[200:201], v3 offset:33728
    ds_read_b64_tr_b16 a[202:203], v3 offset:34240
    v_mfma_f32_16x16x32_bf16 v[28:31], a[112:115], a[48:51], v[52:55]
    v_exp_f32 v22, v22
    v_mfma_f32_16x16x32_bf16 v[28:31], a[116:119], a[52:55], v[28:31]
    v_cvt_pk_bf16_f32 v34, v20, v21
    s_add_u32 s71, s71, 1024
    s_and_b32 s71, s71, 0x3ffff
    v_mfma_f32_16x16x32_bf16 v[28:31], a[120:123], a[56:59], v[28:31]
    v_exp_f32 v23, v23
    v_mfma_f32_16x16x32_bf16 v[28:31], a[124:127], a[60:63], v[28:31]
    ds_read_b64_tr_b16 a[204:205], v3 offset:33760
    ds_read_b64_tr_b16 a[206:207], v3 offset:34272
    v_mfma_f32_16x16x32_bf16 v[96:99], a[160:163], v[36:39], v[96:99]
    v_cvt_pk_bf16_f32 v35, v22, v23
    v_mfma_f32_16x16x32_bf16 v[100:103], a[164:167], v[36:39], v[100:103]
    v_exp_f32 v24, v24
    v_mfma_f32_16x16x32_bf16 v[104:107], a[168:171], v[36:39], v[104:107]
    buffer_load_dwordx4 v0, s[52:55], s71 offen nt lds
    s_add_u32 m0, s75, 107328
    v_mfma_f32_16x16x32_bf16 v[108:111], a[172:175], v[36:39], v[108:111]
    v_exp_f32 v25, v25
    v_mfma_f32_16x16x32_bf16 v[112:115], a[176:179], v[36:39], v[112:115]
    s_add_u32 s71, s71, 1024
    s_and_b32 s71, s71, 0x3ffff
    v_mfma_f32_16x16x32_bf16 v[116:119], a[180:183], v[36:39], v[116:119]
    v_exp_f32 v26, v26
    v_mfma_f32_16x16x32_bf16 v[120:123], a[184:187], v[36:39], v[120:123]
    v_mfma_f32_16x16x32_bf16 v[124:127], a[188:191], v[36:39], v[124:127]
    v_exp_f32 v27, v27
    v_mfma_f32_16x16x32_bf16 a[228:231], a[248:251], v[36:39], a[228:231]
    buffer_load_dwordx4 v0, s[52:55], s71 offen nt lds
    s_add_u32 m0, s75, 108384
    v_mfma_f32_16x16x32_bf16 v[16:19], a[96:99], a[64:67], v[56:59]
    v_exp_f32 v28, v28
    v_mfma_f32_16x16x32_bf16 v[16:19], a[100:103], a[68:71], v[16:19]
    v_cvt_pk_bf16_f32 v36, v24, v25
    v_cvt_pk_bf16_f32 v37, v26, v27
    v_mfma_f32_16x16x32_bf16 v[16:19], a[104:107], a[72:75], v[16:19]
    v_exp_f32 v29, v29
    v_mfma_f32_16x16x32_bf16 v[16:19], a[108:111], a[76:79], v[16:19]
    ds_read_b64_tr_b16 a[208:209], v3 offset:33792
    ds_read_b64_tr_b16 a[210:211], v3 offset:34304
    v_mfma_f32_16x16x32_bf16 v[20:23], a[112:115], a[64:67], v[56:59]
    v_exp_f32 v30, v30
    v_mfma_f32_16x16x32_bf16 v[20:23], a[116:119], a[68:71], v[20:23]
    v_cvt_pk_bf16_f32 v38, v28, v29
    v_mfma_f32_16x16x32_bf16 v[20:23], a[120:123], a[72:75], v[20:23]
    v_exp_f32 v31, v31
    v_mfma_f32_16x16x32_bf16 v[20:23], a[124:127], a[76:79], v[20:23]
    ds_read_b64_tr_b16 a[212:213], v3 offset:33824
    ds_read_b64_tr_b16 a[214:215], v3 offset:34336
    v_mfma_f32_16x16x32_bf16 v[128:131], a[160:163], v[32:35], v[128:131]
    v_cvt_pk_bf16_f32 v39, v30, v31
    v_mfma_f32_16x16x32_bf16 v[132:135], a[164:167], v[32:35], v[132:135]
    v_exp_f32 v16, v16
    v_mfma_f32_16x16x32_bf16 v[136:139], a[168:171], v[32:35], v[136:139]
    s_add_u32 s71, s71, 1024
    s_and_b32 s71, s71, 0x3ffff
    v_mfma_f32_16x16x32_bf16 v[140:143], a[172:175], v[32:35], v[140:143]
    v_exp_f32 v17, v17
    v_mfma_f32_16x16x32_bf16 v[144:147], a[176:179], v[32:35], v[144:147]
    buffer_load_dwordx4 v0, s[52:55], s71 offen nt lds
    v_mfma_f32_16x16x32_bf16 v[148:151], a[180:183], v[32:35], v[148:151]
    v_exp_f32 v18, v18
    v_mfma_f32_16x16x32_bf16 v[152:155], a[184:187], v[32:35], v[152:155]
    v_mfma_f32_16x16x32_bf16 v[156:159], a[188:191], v[32:35], v[156:159]
    v_exp_f32 v19, v19
    v_mfma_f32_16x16x32_bf16 a[232:235], a[248:251], v[32:35], a[232:235]
    v_mfma_f32_16x16x32_bf16 v[24:27], a[96:99], a[80:83], v[60:63]
    v_exp_f32 v20, v20
    v_mfma_f32_16x16x32_bf16 v[24:27], a[100:103], a[84:87], v[24:27]
    v_cvt_pk_bf16_f32 v32, v16, v17
    v_cvt_pk_bf16_f32 v33, v18, v19
    v_mfma_f32_16x16x32_bf16 v[24:27], a[104:107], a[88:91], v[24:27]
    v_exp_f32 v21, v21
    v_mfma_f32_16x16x32_bf16 v[24:27], a[108:111], a[92:95], v[24:27]
    ds_read_b64_tr_b16 a[216:217], v3 offset:33856
    ds_read_b64_tr_b16 a[218:219], v3 offset:34368
    v_mfma_f32_16x16x32_bf16 v[28:31], a[112:115], a[80:83], v[60:63]
    v_exp_f32 v22, v22
    v_mfma_f32_16x16x32_bf16 v[28:31], a[116:119], a[84:87], v[28:31]
    v_cvt_pk_bf16_f32 v34, v20, v21
    v_mfma_f32_16x16x32_bf16 v[28:31], a[120:123], a[88:91], v[28:31]
    v_exp_f32 v23, v23
    v_mfma_f32_16x16x32_bf16 v[28:31], a[124:127], a[92:95], v[28:31]
    ds_read_b64_tr_b16 a[220:221], v3 offset:33888
    ds_read_b64_tr_b16 a[222:223], v3 offset:34400
    v_mfma_f32_16x16x32_bf16 v[160:163], a[160:163], v[36:39], v[160:163]
    v_cvt_pk_bf16_f32 v35, v22, v23
    v_mfma_f32_16x16x32_bf16 v[164:167], a[164:167], v[36:39], v[164:167]
    v_exp_f32 v24, v24
    v_mfma_f32_16x16x32_bf16 v[168:171], a[168:171], v[36:39], v[168:171]
    v_mfma_f32_16x16x32_bf16 v[172:175], a[172:175], v[36:39], v[172:175]
    v_exp_f32 v25, v25
    v_mfma_f32_16x16x32_bf16 v[176:179], a[176:179], v[36:39], v[176:179]
    v_mfma_f32_16x16x32_bf16 v[180:183], a[180:183], v[36:39], v[180:183]
    v_exp_f32 v26, v26
    v_mfma_f32_16x16x32_bf16 v[184:187], a[184:187], v[36:39], v[184:187]
    v_add_u32 v3, s74, v3
    v_mfma_f32_16x16x32_bf16 v[188:191], a[188:191], v[36:39], v[188:191]
    v_exp_f32 v27, v27
    v_mfma_f32_16x16x32_bf16 a[236:239], a[248:251], v[36:39], a[236:239]
    s_waitcnt vmcnt(8) lgkmcnt(0)
    s_barrier
    v_mfma_f32_16x16x32_bf16 v[16:19], a[128:131], a[0:3], v[40:43]
    v_exp_f32 v28, v28
    v_mfma_f32_16x16x32_bf16 v[16:19], a[132:135], a[4:7], v[16:19]
    v_cvt_pk_bf16_f32 v36, v24, v25
    v_cvt_pk_bf16_f32 v37, v26, v27
    v_mfma_f32_16x16x32_bf16 v[16:19], a[136:139], a[8:11], v[16:19]
    v_exp_f32 v29, v29
    v_mfma_f32_16x16x32_bf16 v[16:19], a[140:143], a[12:15], v[16:19]
    v_mfma_f32_16x16x32_bf16 v[20:23], a[144:147], a[0:3], v[40:43]
    v_exp_f32 v30, v30
    v_mfma_f32_16x16x32_bf16 v[20:23], a[148:151], a[4:7], v[20:23]
    v_cvt_pk_bf16_f32 v38, v28, v29
    v_mfma_f32_16x16x32_bf16 v[20:23], a[152:155], a[8:11], v[20:23]
    v_exp_f32 v31, v31
    v_mfma_f32_16x16x32_bf16 v[20:23], a[156:159], a[12:15], v[20:23]
    ds_read_b128 a[96:99], v2 offset:0
    ds_read_b128 a[100:103], v2 offset:64
    v_mfma_f32_16x16x32_bf16 v[192:195], a[160:163], v[32:35], v[192:195]
    v_cvt_pk_bf16_f32 v39, v30, v31
    v_mfma_f32_16x16x32_bf16 v[196:199], a[164:167], v[32:35], v[196:199]
    v_exp_f32 v16, v16
    v_mfma_f32_16x16x32_bf16 v[200:203], a[168:171], v[32:35], v[200:203]
    s_mov_b32 s15, 0x53800000
    s_mov_b64 s[12:13], 0
    v_mfma_f32_16x16x32_bf16 v[204:207], a[172:175], v[32:35], v[204:207]
    v_exp_f32 v17, v17
    v_mfma_f32_16x16x32_bf16 v[208:211], a[176:179], v[32:35], v[208:211]
    ds_read_b128 a[104:107], v2 offset:128
    ds_read_b128 a[108:111], v2 offset:192
    v_mfma_f32_16x16x32_bf16 v[212:215], a[180:183], v[32:35], v[212:215]
    v_exp_f32 v18, v18
    v_mfma_f32_16x16x32_bf16 v[216:219], a[184:187], v[32:35], v[216:219]
    s_mov_b32 s14, 0
    s_mul_i32 s10, s9, 49152
    v_mfma_f32_16x16x32_bf16 v[220:223], a[188:191], v[32:35], v[220:223]
    v_exp_f32 v19, v19
    v_mfma_f32_16x16x32_bf16 a[240:243], a[248:251], v[32:35], a[240:243]
    s_mul_i32 s11, s8, 6144
    s_add_u32 s10, s10, s11
    v_mfma_f32_16x16x32_bf16 v[24:27], a[128:131], a[16:19], v[44:47]
    v_exp_f32 v20, v20
    v_mfma_f32_16x16x32_bf16 v[24:27], a[132:135], a[20:23], v[24:27]
    v_cvt_pk_bf16_f32 v32, v16, v17
    v_cvt_pk_bf16_f32 v33, v18, v19
    v_mfma_f32_16x16x32_bf16 v[24:27], a[136:139], a[24:27], v[24:27]
    v_exp_f32 v21, v21
    v_mfma_f32_16x16x32_bf16 v[24:27], a[140:143], a[28:31], v[24:27]
    ds_read_b128 a[112:115], v2 offset:512
    ds_read_b128 a[116:119], v2 offset:576
    v_mfma_f32_16x16x32_bf16 v[28:31], a[144:147], a[16:19], v[44:47]
    v_exp_f32 v22, v22
    v_mfma_f32_16x16x32_bf16 v[28:31], a[148:151], a[20:23], v[28:31]
    v_cvt_pk_bf16_f32 v34, v20, v21
    v_mfma_f32_16x16x32_bf16 v[28:31], a[152:155], a[24:27], v[28:31]
    v_exp_f32 v23, v23
    v_mfma_f32_16x16x32_bf16 v[28:31], a[156:159], a[28:31], v[28:31]
    ds_read_b128 a[120:123], v2 offset:640
    ds_read_b128 a[124:127], v2 offset:704
    v_mfma_f32_16x16x32_bf16 v[224:227], a[160:163], v[36:39], v[224:227]
    v_cvt_pk_bf16_f32 v35, v22, v23
    v_mfma_f32_16x16x32_bf16 v[228:231], a[164:167], v[36:39], v[228:231]
    v_exp_f32 v24, v24
    v_mfma_f32_16x16x32_bf16 v[232:235], a[168:171], v[36:39], v[232:235]
    s_add_u32 s10, s10, 65536
    v_add_u32 v13, s10, v0
    v_mfma_f32_16x16x32_bf16 v[236:239], a[172:175], v[36:39], v[236:239]
    v_exp_f32 v25, v25
    v_mfma_f32_16x16x32_bf16 v[240:243], a[176:179], v[36:39], v[240:243]
    v_mfma_f32_16x16x32_bf16 v[244:247], a[180:183], v[36:39], v[244:247]
    v_exp_f32 v26, v26
    v_mfma_f32_16x16x32_bf16 v[248:251], a[184:187], v[36:39], v[248:251]
    v_mfma_f32_16x16x32_bf16 v[252:255], a[188:191], v[36:39], v[252:255]
    v_exp_f32 v27, v27
    v_mfma_f32_16x16x32_bf16 a[244:247], a[248:251], v[36:39], a[244:247]
    v_mfma_f32_16x16x32_bf16 v[16:19], a[128:131], a[32:35], v[48:51]
    v_exp_f32 v28, v28
    v_mfma_f32_16x16x32_bf16 v[16:19], a[132:135], a[36:39], v[16:19]
    v_cvt_pk_bf16_f32 v36, v24, v25
    v_cvt_pk_bf16_f32 v37, v26, v27
    v_mfma_f32_16x16x32_bf16 v[16:19], a[136:139], a[40:43], v[16:19]
    v_exp_f32 v29, v29
    v_mfma_f32_16x16x32_bf16 v[16:19], a[140:143], a[44:47], v[16:19]
    ds_read_b64_tr_b16 a[160:161], v3 offset:0
    ds_read_b64_tr_b16 a[162:163], v3 offset:512
    v_mfma_f32_16x16x32_bf16 v[20:23], a[144:147], a[32:35], v[48:51]
    v_exp_f32 v30, v30
    v_mfma_f32_16x16x32_bf16 v[20:23], a[148:151], a[36:39], v[20:23]
    v_cvt_pk_bf16_f32 v38, v28, v29
    v_mfma_f32_16x16x32_bf16 v[20:23], a[152:155], a[40:43], v[20:23]
    v_exp_f32 v31, v31
    v_mfma_f32_16x16x32_bf16 v[20:23], a[156:159], a[44:47], v[20:23]
    ds_read_b64_tr_b16 a[164:165], v3 offset:32
    ds_read_b64_tr_b16 a[166:167], v3 offset:544
    v_mfma_f32_16x16x32_bf16 v[64:67], a[192:195], v[32:35], v[64:67]
    v_cvt_pk_bf16_f32 v39, v30, v31
    v_mfma_f32_16x16x32_bf16 v[68:71], a[196:199], v[32:35], v[68:71]
    v_exp_f32 v16, v16
    v_mfma_f32_16x16x32_bf16 v[72:75], a[200:203], v[32:35], v[72:75]
    v_mfma_f32_16x16x32_bf16 v[76:79], a[204:207], v[32:35], v[76:79]
    v_exp_f32 v17, v17
    v_mfma_f32_16x16x32_bf16 v[80:83], a[208:211], v[32:35], v[80:83]
    v_mfma_f32_16x16x32_bf16 v[84:87], a[212:215], v[32:35], v[84:87]
    v_exp_f32 v18, v18
    v_mfma_f32_16x16x32_bf16 v[88:91], a[216:219], v[32:35], v[88:91]
    v_mfma_f32_16x16x32_bf16 v[92:95], a[220:223], v[32:35], v[92:95]
    v_exp_f32 v19, v19
    v_mfma_f32_16x16x32_bf16 a[224:227], a[248:251], v[32:35], a[224:227]
    v_mfma_f32_16x16x32_bf16 v[24:27], a[128:131], a[48:51], v[52:55]
    v_exp_f32 v20, v20
    v_mfma_f32_16x16x32_bf16 v[24:27], a[132:135], a[52:55], v[24:27]
    v_cvt_pk_bf16_f32 v32, v16, v17
    v_cvt_pk_bf16_f32 v33, v18, v19
    v_mfma_f32_16x16x32_bf16 v[24:27], a[136:139], a[56:59], v[24:27]
    v_exp_f32 v21, v21
    v_mfma_f32_16x16x32_bf16 v[24:27], a[140:143], a[60:63], v[24:27]
    ds_read_b64_tr_b16 a[168:169], v3 offset:64
    ds_read_b64_tr_b16 a[170:171], v3 offset:576
    v_mfma_f32_16x16x32_bf16 v[28:31], a[144:147], a[48:51], v[52:55]
    v_exp_f32 v22, v22
    v_mfma_f32_16x16x32_bf16 v[28:31], a[148:151], a[52:55], v[28:31]
    v_cvt_pk_bf16_f32 v34, v20, v21
    v_mfma_f32_16x16x32_bf16 v[28:31], a[152:155], a[56:59], v[28:31]
    v_exp_f32 v23, v23
    v_mfma_f32_16x16x32_bf16 v[28:31], a[156:159], a[60:63], v[28:31]
    ds_read_b64_tr_b16 a[172:173], v3 offset:96
    ds_read_b64_tr_b16 a[174:175], v3 offset:608
    v_mfma_f32_16x16x32_bf16 v[96:99], a[192:195], v[36:39], v[96:99]
    v_cvt_pk_bf16_f32 v35, v22, v23
    v_mfma_f32_16x16x32_bf16 v[100:103], a[196:199], v[36:39], v[100:103]
    v_exp_f32 v24, v24
    v_mfma_f32_16x16x32_bf16 v[104:107], a[200:203], v[36:39], v[104:107]
    v_mfma_f32_16x16x32_bf16 v[108:111], a[204:207], v[36:39], v[108:111]
    v_exp_f32 v25, v25
    v_mfma_f32_16x16x32_bf16 v[112:115], a[208:211], v[36:39], v[112:115]
    v_mfma_f32_16x16x32_bf16 v[116:119], a[212:215], v[36:39], v[116:119]
    v_exp_f32 v26, v26
    v_mfma_f32_16x16x32_bf16 v[120:123], a[216:219], v[36:39], v[120:123]
    v_mfma_f32_16x16x32_bf16 v[124:127], a[220:223], v[36:39], v[124:127]
    v_exp_f32 v27, v27
    v_mfma_f32_16x16x32_bf16 a[228:231], a[248:251], v[36:39], a[228:231]
    v_mfma_f32_16x16x32_bf16 v[16:19], a[128:131], a[64:67], v[56:59]
    v_exp_f32 v28, v28
    v_mfma_f32_16x16x32_bf16 v[16:19], a[132:135], a[68:71], v[16:19]
    v_cvt_pk_bf16_f32 v36, v24, v25
    v_cvt_pk_bf16_f32 v37, v26, v27
    v_mfma_f32_16x16x32_bf16 v[16:19], a[136:139], a[72:75], v[16:19]
    v_exp_f32 v29, v29
    v_mfma_f32_16x16x32_bf16 v[16:19], a[140:143], a[76:79], v[16:19]
    ds_read_b64_tr_b16 a[176:177], v3 offset:128
    ds_read_b64_tr_b16 a[178:179], v3 offset:640
    v_mfma_f32_16x16x32_bf16 v[20:23], a[144:147], a[64:67], v[56:59]
    v_exp_f32 v30, v30
    v_mfma_f32_16x16x32_bf16 v[20:23], a[148:151], a[68:71], v[20:23]
    v_cvt_pk_bf16_f32 v38, v28, v29
    v_mfma_f32_16x16x32_bf16 v[20:23], a[152:155], a[72:75], v[20:23]
    v_exp_f32 v31, v31
    v_mfma_f32_16x16x32_bf16 v[20:23], a[156:159], a[76:79], v[20:23]
    ds_read_b64_tr_b16 a[180:181], v3 offset:160
    ds_read_b64_tr_b16 a[182:183], v3 offset:672
    v_mfma_f32_16x16x32_bf16 v[128:131], a[192:195], v[32:35], v[128:131]
    v_cvt_pk_bf16_f32 v39, v30, v31
    v_mfma_f32_16x16x32_bf16 v[132:135], a[196:199], v[32:35], v[132:135]
    v_exp_f32 v16, v16
    v_mfma_f32_16x16x32_bf16 v[136:139], a[200:203], v[32:35], v[136:139]
    v_mfma_f32_16x16x32_bf16 v[140:143], a[204:207], v[32:35], v[140:143]
    v_exp_f32 v17, v17
    v_mfma_f32_16x16x32_bf16 v[144:147], a[208:211], v[32:35], v[144:147]
    v_mfma_f32_16x16x32_bf16 v[148:151], a[212:215], v[32:35], v[148:151]
    v_exp_f32 v18, v18
    v_mfma_f32_16x16x32_bf16 v[152:155], a[216:219], v[32:35], v[152:155]
    v_mfma_f32_16x16x32_bf16 v[156:159], a[220:223], v[32:35], v[156:159]
    v_exp_f32 v19, v19
    v_mfma_f32_16x16x32_bf16 a[232:235], a[248:251], v[32:35], a[232:235]
    v_mfma_f32_16x16x32_bf16 v[24:27], a[128:131], a[80:83], v[60:63]
    v_exp_f32 v20, v20
    v_mfma_f32_16x16x32_bf16 v[24:27], a[132:135], a[84:87], v[24:27]
    v_cvt_pk_bf16_f32 v32, v16, v17
    v_cvt_pk_bf16_f32 v33, v18, v19
    v_mfma_f32_16x16x32_bf16 v[24:27], a[136:139], a[88:91], v[24:27]
    v_exp_f32 v21, v21
    v_mfma_f32_16x16x32_bf16 v[24:27], a[140:143], a[92:95], v[24:27]
    ds_read_b64_tr_b16 a[184:185], v3 offset:192
    ds_read_b64_tr_b16 a[186:187], v3 offset:704
    v_mfma_f32_16x16x32_bf16 v[28:31], a[144:147], a[80:83], v[60:63]
    v_exp_f32 v22, v22
    v_mfma_f32_16x16x32_bf16 v[28:31], a[148:151], a[84:87], v[28:31]
    v_cvt_pk_bf16_f32 v34, v20, v21
    v_mfma_f32_16x16x32_bf16 v[28:31], a[152:155], a[88:91], v[28:31]
    v_exp_f32 v23, v23
    v_mfma_f32_16x16x32_bf16 v[28:31], a[156:159], a[92:95], v[28:31]
    ds_read_b64_tr_b16 a[188:189], v3 offset:224
    ds_read_b64_tr_b16 a[190:191], v3 offset:736
    v_mfma_f32_16x16x32_bf16 v[160:163], a[192:195], v[36:39], v[160:163]
    v_cvt_pk_bf16_f32 v35, v22, v23
    v_mfma_f32_16x16x32_bf16 v[164:167], a[196:199], v[36:39], v[164:167]
    v_exp_f32 v24, v24
    v_mfma_f32_16x16x32_bf16 v[168:171], a[200:203], v[36:39], v[168:171]
    v_mfma_f32_16x16x32_bf16 v[172:175], a[204:207], v[36:39], v[172:175]
    v_exp_f32 v25, v25
    v_mfma_f32_16x16x32_bf16 v[176:179], a[208:211], v[36:39], v[176:179]
    v_mfma_f32_16x16x32_bf16 v[180:183], a[212:215], v[36:39], v[180:183]
    v_exp_f32 v26, v26
    v_mfma_f32_16x16x32_bf16 v[184:187], a[216:219], v[36:39], v[184:187]
    s_sub_u32 s74, 0, s74
    v_mfma_f32_16x16x32_bf16 v[188:191], a[220:223], v[36:39], v[188:191]
    v_exp_f32 v27, v27
    v_mfma_f32_16x16x32_bf16 a[236:239], a[248:251], v[36:39], a[236:239]
    s_waitcnt vmcnt(0) lgkmcnt(0)
    s_barrier
    v_mfma_f32_16x16x32_bf16 v[16:19], a[96:99], a[0:3], v[40:43]
    v_exp_f32 v28, v28
    v_mfma_f32_16x16x32_bf16 v[16:19], a[100:103], a[4:7], v[16:19]
    v_cvt_pk_bf16_f32 v36, v24, v25
    v_cvt_pk_bf16_f32 v37, v26, v27
    v_mfma_f32_16x16x32_bf16 v[16:19], a[104:107], a[8:11], v[16:19]
    v_exp_f32 v29, v29
    v_mfma_f32_16x16x32_bf16 v[16:19], a[108:111], a[12:15], v[16:19]
    v_mfma_f32_16x16x32_bf16 v[20:23], a[112:115], a[0:3], v[40:43]
    v_exp_f32 v30, v30
    v_mfma_f32_16x16x32_bf16 v[20:23], a[116:119], a[4:7], v[20:23]
    v_cvt_pk_bf16_f32 v38, v28, v29
    v_mfma_f32_16x16x32_bf16 v[20:23], a[120:123], a[8:11], v[20:23]
    v_exp_f32 v31, v31
    v_mfma_f32_16x16x32_bf16 v[20:23], a[124:127], a[12:15], v[20:23]
    ds_read_b128 a[128:131], v2 offset:33664
    ds_read_b128 a[132:135], v2 offset:33728
    v_mfma_f32_16x16x32_bf16 v[192:195], a[192:195], v[32:35], v[192:195]
    v_cvt_pk_bf16_f32 v39, v30, v31
    v_mfma_f32_16x16x32_bf16 v[196:199], a[196:199], v[32:35], v[196:199]
    v_exp_f32 v16, v16
    v_mfma_f32_16x16x32_bf16 v[200:203], a[200:203], v[32:35], v[200:203]
    s_mul_i32 s64, s6, 327680
    s_add_u32 m0, s70, 0
    v_mfma_f32_16x16x32_bf16 v[204:207], a[204:207], v[32:35], v[204:207]
    v_exp_f32 v17, v17
    v_mfma_f32_16x16x32_bf16 v[208:211], a[208:211], v[32:35], v[208:211]
    ds_read_b128 a[136:139], v2 offset:33792
    ds_read_b128 a[140:143], v2 offset:33856
    v_mfma_f32_16x16x32_bf16 v[212:215], a[212:215], v[32:35], v[212:215]
    v_exp_f32 v18, v18
    v_mfma_f32_16x16x32_bf16 v[216:219], a[216:219], v[32:35], v[216:219]
    buffer_load_dwordx4 v4, s[84:87], s64 offen  lds
    s_add_u32 m0, s70, 1024
    v_mfma_f32_16x16x32_bf16 v[220:223], a[220:223], v[32:35], v[220:223]
    v_exp_f32 v19, v19
    v_mfma_f32_16x16x32_bf16 a[240:243], a[248:251], v[32:35], a[240:243]
    buffer_load_dwordx4 v5, s[84:87], s64 offen  lds
    s_add_u32 m0, s70, 2048
    v_mfma_f32_16x16x32_bf16 v[24:27], a[96:99], a[16:19], v[44:47]
    v_exp_f32 v20, v20
    v_mfma_f32_16x16x32_bf16 v[24:27], a[100:103], a[20:23], v[24:27]
    v_cvt_pk_bf16_f32 v32, v16, v17
    v_cvt_pk_bf16_f32 v33, v18, v19
    v_mfma_f32_16x16x32_bf16 v[24:27], a[104:107], a[24:27], v[24:27]
    v_exp_f32 v21, v21
    v_mfma_f32_16x16x32_bf16 v[24:27], a[108:111], a[28:31], v[24:27]
    ds_read_b128 a[144:147], v2 offset:34176
    ds_read_b128 a[148:151], v2 offset:34240
    v_mfma_f32_16x16x32_bf16 v[28:31], a[112:115], a[16:19], v[44:47]
    v_exp_f32 v22, v22
    v_mfma_f32_16x16x32_bf16 v[28:31], a[116:119], a[20:23], v[28:31]
    v_cvt_pk_bf16_f32 v34, v20, v21
    v_mfma_f32_16x16x32_bf16 v[28:31], a[120:123], a[24:27], v[28:31]
    v_exp_f32 v23, v23
    v_mfma_f32_16x16x32_bf16 v[28:31], a[124:127], a[28:31], v[28:31]
    ds_read_b128 a[152:155], v2 offset:34304
    ds_read_b128 a[156:159], v2 offset:34368
    v_mfma_f32_16x16x32_bf16 v[224:227], a[192:195], v[36:39], v[224:227]
    v_cvt_pk_bf16_f32 v35, v22, v23
    v_mfma_f32_16x16x32_bf16 v[228:231], a[196:199], v[36:39], v[228:231]
    v_exp_f32 v24, v24
    v_mfma_f32_16x16x32_bf16 v[232:235], a[200:203], v[36:39], v[232:235]
    buffer_load_dwordx4 v6, s[84:87], s64 offen  lds
    s_add_u32 m0, s70, 3072
    v_mfma_f32_16x16x32_bf16 v[236:239], a[204:207], v[36:39], v[236:239]
    v_exp_f32 v25, v25
    v_mfma_f32_16x16x32_bf16 v[240:243], a[208:211], v[36:39], v[240:243]
    buffer_load_dwordx4 v7, s[84:87], s64 offen  lds
    s_add_u32 m0, s70, 4096
    v_mfma_f32_16x16x32_bf16 v[244:247], a[212:215], v[36:39], v[244:247]
    v_exp_f32 v26, v26
    v_mfma_f32_16x16x32_bf16 v[248:251], a[216:219], v[36:39], v[248:251]
    buffer_load_dwordx4 v8, s[84:87], s64 offen  lds
    s_add_u32 s64, s64, 81920
    s_cmp_eq_u32 s64, 1310720
    s_cselect_b32 s64, 0, s64
    s_add_u32 m0, s70, 20480
    v_mfma_f32_16x16x32_bf16 v[252:255], a[220:223], v[36:39], v[252:255]
    v_exp_f32 v27, v27
    v_mfma_f32_16x16x32_bf16 a[244:247], a[248:251], v[36:39], a[244:247]
    buffer_load_dwordx4 v4, s[84:87], s64 offen  lds
    s_add_u32 m0, s70, 21504
    v_mfma_f32_16x16x32_bf16 v[16:19], a[96:99], a[32:35], v[48:51]
    v_exp_f32 v28, v28
    v_mfma_f32_16x16x32_bf16 v[16:19], a[100:103], a[36:39], v[16:19]
    v_cvt_pk_bf16_f32 v36, v24, v25
    v_cvt_pk_bf16_f32 v37, v26, v27
    v_mfma_f32_16x16x32_bf16 v[16:19], a[104:107], a[40:43], v[16:19]
    v_exp_f32 v29, v29
    v_mfma_f32_16x16x32_bf16 v[16:19], a[108:111], a[44:47], v[16:19]
    ds_read_b64_tr_b16 a[192:193], v3 offset:33664
    ds_read_b64_tr_b16 a[194:195], v3 offset:34176
    v_mfma_f32_16x16x32_bf16 v[20:23], a[112:115], a[32:35], v[48:51]
    v_exp_f32 v30, v30
    v_mfma_f32_16x16x32_bf16 v[20:23], a[116:119], a[36:39], v[20:23]
    v_cvt_pk_bf16_f32 v38, v28, v29
    v_mfma_f32_16x16x32_bf16 v[20:23], a[120:123], a[40:43], v[20:23]
    v_exp_f32 v31, v31
    v_mfma_f32_16x16x32_bf16 v[20:23], a[124:127], a[44:47], v[20:23]
    ds_read_b64_tr_b16 a[196:197], v3 offset:33696
    ds_read_b64_tr_b16 a[198:199], v3 offset:34208
    v_mfma_f32_16x16x32_bf16 v[64:67], a[160:163], v[32:35], v[64:67]
    v_cvt_pk_bf16_f32 v39, v30, v31
    v_mfma_f32_16x16x32_bf16 v[68:71], a[164:167], v[32:35], v[68:71]
    v_exp_f32 v16, v16
    v_mfma_f32_16x16x32_bf16 v[72:75], a[168:171], v[32:35], v[72:75]
    buffer_load_dwordx4 v5, s[84:87], s64 offen  lds
    s_add_u32 m0, s70, 22528
    v_mfma_f32_16x16x32_bf16 v[76:79], a[172:175], v[32:35], v[76:79]
    v_exp_f32 v17, v17
    v_mfma_f32_16x16x32_bf16 v[80:83], a[176:179], v[32:35], v[80:83]
    v_add_u32 v2, s74, v2
    v_mfma_f32_16x16x32_bf16 v[84:87], a[180:183], v[32:35], v[84:87]
    v_exp_f32 v18, v18
    v_mfma_f32_16x16x32_bf16 v[88:91], a[184:187], v[32:35], v[88:91]
    buffer_load_dwordx4 v6, s[84:87], s64 offen  lds
    s_add_u32 m0, s70, 23552
    v_mfma_f32_16x16x32_bf16 v[92:95], a[188:191], v[32:35], v[92:95]
    v_exp_f32 v19, v19
    v_mfma_f32_16x16x32_bf16 a[224:227], a[248:251], v[32:35], a[224:227]
    buffer_load_dwordx4 v7, s[84:87], s64 offen  lds
    s_add_u32 m0, s70, 24576
    v_mfma_f32_16x16x32_bf16 v[24:27], a[96:99], a[48:51], v[52:55]
    v_exp_f32 v20, v20
    v_mfma_f32_16x16x32_bf16 v[24:27], a[100:103], a[52:55], v[24:27]
    v_cvt_pk_bf16_f32 v32, v16, v17
    v_cvt_pk_bf16_f32 v33, v18, v19
    v_mfma_f32_16x16x32_bf16 v[24:27], a[104:107], a[56:59], v[24:27]
    v_exp_f32 v21, v21
    v_mfma_f32_16x16x32_bf16 v[24:27], a[108:111], a[60:63], v[24:27]
    ds_read_b64_tr_b16 a[200:201], v3 offset:33728
    ds_read_b64_tr_b16 a[202:203], v3 offset:34240
    v_mfma_f32_16x16x32_bf16 v[28:31], a[112:115], a[48:51], v[52:55]
    v_exp_f32 v22, v22
    v_mfma_f32_16x16x32_bf16 v[28:31], a[116:119], a[52:55], v[28:31]
    v_cvt_pk_bf16_f32 v34, v20, v21
    v_mfma_f32_16x16x32_bf16 v[28:31], a[120:123], a[56:59], v[28:31]
    v_exp_f32 v23, v23
    v_mfma_f32_16x16x32_bf16 v[28:31], a[124:127], a[60:63], v[28:31]
    ds_read_b64_tr_b16 a[204:205], v3 offset:33760
    ds_read_b64_tr_b16 a[206:207], v3 offset:34272
    v_mfma_f32_16x16x32_bf16 v[96:99], a[160:163], v[36:39], v[96:99]
    v_cvt_pk_bf16_f32 v35, v22, v23
    v_mfma_f32_16x16x32_bf16 v[100:103], a[164:167], v[36:39], v[100:103]
    v_exp_f32 v24, v24
    v_mfma_f32_16x16x32_bf16 v[104:107], a[168:171], v[36:39], v[104:107]
    buffer_load_dwordx4 v8, s[84:87], s64 offen  lds
    s_add_u32 s64, s64, 81920
    s_cmp_eq_u32 s64, 1310720
    s_cselect_b32 s64, 0, s64
    s_add_u32 m0, s70, 40960
    v_mfma_f32_16x16x32_bf16 v[108:111], a[172:175], v[36:39], v[108:111]
    v_exp_f32 v25, v25
    v_mfma_f32_16x16x32_bf16 v[112:115], a[176:179], v[36:39], v[112:115]
    buffer_load_dwordx4 v4, s[84:87], s64 offen  lds
    s_add_u32 m0, s70, 41984
    v_mfma_f32_16x16x32_bf16 v[116:119], a[180:183], v[36:39], v[116:119]
    v_exp_f32 v26, v26
    v_mfma_f32_16x16x32_bf16 v[120:123], a[184:187], v[36:39], v[120:123]
    buffer_load_dwordx4 v5, s[84:87], s64 offen  lds
    s_add_u32 m0, s70, 43008
    v_mfma_f32_16x16x32_bf16 v[124:127], a[188:191], v[36:39], v[124:127]
    v_exp_f32 v27, v27
    v_mfma_f32_16x16x32_bf16 a[228:231], a[248:251], v[36:39], a[228:231]
    buffer_load_dwordx4 v6, s[84:87], s64 offen  lds
    s_add_u32 m0, s70, 44032
    v_mfma_f32_16x16x32_bf16 v[16:19], a[96:99], a[64:67], v[56:59]
    v_exp_f32 v28, v28
    v_mfma_f32_16x16x32_bf16 v[16:19], a[100:103], a[68:71], v[16:19]
    v_cvt_pk_bf16_f32 v36, v24, v25
    v_cvt_pk_bf16_f32 v37, v26, v27
    v_mfma_f32_16x16x32_bf16 v[16:19], a[104:107], a[72:75], v[16:19]
    v_exp_f32 v29, v29
    v_mfma_f32_16x16x32_bf16 v[16:19], a[108:111], a[76:79], v[16:19]
    ds_read_b64_tr_b16 a[208:209], v3 offset:33792
    ds_read_b64_tr_b16 a[210:211], v3 offset:34304
    v_mfma_f32_16x16x32_bf16 v[20:23], a[112:115], a[64:67], v[56:59]
    v_exp_f32 v30, v30
    v_mfma_f32_16x16x32_bf16 v[20:23], a[116:119], a[68:71], v[20:23]
    v_cvt_pk_bf16_f32 v38, v28, v29
    v_mfma_f32_16x16x32_bf16 v[20:23], a[120:123], a[72:75], v[20:23]
    v_exp_f32 v31, v31
    v_mfma_f32_16x16x32_bf16 v[20:23], a[124:127], a[76:79], v[20:23]
    ds_read_b64_tr_b16 a[212:213], v3 offset:33824
    ds_read_b64_tr_b16 a[214:215], v3 offset:34336
    v_mfma_f32_16x16x32_bf16 v[128:131], a[160:163], v[32:35], v[128:131]
    v_cvt_pk_bf16_f32 v39, v30, v31
    v_mfma_f32_16x16x32_bf16 v[132:135], a[164:167], v[32:35], v[132:135]
    v_exp_f32 v16, v16
    v_mfma_f32_16x16x32_bf16 v[136:139], a[168:171], v[32:35], v[136:139]
    buffer_load_dwordx4 v7, s[84:87], s64 offen  lds
    s_add_u32 m0, s70, 45056
    v_mfma_f32_16x16x32_bf16 v[140:143], a[172:175], v[32:35], v[140:143]
    v_exp_f32 v17, v17
    v_mfma_f32_16x16x32_bf16 v[144:147], a[176:179], v[32:35], v[144:147]
    buffer_load_dwordx4 v8, s[84:87], s64 offen  lds
    s_add_u32 s64, s64, 81920
    s_cmp_eq_u32 s64, 1310720
    s_cselect_b32 s64, 0, s64
    v_mfma_f32_16x16x32_bf16 v[148:151], a[180:183], v[32:35], v[148:151]
    v_exp_f32 v18, v18
    v_mfma_f32_16x16x32_bf16 v[152:155], a[184:187], v[32:35], v[152:155]
    v_mfma_f32_16x16x32_bf16 v[156:159], a[188:191], v[32:35], v[156:159]
    v_exp_f32 v19, v19
    v_mfma_f32_16x16x32_bf16 a[232:235], a[248:251], v[32:35], a[232:235]
    v_mfma_f32_16x16x32_bf16 v[24:27], a[96:99], a[80:83], v[60:63]
    v_exp_f32 v20, v20
    v_mfma_f32_16x16x32_bf16 v[24:27], a[100:103], a[84:87], v[24:27]
    v_cvt_pk_bf16_f32 v32, v16, v17
    v_cvt_pk_bf16_f32 v33, v18, v19
    v_mfma_f32_16x16x32_bf16 v[24:27], a[104:107], a[88:91], v[24:27]
    v_exp_f32 v21, v21
    v_mfma_f32_16x16x32_bf16 v[24:27], a[108:111], a[92:95], v[24:27]
    ds_read_b64_tr_b16 a[216:217], v3 offset:33856
    ds_read_b64_tr_b16 a[218:219], v3 offset:34368
    v_mfma_f32_16x16x32_bf16 v[28:31], a[112:115], a[80:83], v[60:63]
    v_exp_f32 v22, v22
    v_mfma_f32_16x16x32_bf16 v[28:31], a[116:119], a[84:87], v[28:31]
    v_cvt_pk_bf16_f32 v34, v20, v21
    v_mfma_f32_16x16x32_bf16 v[28:31], a[120:123], a[88:91], v[28:31]
    v_exp_f32 v23, v23
    v_mfma_f32_16x16x32_bf16 v[28:31], a[124:127], a[92:95], v[28:31]
    ds_read_b64_tr_b16 a[220:221], v3 offset:33888
    ds_read_b64_tr_b16 a[222:223], v3 offset:34400
    v_mfma_f32_16x16x32_bf16 v[160:163], a[160:163], v[36:39], v[160:163]
    v_cvt_pk_bf16_f32 v35, v22, v23
    v_mfma_f32_16x16x32_bf16 v[164:167], a[164:167], v[36:39], v[164:167]
    v_exp_f32 v24, v24
    v_mfma_f32_16x16x32_bf16 v[168:171], a[168:171], v[36:39], v[168:171]
    v_mfma_f32_16x16x32_bf16 v[172:175], a[172:175], v[36:39], v[172:175]
    v_exp_f32 v25, v25
    v_mfma_f32_16x16x32_bf16 v[176:179], a[176:179], v[36:39], v[176:179]
    v_mfma_f32_16x16x32_bf16 v[180:183], a[180:183], v[36:39], v[180:183]
    v_exp_f32 v26, v26
    v_mfma_f32_16x16x32_bf16 v[184:187], a[184:187], v[36:39], v[184:187]
    v_add_u32 v3, s74, v3
    v_mfma_f32_16x16x32_bf16 v[188:191], a[188:191], v[36:39], v[188:191]
    v_exp_f32 v27, v27
    v_mfma_f32_16x16x32_bf16 a[236:239], a[248:251], v[36:39], a[236:239]
    s_waitcnt lgkmcnt(0)
    s_barrier
    v_mfma_f32_16x16x32_bf16 v[16:19], a[128:131], a[0:3], v[40:43]
    v_exp_f32 v28, v28
    v_mfma_f32_16x16x32_bf16 v[16:19], a[132:135], a[4:7], v[16:19]
    v_cvt_pk_bf16_f32 v36, v24, v25
    v_cvt_pk_bf16_f32 v37, v26, v27
    v_mfma_f32_16x16x32_bf16 v[16:19], a[136:139], a[8:11], v[16:19]
    v_exp_f32 v29, v29
    v_mfma_f32_16x16x32_bf16 v[16:19], a[140:143], a[12:15], v[16:19]
    v_mfma_f32_16x16x32_bf16 v[20:23], a[144:147], a[0:3], v[40:43]
    v_exp_f32 v30, v30
    v_mfma_f32_16x16x32_bf16 v[20:23], a[148:151], a[4:7], v[20:23]
    v_cvt_pk_bf16_f32 v38, v28, v29
    v_mfma_f32_16x16x32_bf16 v[20:23], a[152:155], a[8:11], v[20:23]
    v_exp_f32 v31, v31
    v_mfma_f32_16x16x32_bf16 v[20:23], a[156:159], a[12:15], v[20:23]
    v_mfma_f32_16x16x32_bf16 v[192:195], a[160:163], v[32:35], v[192:195]
    v_cvt_pk_bf16_f32 v39, v30, v31
    v_mfma_f32_16x16x32_bf16 v[196:199], a[164:167], v[32:35], v[196:199]
    v_exp_f32 v16, v16
    v_mfma_f32_16x16x32_bf16 v[200:203], a[168:171], v[32:35], v[200:203]
    v_mfma_f32_16x16x32_bf16 v[204:207], a[172:175], v[32:35], v[204:207]
    v_exp_f32 v17, v17
    v_mfma_f32_16x16x32_bf16 v[208:211], a[176:179], v[32:35], v[208:211]
    v_mfma_f32_16x16x32_bf16 v[212:215], a[180:183], v[32:35], v[212:215]
    v_exp_f32 v18, v18
    v_mfma_f32_16x16x32_bf16 v[216:219], a[184:187], v[32:35], v[216:219]
    v_mfma_f32_16x16x32_bf16 v[220:223], a[188:191], v[32:35], v[220:223]
    v_exp_f32 v19, v19
    v_mfma_f32_16x16x32_bf16 a[240:243], a[248:251], v[32:35], a[240:243]
    v_mfma_f32_16x16x32_bf16 v[24:27], a[128:131], a[16:19], v[44:47]
    v_exp_f32 v20, v20
    v_mfma_f32_16x16x32_bf16 v[24:27], a[132:135], a[20:23], v[24:27]
    v_cvt_pk_bf16_f32 v32, v16, v17
    v_cvt_pk_bf16_f32 v33, v18, v19
    v_mfma_f32_16x16x32_bf16 v[24:27], a[136:139], a[24:27], v[24:27]
    v_exp_f32 v21, v21
    v_mfma_f32_16x16x32_bf16 v[24:27], a[140:143], a[28:31], v[24:27]
    v_mfma_f32_16x16x32_bf16 v[28:31], a[144:147], a[16:19], v[44:47]
    v_exp_f32 v22, v22
    v_mfma_f32_16x16x32_bf16 v[28:31], a[148:151], a[20:23], v[28:31]
    v_cvt_pk_bf16_f32 v34, v20, v21
    v_mfma_f32_16x16x32_bf16 v[28:31], a[152:155], a[24:27], v[28:31]
    v_exp_f32 v23, v23
    v_mfma_f32_16x16x32_bf16 v[28:31], a[156:159], a[28:31], v[28:31]
    v_mfma_f32_16x16x32_bf16 v[224:227], a[160:163], v[36:39], v[224:227]
    v_cvt_pk_bf16_f32 v35, v22, v23
    v_mfma_f32_16x16x32_bf16 v[228:231], a[164:167], v[36:39], v[228:231]
    v_exp_f32 v24, v24
    v_mfma_f32_16x16x32_bf16 v[232:235], a[168:171], v[36:39], v[232:235]
    v_mfma_f32_16x16x32_bf16 v[236:239], a[172:175], v[36:39], v[236:239]
    v_exp_f32 v25, v25
    v_mfma_f32_16x16x32_bf16 v[240:243], a[176:179], v[36:39], v[240:243]
    v_mfma_f32_16x16x32_bf16 v[244:247], a[180:183], v[36:39], v[244:247]
    v_exp_f32 v26, v26
    v_mfma_f32_16x16x32_bf16 v[248:251], a[184:187], v[36:39], v[248:251]
    v_mfma_f32_16x16x32_bf16 v[252:255], a[188:191], v[36:39], v[252:255]
    v_exp_f32 v27, v27
    v_mfma_f32_16x16x32_bf16 a[244:247], a[248:251], v[36:39], a[244:247]
    v_mfma_f32_16x16x32_bf16 v[16:19], a[128:131], a[32:35], v[48:51]
    v_exp_f32 v28, v28
    v_mfma_f32_16x16x32_bf16 v[16:19], a[132:135], a[36:39], v[16:19]
    v_cvt_pk_bf16_f32 v36, v24, v25
    v_cvt_pk_bf16_f32 v37, v26, v27
    v_mfma_f32_16x16x32_bf16 v[16:19], a[136:139], a[40:43], v[16:19]
    v_exp_f32 v29, v29
    v_mfma_f32_16x16x32_bf16 v[16:19], a[140:143], a[44:47], v[16:19]
    v_mfma_f32_16x16x32_bf16 v[20:23], a[144:147], a[32:35], v[48:51]
    v_exp_f32 v30, v30
    v_mfma_f32_16x16x32_bf16 v[20:23], a[148:151], a[36:39], v[20:23]
    v_cvt_pk_bf16_f32 v38, v28, v29
    v_mfma_f32_16x16x32_bf16 v[20:23], a[152:155], a[40:43], v[20:23]
    v_exp_f32 v31, v31
    v_mfma_f32_16x16x32_bf16 v[20:23], a[156:159], a[44:47], v[20:23]
    v_mfma_f32_16x16x32_bf16 v[64:67], a[192:195], v[32:35], v[64:67]
    v_cvt_pk_bf16_f32 v39, v30, v31
    v_mfma_f32_16x16x32_bf16 v[68:71], a[196:199], v[32:35], v[68:71]
    v_exp_f32 v16, v16
    v_mfma_f32_16x16x32_bf16 v[72:75], a[200:203], v[32:35], v[72:75]
    v_mfma_f32_16x16x32_bf16 v[76:79], a[204:207], v[32:35], v[76:79]
    v_exp_f32 v17, v17
    v_mfma_f32_16x16x32_bf16 v[80:83], a[208:211], v[32:35], v[80:83]
    v_mfma_f32_16x16x32_bf16 v[84:87], a[212:215], v[32:35], v[84:87]
    v_exp_f32 v18, v18
    v_mfma_f32_16x16x32_bf16 v[88:91], a[216:219], v[32:35], v[88:91]
    v_mfma_f32_16x16x32_bf16 v[92:95], a[220:223], v[32:35], v[92:95]
    v_exp_f32 v19, v19
    v_mfma_f32_16x16x32_bf16 a[224:227], a[248:251], v[32:35], a[224:227]
    v_mfma_f32_16x16x32_bf16 v[24:27], a[128:131], a[48:51], v[52:55]
    v_exp_f32 v20, v20
    v_mfma_f32_16x16x32_bf16 v[24:27], a[132:135], a[52:55], v[24:27]
    v_cvt_pk_bf16_f32 v32, v16, v17
    v_cvt_pk_bf16_f32 v33, v18, v19
    v_mfma_f32_16x16x32_bf16 v[24:27], a[136:139], a[56:59], v[24:27]
    v_exp_f32 v21, v21
    v_mfma_f32_16x16x32_bf16 v[24:27], a[140:143], a[60:63], v[24:27]
    v_mfma_f32_16x16x32_bf16 v[28:31], a[144:147], a[48:51], v[52:55]
    v_exp_f32 v22, v22
    v_accvgpr_read_b32 v40, a224
    v_cmp_nge_f32 vcc, s15, v40
    v_rcp_f32 v40, v40
    v_mfma_f32_16x16x32_bf16 v[28:31], a[148:151], a[52:55], v[28:31]
    v_cvt_pk_bf16_f32 v34, v20, v21
    s_nop 0
    s_or_b64 s[12:13], s[12:13], vcc
    v_pk_mul_f32 v[64:65], v[64:65], v[40:41] op_sel_hi:[1,0]
    v_mfma_f32_16x16x32_bf16 v[28:31], a[152:155], a[56:59], v[28:31]
    v_exp_f32 v23, v23
    v_pk_mul_f32 v[66:67], v[66:67], v[40:41] op_sel_hi:[1,0]
    v_pk_mul_f32 v[68:69], v[68:69], v[40:41] op_sel_hi:[1,0]
    v_pk_mul_f32 v[70:71], v[70:71], v[40:41] op_sel_hi:[1,0]
    v_mfma_f32_16x16x32_bf16 v[28:31], a[156:159], a[60:63], v[28:31]
    v_cvt_pk_bf16_f32 v64, v64, v65
    v_cvt_pk_bf16_f32 v65, v66, v67
    v_mfma_f32_16x16x32_bf16 v[96:99], a[192:195], v[36:39], v[96:99]
    v_cvt_pk_bf16_f32 v35, v22, v23
    v_cvt_pk_bf16_f32 v66, v68, v69
    v_cvt_pk_bf16_f32 v67, v70, v71
    buffer_store_dwordx4 v[64:67], v0, s[56:59], s14 offen offset:0 sc1
    v_mfma_f32_16x16x32_bf16 v[100:103], a[196:199], v[36:39], v[100:103]
    v_exp_f32 v24, v24
    ds_write_b128 v13, v[64:67] offset:0
    v_pk_mul_f32 v[72:73], v[72:73], v[40:41] op_sel_hi:[1,0]
    v_pk_mul_f32 v[74:75], v[74:75], v[40:41] op_sel_hi:[1,0]
    v_mfma_f32_16x16x32_bf16 v[104:107], a[200:203], v[36:39], v[104:107]
    v_pk_mul_f32 v[76:77], v[76:77], v[40:41] op_sel_hi:[1,0]
    v_pk_mul_f32 v[78:79], v[78:79], v[40:41] op_sel_hi:[1,0]
    v_mfma_f32_16x16x32_bf16 v[108:111], a[204:207], v[36:39], v[108:111]
    v_exp_f32 v25, v25
    v_cvt_pk_bf16_f32 v72, v72, v73
    v_cvt_pk_bf16_f32 v73, v74, v75
    v_cvt_pk_bf16_f32 v74, v76, v77
    v_mfma_f32_16x16x32_bf16 v[112:115], a[208:211], v[36:39], v[112:115]
    v_cvt_pk_bf16_f32 v75, v78, v79
    buffer_store_dwordx4 v[72:75], v0, s[56:59], s14 offen offset:1024 sc1
    ds_write_b128 v13, v[72:75] offset:12288
    v_mfma_f32_16x16x32_bf16 v[116:119], a[212:215], v[36:39], v[116:119]
    v_exp_f32 v26, v26
    v_pk_mul_f32 v[80:81], v[80:81], v[40:41] op_sel_hi:[1,0]
    v_pk_mul_f32 v[82:83], v[82:83], v[40:41] op_sel_hi:[1,0]
    v_pk_mul_f32 v[84:85], v[84:85], v[40:41] op_sel_hi:[1,0]
    v_mfma_f32_16x16x32_bf16 v[120:123], a[216:219], v[36:39], v[120:123]
    v_pk_mul_f32 v[86:87], v[86:87], v[40:41] op_sel_hi:[1,0]
    v_cvt_pk_bf16_f32 v80, v80, v81
    v_mfma_f32_16x16x32_bf16 v[124:127], a[220:223], v[36:39], v[124:127]
    v_exp_f32 v27, v27
    v_cvt_pk_bf16_f32 v81, v82, v83
    v_cvt_pk_bf16_f32 v82, v84, v85
    v_cvt_pk_bf16_f32 v83, v86, v87
    v_mfma_f32_16x16x32_bf16 a[228:231], a[248:251], v[36:39], a[228:231]
    buffer_store_dwordx4 v[80:83], v0, s[56:59], s14 offen offset:2048 sc1
    ds_write_b128 v13, v[80:83] offset:24576
    v_pk_mul_f32 v[88:89], v[88:89], v[40:41] op_sel_hi:[1,0]
    v_mfma_f32_16x16x32_bf16 v[16:19], a[128:131], a[64:67], v[56:59]
    v_exp_f32 v28, v28
    v_pk_mul_f32 v[90:91], v[90:91], v[40:41] op_sel_hi:[1,0]
    v_pk_mul_f32 v[92:93], v[92:93], v[40:41] op_sel_hi:[1,0]
    v_mfma_f32_16x16x32_bf16 v[16:19], a[132:135], a[68:71], v[16:19]
    v_cvt_pk_bf16_f32 v36, v24, v25
    v_cvt_pk_bf16_f32 v37, v26, v27
    v_pk_mul_f32 v[94:95], v[94:95], v[40:41] op_sel_hi:[1,0]
    v_cvt_pk_bf16_f32 v88, v88, v89
    v_cvt_pk_bf16_f32 v89, v90, v91
    v_mfma_f32_16x16x32_bf16 v[16:19], a[136:139], a[72:75], v[16:19]
    v_exp_f32 v29, v29
    v_cvt_pk_bf16_f32 v90, v92, v93
    v_cvt_pk_bf16_f32 v91, v94, v95
    buffer_store_dwordx4 v[88:91], v0, s[56:59], s14 offen offset:3072 sc1
    v_mfma_f32_16x16x32_bf16 v[16:19], a[140:143], a[76:79], v[16:19]
    ds_write_b128 v13, v[88:91] offset:36864
    s_add_u32 s14, s14, 131072
    v_mfma_f32_16x16x32_bf16 v[20:23], a[144:147], a[64:67], v[56:59]
    v_exp_f32 v30, v30
    v_accvgpr_read_b32 v44, a228
    v_cmp_nge_f32 vcc, s15, v44
    v_rcp_f32 v44, v44
    v_mfma_f32_16x16x32_bf16 v[20:23], a[148:151], a[68:71], v[20:23]
    v_cvt_pk_bf16_f32 v38, v28, v29
    s_nop 0
    s_or_b64 s[12:13], s[12:13], vcc
    v_pk_mul_f32 v[96:97], v[96:97], v[44:45] op_sel_hi:[1,0]
    v_mfma_f32_16x16x32_bf16 v[20:23], a[152:155], a[72:75], v[20:23]
    v_exp_f32 v31, v31
    v_pk_mul_f32 v[98:99], v[98:99], v[44:45] op_sel_hi:[1,0]
    v_pk_mul_f32 v[100:101], v[100:101], v[44:45] op_sel_hi:[1,0]
    v_pk_mul_f32 v[102:103], v[102:103], v[44:45] op_sel_hi:[1,0]
    v_mfma_f32_16x16x32_bf16 v[20:23], a[156:159], a[76:79], v[20:23]
    v_cvt_pk_bf16_f32 v96, v96, v97
    v_cvt_pk_bf16_f32 v97, v98, v99
    v_mfma_f32_16x16x32_bf16 v[128:131], a[192:195], v[32:35], v[128:131]
    v_cvt_pk_bf16_f32 v39, v30, v31
    v_cvt_pk_bf16_f32 v98, v100, v101
    v_cvt_pk_bf16_f32 v99, v102, v103
    buffer_store_dwordx4 v[96:99], v0, s[56:59], s14 offen offset:0 sc1
    v_mfma_f32_16x16x32_bf16 v[132:135], a[196:199], v[32:35], v[132:135]
    v_exp_f32 v16, v16
    ds_write_b128 v13, v[96:99] offset:1024
    v_pk_mul_f32 v[104:105], v[104:105], v[44:45] op_sel_hi:[1,0]
    v_pk_mul_f32 v[106:107], v[106:107], v[44:45] op_sel_hi:[1,0]
    v_mfma_f32_16x16x32_bf16 v[136:139], a[200:203], v[32:35], v[136:139]
    v_pk_mul_f32 v[108:109], v[108:109], v[44:45] op_sel_hi:[1,0]
    v_pk_mul_f32 v[110:111], v[110:111], v[44:45] op_sel_hi:[1,0]
    v_mfma_f32_16x16x32_bf16 v[140:143], a[204:207], v[32:35], v[140:143]
    v_exp_f32 v17, v17
    v_cvt_pk_bf16_f32 v104, v104, v105
    v_cvt_pk_bf16_f32 v105, v106, v107
    v_cvt_pk_bf16_f32 v106, v108, v109
    v_mfma_f32_16x16x32_bf16 v[144:147], a[208:211], v[32:35], v[144:147]
    v_cvt_pk_bf16_f32 v107, v110, v111
    buffer_store_dwordx4 v[104:107], v0, s[56:59], s14 offen offset:1024 sc1
    ds_write_b128 v13, v[104:107] offset:13312
    v_mfma_f32_16x16x32_bf16 v[148:151], a[212:215], v[32:35], v[148:151]
    v_exp_f32 v18, v18
    v_pk_mul_f32 v[112:113], v[112:113], v[44:45] op_sel_hi:[1,0]
    v_pk_mul_f32 v[114:115], v[114:115], v[44:45] op_sel_hi:[1,0]
    v_pk_mul_f32 v[116:117], v[116:117], v[44:45] op_sel_hi:[1,0]
    v_mfma_f32_16x16x32_bf16 v[152:155], a[216:219], v[32:35], v[152:155]
    v_pk_mul_f32 v[118:119], v[118:119], v[44:45] op_sel_hi:[1,0]
    v_cvt_pk_bf16_f32 v112, v112, v113
    v_mfma_f32_16x16x32_bf16 v[156:159], a[220:223], v[32:35], v[156:159]
    v_exp_f32 v19, v19
    v_cvt_pk_bf16_f32 v113, v114, v115
    v_cvt_pk_bf16_f32 v114, v116, v117
    v_cvt_pk_bf16_f32 v115, v118, v119
    v_mfma_f32_16x16x32_bf16 a[232:235], a[248:251], v[32:35], a[232:235]
    buffer_store_dwordx4 v[112:115], v0, s[56:59], s14 offen offset:2048 sc1
    ds_write_b128 v13, v[112:115] offset:25600
    v_pk_mul_f32 v[120:121], v[120:121], v[44:45] op_sel_hi:[1,0]
    v_mfma_f32_16x16x32_bf16 v[24:27], a[128:131], a[80:83], v[60:63]
    v_exp_f32 v20, v20
    v_pk_mul_f32 v[122:123], v[122:123], v[44:45] op_sel_hi:[1,0]
    v_pk_mul_f32 v[124:125], v[124:125], v[44:45] op_sel_hi:[1,0]
    v_mfma_f32_16x16x32_bf16 v[24:27], a[132:135], a[84:87], v[24:27]
    v_cvt_pk_bf16_f32 v32, v16, v17
    v_cvt_pk_bf16_f32 v33, v18, v19
    v_pk_mul_f32 v[126:127], v[126:127], v[44:45] op_sel_hi:[1,0]
    v_cvt_pk_bf16_f32 v120, v120, v121
    v_cvt_pk_bf16_f32 v121, v122, v123
    v_mfma_f32_16x16x32_bf16 v[24:27], a[136:139], a[88:91], v[24:27]
    v_exp_f32 v21, v21
    v_cvt_pk_bf16_f32 v122, v124, v125
    v_cvt_pk_bf16_f32 v123, v126, v127
    buffer_store_dwordx4 v[120:123], v0, s[56:59], s14 offen offset:3072 sc1
    v_mfma_f32_16x16x32_bf16 v[24:27], a[140:143], a[92:95], v[24:27]
    ds_write_b128 v13, v[120:123] offset:37888
    s_add_u32 s14, s14, 131072
    v_mfma_f32_16x16x32_bf16 v[28:31], a[144:147], a[80:83], v[60:63]
    v_exp_f32 v22, v22
    v_accvgpr_read_b32 v48, a232
    v_cmp_nge_f32 vcc, s15, v48
    v_rcp_f32 v48, v48
    v_mfma_f32_16x16x32_bf16 v[28:31], a[148:151], a[84:87], v[28:31]
    v_cvt_pk_bf16_f32 v34, v20, v21
    s_nop 0
    s_or_b64 s[12:13], s[12:13], vcc
    v_pk_mul_f32 v[128:129], v[128:129], v[48:49] op_sel_hi:[1,0]
    v_mfma_f32_16x16x32_bf16 v[28:31], a[152:155], a[88:91], v[28:31]
    v_exp_f32 v23, v23
    v_pk_mul_f32 v[130:131], v[130:131], v[48:49] op_sel_hi:[1,0]
    v_pk_mul_f32 v[132:133], v[132:133], v[48:49] op_sel_hi:[1,0]
    v_pk_mul_f32 v[134:135], v[134:135], v[48:49] op_sel_hi:[1,0]
    v_mfma_f32_16x16x32_bf16 v[28:31], a[156:159], a[92:95], v[28:31]
    v_cvt_pk_bf16_f32 v128, v128, v129
    v_cvt_pk_bf16_f32 v129, v130, v131
    v_mfma_f32_16x16x32_bf16 v[160:163], a[192:195], v[36:39], v[160:163]
    v_cvt_pk_bf16_f32 v35, v22, v23
    v_cvt_pk_bf16_f32 v130, v132, v133
    v_cvt_pk_bf16_f32 v131, v134, v135
    buffer_store_dwordx4 v[128:131], v0, s[56:59], s14 offen offset:0 sc1
    v_mfma_f32_16x16x32_bf16 v[164:167], a[196:199], v[36:39], v[164:167]
    v_exp_f32 v24, v24
    ds_write_b128 v13, v[128:131] offset:2048
    v_pk_mul_f32 v[136:137], v[136:137], v[48:49] op_sel_hi:[1,0]
    v_pk_mul_f32 v[138:139], v[138:139], v[48:49] op_sel_hi:[1,0]
    v_mfma_f32_16x16x32_bf16 v[168:171], a[200:203], v[36:39], v[168:171]
    v_pk_mul_f32 v[140:141], v[140:141], v[48:49] op_sel_hi:[1,0]
    v_pk_mul_f32 v[142:143], v[142:143], v[48:49] op_sel_hi:[1,0]
    v_mfma_f32_16x16x32_bf16 v[172:175], a[204:207], v[36:39], v[172:175]
    v_exp_f32 v25, v25
    v_cvt_pk_bf16_f32 v136, v136, v137
    v_cvt_pk_bf16_f32 v137, v138, v139
    v_cvt_pk_bf16_f32 v138, v140, v141
    v_mfma_f32_16x16x32_bf16 v[176:179], a[208:211], v[36:39], v[176:179]
    v_cvt_pk_bf16_f32 v139, v142, v143
    buffer_store_dwordx4 v[136:139], v0, s[56:59], s14 offen offset:1024 sc1
    ds_write_b128 v13, v[136:139] offset:14336
    v_mfma_f32_16x16x32_bf16 v[180:183], a[212:215], v[36:39], v[180:183]
    v_exp_f32 v26, v26
    v_pk_mul_f32 v[144:145], v[144:145], v[48:49] op_sel_hi:[1,0]
    v_pk_mul_f32 v[146:147], v[146:147], v[48:49] op_sel_hi:[1,0]
    v_pk_mul_f32 v[148:149], v[148:149], v[48:49] op_sel_hi:[1,0]
    v_mfma_f32_16x16x32_bf16 v[184:187], a[216:219], v[36:39], v[184:187]
    s_sub_u32 s74, 0, s74
    v_pk_mul_f32 v[150:151], v[150:151], v[48:49] op_sel_hi:[1,0]
    v_cvt_pk_bf16_f32 v144, v144, v145
    v_mfma_f32_16x16x32_bf16 v[188:191], a[220:223], v[36:39], v[188:191]
    v_exp_f32 v27, v27
    v_cvt_pk_bf16_f32 v145, v146, v147
    v_cvt_pk_bf16_f32 v146, v148, v149
    v_cvt_pk_bf16_f32 v147, v150, v151
    v_mfma_f32_16x16x32_bf16 a[236:239], a[248:251], v[36:39], a[236:239]
    buffer_store_dwordx4 v[144:147], v0, s[56:59], s14 offen offset:2048 sc1
    ds_write_b128 v13, v[144:147] offset:26624
    v_pk_mul_f32 v[152:153], v[152:153], v[48:49] op_sel_hi:[1,0]
    v_mfma_f32_16x16x32_bf16 v[192:195], a[192:195], v[32:35], v[192:195]
    v_exp_f32 v28, v28
    v_pk_mul_f32 v[154:155], v[154:155], v[48:49] op_sel_hi:[1,0]
    v_pk_mul_f32 v[156:157], v[156:157], v[48:49] op_sel_hi:[1,0]
    v_mfma_f32_16x16x32_bf16 v[196:199], a[196:199], v[32:35], v[196:199]
    v_cvt_pk_bf16_f32 v36, v24, v25
    v_cvt_pk_bf16_f32 v37, v26, v27
    v_pk_mul_f32 v[158:159], v[158:159], v[48:49] op_sel_hi:[1,0]
    v_cvt_pk_bf16_f32 v152, v152, v153
    v_cvt_pk_bf16_f32 v153, v154, v155
    v_mfma_f32_16x16x32_bf16 v[200:203], a[200:203], v[32:35], v[200:203]
    v_exp_f32 v29, v29
    v_cvt_pk_bf16_f32 v154, v156, v157
    v_cvt_pk_bf16_f32 v155, v158, v159
    buffer_store_dwordx4 v[152:155], v0, s[56:59], s14 offen offset:3072 sc1
    v_mfma_f32_16x16x32_bf16 v[204:207], a[204:207], v[32:35], v[204:207]
    v_exp_f32 v30, v30
    ds_write_b128 v13, v[152:155] offset:38912
    s_add_u32 s14, s14, 131072
    v_mfma_f32_16x16x32_bf16 v[208:211], a[208:211], v[32:35], v[208:211]
    v_cvt_pk_bf16_f32 v38, v28, v29
    v_accvgpr_read_b32 v52, a236
    v_cmp_nge_f32 vcc, s15, v52
    v_rcp_f32 v52, v52
    s_nop 0
    s_or_b64 s[12:13], s[12:13], vcc
    v_pk_mul_f32 v[160:161], v[160:161], v[52:53] op_sel_hi:[1,0]
    v_mfma_f32_16x16x32_bf16 v[212:215], a[212:215], v[32:35], v[212:215]
    v_exp_f32 v31, v31
    v_pk_mul_f32 v[162:163], v[162:163], v[52:53] op_sel_hi:[1,0]
    v_pk_mul_f32 v[164:165], v[164:165], v[52:53] op_sel_hi:[1,0]
    v_pk_mul_f32 v[166:167], v[166:167], v[52:53] op_sel_hi:[1,0]
    v_cvt_pk_bf16_f32 v160, v160, v161
    v_cvt_pk_bf16_f32 v161, v162, v163
    v_mfma_f32_16x16x32_bf16 v[216:219], a[216:219], v[32:35], v[216:219]
    v_cvt_pk_bf16_f32 v162, v164, v165
    v_cvt_pk_bf16_f32 v163, v166, v167
    buffer_store_dwordx4 v[160:163], v0, s[56:59], s14 offen offset:0 sc1
    ds_write_b128 v13, v[160:163] offset:3072
    v_pk_mul_f32 v[168:169], v[168:169], v[52:53] op_sel_hi:[1,0]
    v_mfma_f32_16x16x32_bf16 v[220:223], a[220:223], v[32:35], v[220:223]
    v_cvt_pk_bf16_f32 v39, v30, v31
    v_pk_mul_f32 v[170:171], v[170:171], v[52:53] op_sel_hi:[1,0]
    v_pk_mul_f32 v[172:173], v[172:173], v[52:53] op_sel_hi:[1,0]
    v_pk_mul_f32 v[174:175], v[174:175], v[52:53] op_sel_hi:[1,0]
    v_cvt_pk_bf16_f32 v168, v168, v169
    v_cvt_pk_bf16_f32 v169, v170, v171
    v_mfma_f32_16x16x32_bf16 a[240:243], a[248:251], v[32:35], a[240:243]
    v_cvt_pk_bf16_f32 v170, v172, v173
    v_cvt_pk_bf16_f32 v171, v174, v175
    buffer_store_dwordx4 v[168:171], v0, s[56:59], s14 offen offset:1024 sc1
    ds_write_b128 v13, v[168:171] offset:15360
    v_pk_mul_f32 v[176:177], v[176:177], v[52:53] op_sel_hi:[1,0]
    v_mfma_f32_16x16x32_bf16 v[224:227], a[192:195], v[36:39], v[224:227]
    v_pk_mul_f32 v[178:179], v[178:179], v[52:53] op_sel_hi:[1,0]
    v_pk_mul_f32 v[180:181], v[180:181], v[52:53] op_sel_hi:[1,0]
    v_pk_mul_f32 v[182:183], v[182:183], v[52:53] op_sel_hi:[1,0]
    v_cvt_pk_bf16_f32 v176, v176, v177
    v_cvt_pk_bf16_f32 v177, v178, v179
    v_mfma_f32_16x16x32_bf16 v[228:231], a[196:199], v[36:39], v[228:231]
    v_cvt_pk_bf16_f32 v178, v180, v181
    v_cvt_pk_bf16_f32 v179, v182, v183
    buffer_store_dwordx4 v[176:179], v0, s[56:59], s14 offen offset:2048 sc1
    ds_write_b128 v13, v[176:179] offset:27648
    v_pk_mul_f32 v[184:185], v[184:185], v[52:53] op_sel_hi:[1,0]
    v_mfma_f32_16x16x32_bf16 v[232:235], a[200:203], v[36:39], v[232:235]
    v_pk_mul_f32 v[186:187], v[186:187], v[52:53] op_sel_hi:[1,0]
    v_pk_mul_f32 v[188:189], v[188:189], v[52:53] op_sel_hi:[1,0]
    v_pk_mul_f32 v[190:191], v[190:191], v[52:53] op_sel_hi:[1,0]
    v_cvt_pk_bf16_f32 v184, v184, v185
    v_cvt_pk_bf16_f32 v185, v186, v187
    v_mfma_f32_16x16x32_bf16 v[236:239], a[204:207], v[36:39], v[236:239]
    v_cvt_pk_bf16_f32 v186, v188, v189
    v_cvt_pk_bf16_f32 v187, v190, v191
    buffer_store_dwordx4 v[184:187], v0, s[56:59], s14 offen offset:3072 sc1
    ds_write_b128 v13, v[184:187] offset:39936
    s_add_u32 s14, s14, 131072
    v_mfma_f32_16x16x32_bf16 v[240:243], a[208:211], v[36:39], v[240:243]
    v_accvgpr_read_b32 v42, a240
    v_cmp_nge_f32 vcc, s15, v42
    v_rcp_f32 v42, v42
    s_nop 0
    v_mfma_f32_16x16x32_bf16 v[244:247], a[212:215], v[36:39], v[244:247]
    s_or_b64 s[12:13], s[12:13], vcc
    v_pk_mul_f32 v[192:193], v[192:193], v[42:43] op_sel_hi:[1,0]
    v_pk_mul_f32 v[194:195], v[194:195], v[42:43] op_sel_hi:[1,0]
    v_mfma_f32_16x16x32_bf16 v[248:251], a[216:219], v[36:39], v[248:251]
    v_pk_mul_f32 v[196:197], v[196:197], v[42:43] op_sel_hi:[1,0]
    v_pk_mul_f32 v[198:199], v[198:199], v[42:43] op_sel_hi:[1,0]
    v_cvt_pk_bf16_f32 v192, v192, v193
    v_mfma_f32_16x16x32_bf16 v[252:255], a[220:223], v[36:39], v[252:255]
    v_cvt_pk_bf16_f32 v193, v194, v195
    v_cvt_pk_bf16_f32 v194, v196, v197
    v_cvt_pk_bf16_f32 v195, v198, v199
    v_mfma_f32_16x16x32_bf16 a[244:247], a[248:251], v[36:39], a[244:247]
    buffer_store_dwordx4 v[192:195], v0, s[56:59], s14 offen offset:0 sc1
    ds_write_b128 v13, v[192:195] offset:4096
    v_pk_mul_f32 v[200:201], v[200:201], v[42:43] op_sel_hi:[1,0]
    s_lshl_b32 s10, s7, 3
    v_mov_b32 v16, s10
    global_load_dwordx2 v[56:57], v16, s[38:39] sc1
    v_mov_b32 v58, s30
    v_add_u32 v60, 65536, v58
    v_and_b32 v59, 7, v1
    v_lshl_add_u32 v59, v59, 7, s31
    v_and_b32 v61, 3, v1
    v_max_u32 v61, 1, v61
    v_add_u32 v61, s4, v61
    v_and_b32 v61, 3, v61
    v_lshl_add_u32 v61, v61, 10, s32
    v_add_u32 v62, s33, v0
    v_add_u32 v63, 49152, v62
    v_pk_mul_f32 v[202:203], v[202:203], v[42:43] op_sel_hi:[1,0]
    v_pk_mul_f32 v[204:205], v[204:205], v[42:43] op_sel_hi:[1,0]
    v_pk_mul_f32 v[206:207], v[206:207], v[42:43] op_sel_hi:[1,0]
    v_cvt_pk_bf16_f32 v200, v200, v201
    v_cvt_pk_bf16_f32 v201, v202, v203
    v_cvt_pk_bf16_f32 v202, v204, v205
    v_cvt_pk_bf16_f32 v203, v206, v207
    buffer_store_dwordx4 v[200:203], v0, s[56:59], s14 offen offset:1024 sc1
    ds_write_b128 v13, v[200:203] offset:16384
    v_pk_mul_f32 v[208:209], v[208:209], v[42:43] op_sel_hi:[1,0]
    v_pk_mul_f32 v[210:211], v[210:211], v[42:43] op_sel_hi:[1,0]
    v_pk_mul_f32 v[212:213], v[212:213], v[42:43] op_sel_hi:[1,0]
    v_pk_mul_f32 v[214:215], v[214:215], v[42:43] op_sel_hi:[1,0]
    v_cvt_pk_bf16_f32 v208, v208, v209
    v_cvt_pk_bf16_f32 v209, v210, v211
    v_cvt_pk_bf16_f32 v210, v212, v213
    v_cvt_pk_bf16_f32 v211, v214, v215
    buffer_store_dwordx4 v[208:211], v0, s[56:59], s14 offen offset:2048 sc1
    ds_write_b128 v13, v[208:211] offset:28672
    v_pk_mul_f32 v[216:217], v[216:217], v[42:43] op_sel_hi:[1,0]
    v_pk_mul_f32 v[218:219], v[218:219], v[42:43] op_sel_hi:[1,0]
    v_pk_mul_f32 v[220:221], v[220:221], v[42:43] op_sel_hi:[1,0]
    v_pk_mul_f32 v[222:223], v[222:223], v[42:43] op_sel_hi:[1,0]
    v_cvt_pk_bf16_f32 v216, v216, v217
    v_cvt_pk_bf16_f32 v217, v218, v219
    v_cvt_pk_bf16_f32 v218, v220, v221
    v_cvt_pk_bf16_f32 v219, v222, v223
    buffer_store_dwordx4 v[216:219], v0, s[56:59], s14 offen offset:3072 sc1
    ds_write_b128 v13, v[216:219] offset:40960
    s_add_u32 s14, s14, 131072
    v_accvgpr_read_b32 v46, a244
    v_cmp_nge_f32 vcc, s15, v46
    v_rcp_f32 v46, v46
    s_nop 0
    s_or_b64 s[12:13], s[12:13], vcc
    v_pk_mul_f32 v[224:225], v[224:225], v[46:47] op_sel_hi:[1,0]
    v_pk_mul_f32 v[226:227], v[226:227], v[46:47] op_sel_hi:[1,0]
    v_pk_mul_f32 v[228:229], v[228:229], v[46:47] op_sel_hi:[1,0]
    v_pk_mul_f32 v[230:231], v[230:231], v[46:47] op_sel_hi:[1,0]
    v_cvt_pk_bf16_f32 v224, v224, v225
    v_cvt_pk_bf16_f32 v225, v226, v227
    v_cvt_pk_bf16_f32 v226, v228, v229
    v_cvt_pk_bf16_f32 v227, v230, v231
    buffer_store_dwordx4 v[224:227], v0, s[56:59], s14 offen offset:0 sc1
    ds_write_b128 v13, v[224:227] offset:5120
    v_pk_mul_f32 v[232:233], v[232:233], v[46:47] op_sel_hi:[1,0]
    v_pk_mul_f32 v[234:235], v[234:235], v[46:47] op_sel_hi:[1,0]
    v_pk_mul_f32 v[236:237], v[236:237], v[46:47] op_sel_hi:[1,0]
    v_pk_mul_f32 v[238:239], v[238:239], v[46:47] op_sel_hi:[1,0]
    v_cvt_pk_bf16_f32 v232, v232, v233
    v_cvt_pk_bf16_f32 v233, v234, v235
    v_cvt_pk_bf16_f32 v234, v236, v237
    v_cvt_pk_bf16_f32 v235, v238, v239
    buffer_store_dwordx4 v[232:235], v0, s[56:59], s14 offen offset:1024 sc1
    ds_write_b128 v13, v[232:235] offset:17408
    v_pk_mul_f32 v[240:241], v[240:241], v[46:47] op_sel_hi:[1,0]
    v_pk_mul_f32 v[242:243], v[242:243], v[46:47] op_sel_hi:[1,0]
    v_pk_mul_f32 v[244:245], v[244:245], v[46:47] op_sel_hi:[1,0]
    v_pk_mul_f32 v[246:247], v[246:247], v[46:47] op_sel_hi:[1,0]
    v_cvt_pk_bf16_f32 v240, v240, v241
    v_cvt_pk_bf16_f32 v241, v242, v243
    v_cvt_pk_bf16_f32 v242, v244, v245
    v_cvt_pk_bf16_f32 v243, v246, v247
    buffer_store_dwordx4 v[240:243], v0, s[56:59], s14 offen offset:2048 sc1
    ds_write_b128 v13, v[240:243] offset:29696
    v_pk_mul_f32 v[248:249], v[248:249], v[46:47] op_sel_hi:[1,0]
    v_pk_mul_f32 v[250:251], v[250:251], v[46:47] op_sel_hi:[1,0]
    v_pk_mul_f32 v[252:253], v[252:253], v[46:47] op_sel_hi:[1,0]
    v_pk_mul_f32 v[254:255], v[254:255], v[46:47] op_sel_hi:[1,0]
    v_cvt_pk_bf16_f32 v248, v248, v249
    v_cvt_pk_bf16_f32 v249, v250, v251
    v_cvt_pk_bf16_f32 v250, v252, v253
    v_cvt_pk_bf16_f32 v251, v254, v255
    buffer_store_dwordx4 v[248:251], v0, s[56:59], s14 offen offset:3072 sc1
    ds_write_b128 v13, v[248:251] offset:41984
    s_add_u32 s14, s14, 131072
    s_cmp_lg_u64 s[12:13], 0
    s_cselect_b32 s10, 1, 0
    v_mov_b32 v16, s10
    s_lshl_b32 s10, s60, 2
    s_add_u32 s10, s10, 61440
    v_mov_b32 v17, s10
    v_mov_b32 v18, 61440
    ds_write_b32 v17, v16
    global_load_dwordx2 v[228:229], v59, s[40:41] sc1
    s_waitcnt vmcnt(26) lgkmcnt(0)
    s_barrier
    ds_read_b128 v[20:23], v18
    ds_read_b64_tr_b16 v[184:185], v9 offset:0
    ds_read_b64_tr_b16 v[186:187], v9 offset:5120
    ds_read_b64_tr_b16 v[188:189], v10 offset:0
    ds_read_b64_tr_b16 v[190:191], v10 offset:5120
    ds_read_b64_tr_b16 v[192:193], v9 offset:64
    ds_read_b64_tr_b16 v[194:195], v9 offset:5184
    ds_read_b64_tr_b16 v[196:197], v10 offset:64
    ds_read_b64_tr_b16 v[198:199], v10 offset:5184
    ds_read_b64_tr_b16 v[200:201], v9 offset:128
    ds_read_b64_tr_b16 v[202:203], v9 offset:5248
    ds_read_b64_tr_b16 v[204:205], v10 offset:128
    ds_read_b64_tr_b16 v[206:207], v10 offset:5248
    ds_read_b64_tr_b16 v[208:209], v9 offset:192
    ds_read_b64_tr_b16 v[210:211], v9 offset:5312
    ds_read_b64_tr_b16 v[212:213], v10 offset:192
    ds_read_b64_tr_b16 v[214:215], v10 offset:5312
    ds_read_b64_tr_b16 v[216:217], v9 offset:256
    ds_read_b64_tr_b16 v[218:219], v9 offset:5376
    ds_read_b64_tr_b16 v[220:221], v10 offset:256
    ds_read_b64_tr_b16 v[222:223], v10 offset:5376
    ds_read_b128 a[96:99], v62 offset:0
    ds_read_b128 a[100:103], v62 offset:1024
    ds_read_b128 a[104:107], v62 offset:2048
    ds_read_b128 a[108:111], v62 offset:12288
    ds_read_b128 a[112:115], v62 offset:13312
    ds_read_b128 a[116:119], v62 offset:14336
    s_waitcnt lgkmcnt(15)
    v_or_b32 v20, v20, v21
    v_or3_b32 v20, v20, v22, v23
    s_nop 0
    v_readfirstlane_b32 s10, v20
    s_nop 0
    s_andn2_b32 s10, s10, s78
    s_cmp_lg_u32 s10, 0
    s_cbranch_scc1 L_FALLBACK
    s_waitcnt lgkmcnt(0)
    v_mfma_f32_16x16x32_bf16 v[64:67], v[184:187], a[96:99], 0
    ds_read_b128 a[120:123], v62 offset:24576
    ds_read_b64_tr_b16 v[16:17], v9 offset:10240
    v_mfma_f32_16x16x32_bf16 v[104:107], v[184:187], a[100:103], 0
    ds_read_b64_tr_b16 v[18:19], v9 offset:15360
    v_mfma_f32_16x16x32_bf16 v[144:147], v[184:187], a[104:107], 0
    ds_read_b64_tr_b16 v[20:21], v10 offset:10240
    v_mfma_f32_16x16x32_bf16 v[68:71], v[188:191], a[96:99], 0
    ds_read_b64_tr_b16 v[22:23], v10 offset:15360
    v_mfma_f32_16x16x32_bf16 v[108:111], v[188:191], a[100:103], 0
    ds_read_b128 a[124:127], v62 offset:25600
    ds_read_b64_tr_b16 v[24:25], v9 offset:10304
    v_mfma_f32_16x16x32_bf16 v[148:151], v[188:191], a[104:107], 0
    v_mfma_f32_16x16x32_bf16 v[72:75], v[192:195], a[96:99], 0
    ds_read_b64_tr_b16 v[26:27], v9 offset:15424
    v_mfma_f32_16x16x32_bf16 v[112:115], v[192:195], a[100:103], 0
    ds_read_b64_tr_b16 v[28:29], v10 offset:10304
    v_mfma_f32_16x16x32_bf16 v[152:155], v[192:195], a[104:107], 0
    ds_read_b64_tr_b16 v[30:31], v10 offset:15424
    v_mfma_f32_16x16x32_bf16 v[76:79], v[196:199], a[96:99], 0
    ds_read_b128 a[128:131], v62 offset:26624
    ds_read_b64_tr_b16 v[32:33], v9 offset:10368
    v_mfma_f32_16x16x32_bf16 v[116:119], v[196:199], a[100:103], 0
    ds_read_b64_tr_b16 v[34:35], v9 offset:15488
    v_mfma_f32_16x16x32_bf16 v[156:159], v[196:199], a[104:107], 0
    v_mfma_f32_16x16x32_bf16 v[80:83], v[200:203], a[96:99], 0
    ds_read_b64_tr_b16 v[36:37], v10 offset:10368
    v_mfma_f32_16x16x32_bf16 v[120:123], v[200:203], a[100:103], 0
    ds_read_b128 a[132:135], v62 offset:36864
    ds_read_b64_tr_b16 v[38:39], v10 offset:15488
    v_mfma_f32_16x16x32_bf16 v[160:163], v[200:203], a[104:107], 0
    ds_read_b64_tr_b16 v[40:41], v9 offset:10432
    v_mfma_f32_16x16x32_bf16 v[84:87], v[204:207], a[96:99], 0
    ds_read_b64_tr_b16 v[42:43], v9 offset:15552
    v_mfma_f32_16x16x32_bf16 v[124:127], v[204:207], a[100:103], 0
    ds_read_b64_tr_b16 v[44:45], v10 offset:10432
    v_mfma_f32_16x16x32_bf16 v[164:167], v[204:207], a[104:107], 0
    v_mfma_f32_16x16x32_bf16 v[88:91], v[208:211], a[96:99], 0
    ds_read_b128 a[136:139], v62 offset:37888
    ds_read_b64_tr_b16 v[46:47], v10 offset:15552
    v_mfma_f32_16x16x32_bf16 v[128:131], v[208:211], a[100:103], 0
    ds_read_b64_tr_b16 v[48:49], v9 offset:10496
    v_mfma_f32_16x16x32_bf16 v[168:171], v[208:211], a[104:107], 0
    ds_read_b64_tr_b16 v[50:51], v9 offset:15616
    v_mfma_f32_16x16x32_bf16 v[92:95], v[212:215], a[96:99], 0
    ds_read_b64_tr_b16 v[52:53], v10 offset:10496
    v_mfma_f32_16x16x32_bf16 v[132:135], v[212:215], a[100:103], 0
    ds_read_b128 a[140:143], v62 offset:38912
    ds_read_b64_tr_b16 v[54:55], v10 offset:15616
    v_mfma_f32_16x16x32_bf16 v[172:175], v[212:215], a[104:107], 0
    v_mfma_f32_16x16x32_bf16 v[96:99], v[216:219], a[96:99], 0
    v_mfma_f32_16x16x32_bf16 v[136:139], v[216:219], a[100:103], 0
    v_mfma_f32_16x16x32_bf16 v[176:179], v[216:219], a[104:107], 0
    v_mfma_f32_16x16x32_bf16 v[100:103], v[220:223], a[96:99], 0
    v_mfma_f32_16x16x32_bf16 v[140:143], v[220:223], a[100:103], 0
    v_mfma_f32_16x16x32_bf16 v[180:183], v[220:223], a[104:107], 0
    s_waitcnt lgkmcnt(0)
    s_barrier
    v_mfma_f32_16x16x32_bf16 v[64:67], v[16:19], a[108:111], v[64:67]
    s_add_u32 m0, s70, 0
    ds_read_b64_tr_b16 v[184:185], v9 offset:20480
    v_mfma_f32_16x16x32_bf16 v[104:107], v[16:19], a[112:115], v[104:107]
    ds_read_b64_tr_b16 v[186:187], v9 offset:25600
    v_mfma_f32_16x16x32_bf16 v[144:147], v[16:19], a[116:119], v[144:147]
    buffer_load_dwordx4 v4, s[84:87], s64 offen  lds
    s_add_u32 m0, s70, 1024
    v_mfma_f32_16x16x32_bf16 v[68:71], v[20:23], a[108:111], v[68:71]
    ds_read_b64_tr_b16 v[188:189], v10 offset:20480
    ds_read_b64_tr_b16 v[190:191], v10 offset:25600
    v_mfma_f32_16x16x32_bf16 v[108:111], v[20:23], a[112:115], v[108:111]
    buffer_load_dwordx4 v5, s[84:87], s64 offen  lds
    s_add_u32 m0, s70, 2048
    v_mfma_f32_16x16x32_bf16 v[148:151], v[20:23], a[116:119], v[148:151]
    ds_read_b64_tr_b16 v[192:193], v9 offset:20544
    v_mfma_f32_16x16x32_bf16 v[72:75], v[24:27], a[108:111], v[72:75]
    buffer_load_dwordx4 v6, s[84:87], s64 offen  lds
    s_add_u32 m0, s70, 3072
    v_mfma_f32_16x16x32_bf16 v[112:115], v[24:27], a[112:115], v[112:115]
    ds_read_b64_tr_b16 v[194:195], v9 offset:25664
    ds_read_b64_tr_b16 v[196:197], v10 offset:20544
    v_mfma_f32_16x16x32_bf16 v[152:155], v[24:27], a[116:119], v[152:155]
    buffer_load_dwordx4 v7, s[84:87], s64 offen  lds
    s_add_u32 m0, s70, 4096
    v_mfma_f32_16x16x32_bf16 v[76:79], v[28:31], a[108:111], v[76:79]
    ds_read_b64_tr_b16 v[198:199], v10 offset:25664
    ds_read_b64_tr_b16 v[200:201], v9 offset:20608
    v_mfma_f32_16x16x32_bf16 v[116:119], v[28:31], a[112:115], v[116:119]
    buffer_load_dwordx4 v8, s[84:87], s64 offen  lds
    s_add_u32 s64, s64, 81920
    v_mfma_f32_16x16x32_bf16 v[156:159], v[28:31], a[116:119], v[156:159]
    ds_read_b64_tr_b16 v[202:203], v9 offset:25728
    v_mfma_f32_16x16x32_bf16 v[80:83], v[32:35], a[108:111], v[80:83]
    s_cmp_eq_u32 s64, 1310720
    s_cselect_b32 s64, 0, s64
    v_mfma_f32_16x16x32_bf16 v[120:123], v[32:35], a[112:115], v[120:123]
    ds_read_b64_tr_b16 v[204:205], v10 offset:20608
    ds_read_b64_tr_b16 v[206:207], v10 offset:25728
    v_mfma_f32_16x16x32_bf16 v[160:163], v[32:35], a[116:119], v[160:163]
    ds_read_b128 a[144:147], v63 offset:0
    ds_read_b64_tr_b16 v[208:209], v9 offset:20672
    v_mfma_f32_16x16x32_bf16 v[84:87], v[36:39], a[108:111], v[84:87]
    ds_read_b64_tr_b16 v[210:211], v9 offset:25792
    v_mfma_f32_16x16x32_bf16 v[124:127], v[36:39], a[112:115], v[124:127]
    ds_read_b128 a[148:151], v63 offset:1024
    ds_read_b64_tr_b16 v[212:213], v10 offset:20672
    v_mfma_f32_16x16x32_bf16 v[164:167], v[36:39], a[116:119], v[164:167]
    v_mfma_f32_16x16x32_bf16 v[88:91], v[40:43], a[108:111], v[88:91]
    ds_read_b128 a[152:155], v63 offset:2048
    ds_read_b64_tr_b16 v[214:215], v10 offset:25792
    v_mfma_f32_16x16x32_bf16 v[128:131], v[40:43], a[112:115], v[128:131]
    ds_read_b64_tr_b16 v[216:217], v9 offset:20736
    v_mfma_f32_16x16x32_bf16 v[168:171], v[40:43], a[116:119], v[168:171]
    ds_read_b128 a[156:159], v63 offset:12288
    ds_read_b64_tr_b16 v[218:219], v9 offset:25856
    v_mfma_f32_16x16x32_bf16 v[92:95], v[44:47], a[108:111], v[92:95]
    ds_read_b64_tr_b16 v[220:221], v10 offset:20736
    v_mfma_f32_16x16x32_bf16 v[132:135], v[44:47], a[112:115], v[132:135]
    ds_read_b128 a[160:163], v63 offset:13312
    ds_read_b64_tr_b16 v[222:223], v10 offset:25856
    v_mfma_f32_16x16x32_bf16 v[172:175], v[44:47], a[116:119], v[172:175]
    v_mfma_f32_16x16x32_bf16 v[96:99], v[48:51], a[108:111], v[96:99]
    ds_read_b128 a[164:167], v63 offset:14336
    v_mfma_f32_16x16x32_bf16 v[136:139], v[48:51], a[112:115], v[136:139]
    v_mfma_f32_16x16x32_bf16 v[176:179], v[48:51], a[116:119], v[176:179]
    v_mfma_f32_16x16x32_bf16 v[100:103], v[52:55], a[108:111], v[100:103]
    v_mfma_f32_16x16x32_bf16 v[140:143], v[52:55], a[112:115], v[140:143]
    v_mfma_f32_16x16x32_bf16 v[180:183], v[52:55], a[116:119], v[180:183]
    s_waitcnt vmcnt(6)
    s_mov_b32 s79, 1048576
L_TAG:
    v_readfirstlane_b32 s10, v56
    s_nop 0
    s_cmp_lg_u32 s10, 0
    s_cbranch_scc1 L_TAGOK
    s_lshl_b32 s10, s7, 3
    v_mov_b32 v230, s10
    s_sleep 2
    s_sub_u32 s79, s79, 1
    global_load_dwordx2 v[56:57], v230, s[38:39] sc1
    s_waitcnt vmcnt(0)
    s_cbranch_scc0 L_TAG
L_TAGOK:
    global_store_dwordx2 v58, v[56:57], s[40:41] sc1
    s_waitcnt vmcnt(6) lgkmcnt(0)
    v_cmp_ne_u64 s[22:23], v[228:229], v[56:57]
    s_nop 0
    s_and_b64 s[10:11], s[22:23], s[24:25]
    s_cbranch_scc0 L_T0F
    v_mfma_f32_16x16x32_bf16 v[64:67], v[184:187], a[120:123], v[64:67]
    ds_read_b128 a[168:171], v63 offset:24576
    ds_read_b64_tr_b16 v[16:17], v9 offset:30720
    v_mfma_f32_16x16x32_bf16 v[104:107], v[184:187], a[124:127], v[104:107]
    ds_read_b64_tr_b16 v[18:19], v9 offset:35840
    v_mfma_f32_16x16x32_bf16 v[144:147], v[184:187], a[128:131], v[144:147]
    ds_read_b64_tr_b16 v[20:21], v10 offset:30720
    v_mfma_f32_16x16x32_bf16 v[68:71], v[188:191], a[120:123], v[68:71]
    ds_read_b64_tr_b16 v[22:23], v10 offset:35840
    v_mfma_f32_16x16x32_bf16 v[108:111], v[188:191], a[124:127], v[108:111]
    ds_read_b128 a[172:175], v63 offset:25600
    ds_read_b64_tr_b16 v[24:25], v9 offset:30784
    v_mfma_f32_16x16x32_bf16 v[148:151], v[188:191], a[128:131], v[148:151]
    v_mfma_f32_16x16x32_bf16 v[72:75], v[192:195], a[120:123], v[72:75]
    ds_read_b64_tr_b16 v[26:27], v9 offset:35904
    v_mfma_f32_16x16x32_bf16 v[112:115], v[192:195], a[124:127], v[112:115]
    ds_read_b64_tr_b16 v[28:29], v10 offset:30784
    v_mfma_f32_16x16x32_bf16 v[152:155], v[192:195], a[128:131], v[152:155]
    ds_read_b64_tr_b16 v[30:31], v10 offset:35904
    v_mfma_f32_16x16x32_bf16 v[76:79], v[196:199], a[120:123], v[76:79]
    ds_read_b128 a[176:179], v63 offset:26624
    ds_read_b64_tr_b16 v[32:33], v9 offset:30848
    v_mfma_f32_16x16x32_bf16 v[116:119], v[196:199], a[124:127], v[116:119]
    ds_read_b64_tr_b16 v[34:35], v9 offset:35968
    v_mfma_f32_16x16x32_bf16 v[156:159], v[196:199], a[128:131], v[156:159]
    v_mfma_f32_16x16x32_bf16 v[80:83], v[200:203], a[120:123], v[80:83]
    ds_read_b64_tr_b16 v[36:37], v10 offset:30848
    v_mfma_f32_16x16x32_bf16 v[120:123], v[200:203], a[124:127], v[120:123]
    ds_read_b128 a[180:183], v63 offset:36864
    ds_read_b64_tr_b16 v[38:39], v10 offset:35968
    v_mfma_f32_16x16x32_bf16 v[160:163], v[200:203], a[128:131], v[160:163]
    ds_read_b64_tr_b16 v[40:41], v9 offset:30912
    v_mfma_f32_16x16x32_bf16 v[84:87], v[204:207], a[120:123], v[84:87]
    ds_read_b64_tr_b16 v[42:43], v9 offset:36032
    v_mfma_f32_16x16x32_bf16 v[124:127], v[204:207], a[124:127], v[124:127]
    ds_read_b64_tr_b16 v[44:45], v10 offset:30912
    v_mfma_f32_16x16x32_bf16 v[164:167], v[204:207], a[128:131], v[164:167]
    v_mfma_f32_16x16x32_bf16 v[88:91], v[208:211], a[120:123], v[88:91]
    ds_read_b128 a[184:187], v63 offset:37888
    ds_read_b64_tr_b16 v[46:47], v10 offset:36032
    v_mfma_f32_16x16x32_bf16 v[128:131], v[208:211], a[124:127], v[128:131]
    ds_read_b64_tr_b16 v[48:49], v9 offset:30976
    v_mfma_f32_16x16x32_bf16 v[168:171], v[208:211], a[128:131], v[168:171]
    ds_read_b64_tr_b16 v[50:51], v9 offset:36096
    v_mfma_f32_16x16x32_bf16 v[92:95], v[212:215], a[120:123], v[92:95]
    ds_read_b64_tr_b16 v[52:53], v10 offset:30976
    v_mfma_f32_16x16x32_bf16 v[132:135], v[212:215], a[124:127], v[132:135]
    ds_read_b128 a[188:191], v63 offset:38912
    ds_read_b64_tr_b16 v[54:55], v10 offset:36096
    v_mfma_f32_16x16x32_bf16 v[172:175], v[212:215], a[128:131], v[172:175]
    v_mfma_f32_16x16x32_bf16 v[96:99], v[216:219], a[120:123], v[96:99]
    v_mfma_f32_16x16x32_bf16 v[136:139], v[216:219], a[124:127], v[136:139]
    v_mfma_f32_16x16x32_bf16 v[176:179], v[216:219], a[128:131], v[176:179]
    v_mfma_f32_16x16x32_bf16 v[100:103], v[220:223], a[120:123], v[100:103]
    v_mfma_f32_16x16x32_bf16 v[140:143], v[220:223], a[124:127], v[140:143]
    v_mfma_f32_16x16x32_bf16 v[180:183], v[220:223], a[128:131], v[180:183]
    s_waitcnt lgkmcnt(0)
    s_barrier
    v_mfma_f32_16x16x32_bf16 v[64:67], v[16:19], a[132:135], v[64:67]
    s_add_u32 m0, s70, 20480
    ds_read_b64_tr_b16 v[184:185], v9 offset:40960
    v_mfma_f32_16x16x32_bf16 v[104:107], v[16:19], a[136:139], v[104:107]
    ds_read_b64_tr_b16 v[186:187], v9 offset:46080
    v_mfma_f32_16x16x32_bf16 v[144:147], v[16:19], a[140:143], v[144:147]
    ds_read_b64_tr_b16 v[188:189], v10 offset:40960
    v_mfma_f32_16x16x32_bf16 v[68:71], v[20:23], a[132:135], v[68:71]
    buffer_load_dwordx4 v4, s[84:87], s64 offen  lds
    s_add_u32 m0, s70, 21504
    v_mfma_f32_16x16x32_bf16 v[108:111], v[20:23], a[136:139], v[108:111]
    ds_read_b64_tr_b16 v[190:191], v10 offset:46080
    ds_read_b64_tr_b16 v[192:193], v9 offset:41024
    v_mfma_f32_16x16x32_bf16 v[148:151], v[20:23], a[140:143], v[148:151]
    v_mfma_f32_16x16x32_bf16 v[72:75], v[24:27], a[132:135], v[72:75]
    buffer_load_dwordx4 v5, s[84:87], s64 offen  lds
    s_add_u32 m0, s70, 22528
    v_mfma_f32_16x16x32_bf16 v[112:115], v[24:27], a[136:139], v[112:115]
    ds_read_b64_tr_b16 v[194:195], v9 offset:46144
    ds_read_b64_tr_b16 v[196:197], v10 offset:41024
    v_mfma_f32_16x16x32_bf16 v[152:155], v[24:27], a[140:143], v[152:155]
    ds_read_b64_tr_b16 v[198:199], v10 offset:46144
    v_mfma_f32_16x16x32_bf16 v[76:79], v[28:31], a[132:135], v[76:79]
    ds_read_b64_tr_b16 v[200:201], v9 offset:41088
    v_mfma_f32_16x16x32_bf16 v[116:119], v[28:31], a[136:139], v[116:119]
    buffer_load_dwordx4 v6, s[84:87], s64 offen  lds
    s_add_u32 m0, s70, 23552
    v_mfma_f32_16x16x32_bf16 v[156:159], v[28:31], a[140:143], v[156:159]
    ds_read_b64_tr_b16 v[202:203], v9 offset:46208
    v_mfma_f32_16x16x32_bf16 v[80:83], v[32:35], a[132:135], v[80:83]
    ds_read_b64_tr_b16 v[204:205], v10 offset:41088
    v_mfma_f32_16x16x32_bf16 v[120:123], v[32:35], a[136:139], v[120:123]
    buffer_load_dwordx4 v7, s[84:87], s64 offen  lds
    s_add_u32 m0, s70, 24576
    v_mfma_f32_16x16x32_bf16 v[160:163], v[32:35], a[140:143], v[160:163]
    ds_read_b64_tr_b16 v[206:207], v10 offset:46208
    ds_read_b64_tr_b16 v[208:209], v9 offset:41152
    v_mfma_f32_16x16x32_bf16 v[84:87], v[36:39], a[132:135], v[84:87]
    ds_read_b64_tr_b16 v[210:211], v9 offset:46272
    v_mfma_f32_16x16x32_bf16 v[124:127], v[36:39], a[136:139], v[124:127]
    buffer_load_dwordx4 v8, s[84:87], s64 offen  lds
    s_add_u32 s64, s64, 81920
    v_mfma_f32_16x16x32_bf16 v[164:167], v[36:39], a[140:143], v[164:167]
    ds_read_b64_tr_b16 v[212:213], v10 offset:41152
    v_mfma_f32_16x16x32_bf16 v[88:91], v[40:43], a[132:135], v[88:91]
    ds_read_b64_tr_b16 v[214:215], v10 offset:46272
    v_mfma_f32_16x16x32_bf16 v[128:131], v[40:43], a[136:139], v[128:131]
    ds_read_b64_tr_b16 v[216:217], v9 offset:41216
    v_mfma_f32_16x16x32_bf16 v[168:171], v[40:43], a[140:143], v[168:171]
    s_cmp_eq_u32 s64, 1310720
    s_cselect_b32 s64, 0, s64
    v_mfma_f32_16x16x32_bf16 v[92:95], v[44:47], a[132:135], v[92:95]
    ds_read_b64_tr_b16 v[218:219], v9 offset:46336
    ds_read_b64_tr_b16 v[220:221], v10 offset:41216
    v_mfma_f32_16x16x32_bf16 v[132:135], v[44:47], a[136:139], v[132:135]
    ds_read_b64_tr_b16 v[222:223], v10 offset:46336
    v_mfma_f32_16x16x32_bf16 v[172:175], v[44:47], a[140:143], v[172:175]
    global_load_dwordx2 v[228:229], v59, s[40:41] sc1
    v_mfma_f32_16x16x32_bf16 v[96:99], v[48:51], a[132:135], v[96:99]
    v_mfma_f32_16x16x32_bf16 v[136:139], v[48:51], a[136:139], v[136:139]
    v_mfma_f32_16x16x32_bf16 v[176:179], v[48:51], a[140:143], v[176:179]
    v_mfma_f32_16x16x32_bf16 v[100:103], v[52:55], a[132:135], v[100:103]
    v_mfma_f32_16x16x32_bf16 v[140:143], v[52:55], a[136:139], v[140:143]
    v_mfma_f32_16x16x32_bf16 v[180:183], v[52:55], a[140:143], v[180:183]
    s_waitcnt lgkmcnt(0)
    v_mfma_f32_16x16x32_bf16 v[64:67], v[184:187], a[144:147], v[64:67]
    ds_read_b64_tr_b16 v[16:17], v9 offset:51200
    v_mfma_f32_16x16x32_bf16 v[104:107], v[184:187], a[148:151], v[104:107]
    ds_read_b64_tr_b16 v[18:19], v9 offset:56320
    v_mfma_f32_16x16x32_bf16 v[144:147], v[184:187], a[152:155], v[144:147]
    ds_read_b64_tr_b16 v[20:21], v10 offset:51200
    v_mfma_f32_16x16x32_bf16 v[68:71], v[188:191], a[144:147], v[68:71]
    ds_read_b64_tr_b16 v[22:23], v10 offset:56320
    v_mfma_f32_16x16x32_bf16 v[108:111], v[188:191], a[148:151], v[108:111]
    ds_read_b64_tr_b16 v[24:25], v9 offset:51264
    v_mfma_f32_16x16x32_bf16 v[148:151], v[188:191], a[152:155], v[148:151]
    v_mfma_f32_16x16x32_bf16 v[72:75], v[192:195], a[144:147], v[72:75]
    ds_read_b64_tr_b16 v[26:27], v9 offset:56384
    v_mfma_f32_16x16x32_bf16 v[112:115], v[192:195], a[148:151], v[112:115]
    ds_read_b64_tr_b16 v[28:29], v10 offset:51264
    v_mfma_f32_16x16x32_bf16 v[152:155], v[192:195], a[152:155], v[152:155]
    ds_read_b64_tr_b16 v[30:31], v10 offset:56384
    v_mfma_f32_16x16x32_bf16 v[76:79], v[196:199], a[144:147], v[76:79]
    ds_read_b64_tr_b16 v[32:33], v9 offset:51328
    v_mfma_f32_16x16x32_bf16 v[116:119], v[196:199], a[148:151], v[116:119]
    ds_read_b64_tr_b16 v[34:35], v9 offset:56448
    v_mfma_f32_16x16x32_bf16 v[156:159], v[196:199], a[152:155], v[156:159]
    v_mfma_f32_16x16x32_bf16 v[80:83], v[200:203], a[144:147], v[80:83]
    ds_read_b64_tr_b16 v[36:37], v10 offset:51328
    v_mfma_f32_16x16x32_bf16 v[120:123], v[200:203], a[148:151], v[120:123]
    ds_read_b64_tr_b16 v[38:39], v10 offset:56448
    v_mfma_f32_16x16x32_bf16 v[160:163], v[200:203], a[152:155], v[160:163]
    ds_read_b64_tr_b16 v[40:41], v9 offset:51392
    v_mfma_f32_16x16x32_bf16 v[84:87], v[204:207], a[144:147], v[84:87]
    ds_read_b64_tr_b16 v[42:43], v9 offset:56512
    v_mfma_f32_16x16x32_bf16 v[124:127], v[204:207], a[148:151], v[124:127]
    ds_read_b64_tr_b16 v[44:45], v10 offset:51392
    v_mfma_f32_16x16x32_bf16 v[164:167], v[204:207], a[152:155], v[164:167]
    v_mfma_f32_16x16x32_bf16 v[88:91], v[208:211], a[144:147], v[88:91]
    ds_read_b64_tr_b16 v[46:47], v10 offset:56512
    v_mfma_f32_16x16x32_bf16 v[128:131], v[208:211], a[148:151], v[128:131]
    ds_read_b64_tr_b16 v[48:49], v9 offset:51456
    v_mfma_f32_16x16x32_bf16 v[168:171], v[208:211], a[152:155], v[168:171]
    ds_read_b64_tr_b16 v[50:51], v9 offset:56576
    v_mfma_f32_16x16x32_bf16 v[92:95], v[212:215], a[144:147], v[92:95]
    ds_read_b64_tr_b16 v[52:53], v10 offset:51456
    v_mfma_f32_16x16x32_bf16 v[132:135], v[212:215], a[148:151], v[132:135]
    ds_read_b64_tr_b16 v[54:55], v10 offset:56576
    v_mfma_f32_16x16x32_bf16 v[172:175], v[212:215], a[152:155], v[172:175]
    v_mfma_f32_16x16x32_bf16 v[96:99], v[216:219], a[144:147], v[96:99]
    v_mfma_f32_16x16x32_bf16 v[136:139], v[216:219], a[148:151], v[136:139]
    v_mfma_f32_16x16x32_bf16 v[176:179], v[216:219], a[152:155], v[176:179]
    v_mfma_f32_16x16x32_bf16 v[100:103], v[220:223], a[144:147], v[100:103]
    v_mfma_f32_16x16x32_bf16 v[140:143], v[220:223], a[148:151], v[140:143]
    v_mfma_f32_16x16x32_bf16 v[180:183], v[220:223], a[152:155], v[180:183]
    s_waitcnt vmcnt(7) lgkmcnt(0)
    s_barrier
    v_mfma_f32_16x16x32_bf16 v[64:67], v[16:19], a[156:159], v[64:67]
    s_add_u32 m0, s70, 40960
    ds_read_b64_tr_b16 v[184:185], v9 offset:0
    v_mfma_f32_16x16x32_bf16 v[104:107], v[16:19], a[160:163], v[104:107]
    ds_read_b64_tr_b16 v[186:187], v9 offset:5120
    v_mfma_f32_16x16x32_bf16 v[144:147], v[16:19], a[164:167], v[144:147]
    ds_read_b64_tr_b16 v[188:189], v10 offset:0
    v_mfma_f32_16x16x32_bf16 v[68:71], v[20:23], a[156:159], v[68:71]
    buffer_load_dwordx4 v4, s[84:87], s64 offen  lds
    s_add_u32 m0, s70, 41984
    v_mfma_f32_16x16x32_bf16 v[108:111], v[20:23], a[160:163], v[108:111]
    ds_read_b64_tr_b16 v[190:191], v10 offset:5120
    ds_read_b64_tr_b16 v[192:193], v9 offset:64
    v_mfma_f32_16x16x32_bf16 v[148:151], v[20:23], a[164:167], v[148:151]
    v_mfma_f32_16x16x32_bf16 v[72:75], v[24:27], a[156:159], v[72:75]
    ds_read_b64_tr_b16 v[194:195], v9 offset:5184
    v_mfma_f32_16x16x32_bf16 v[112:115], v[24:27], a[160:163], v[112:115]
    buffer_load_dwordx4 v5, s[84:87], s64 offen  lds
    s_add_u32 m0, s70, 43008
    v_mfma_f32_16x16x32_bf16 v[152:155], v[24:27], a[164:167], v[152:155]
    ds_read_b64_tr_b16 v[196:197], v10 offset:64
    ds_read_b64_tr_b16 v[198:199], v10 offset:5184
    v_mfma_f32_16x16x32_bf16 v[76:79], v[28:31], a[156:159], v[76:79]
    ds_read_b64_tr_b16 v[200:201], v9 offset:128
    v_mfma_f32_16x16x32_bf16 v[116:119], v[28:31], a[160:163], v[116:119]
    ds_read_b64_tr_b16 v[202:203], v9 offset:5248
    v_mfma_f32_16x16x32_bf16 v[156:159], v[28:31], a[164:167], v[156:159]
    buffer_load_dwordx4 v6, s[84:87], s64 offen  lds
    s_add_u32 m0, s70, 44032
    v_mfma_f32_16x16x32_bf16 v[80:83], v[32:35], a[156:159], v[80:83]
    ds_read_b64_tr_b16 v[204:205], v10 offset:128
    v_mfma_f32_16x16x32_bf16 v[120:123], v[32:35], a[160:163], v[120:123]
    ds_read_b64_tr_b16 v[206:207], v10 offset:5248
    v_mfma_f32_16x16x32_bf16 v[160:163], v[32:35], a[164:167], v[160:163]
    ds_read_b64_tr_b16 v[208:209], v9 offset:192
    v_mfma_f32_16x16x32_bf16 v[84:87], v[36:39], a[156:159], v[84:87]
    buffer_load_dwordx4 v7, s[84:87], s64 offen  lds
    s_add_u32 m0, s70, 45056
    v_mfma_f32_16x16x32_bf16 v[124:127], v[36:39], a[160:163], v[124:127]
    ds_read_b64_tr_b16 v[210:211], v9 offset:5312
    ds_read_b64_tr_b16 v[212:213], v10 offset:192
    v_mfma_f32_16x16x32_bf16 v[164:167], v[36:39], a[164:167], v[164:167]
    v_mfma_f32_16x16x32_bf16 v[88:91], v[40:43], a[156:159], v[88:91]
    ds_read_b64_tr_b16 v[214:215], v10 offset:5312
    v_mfma_f32_16x16x32_bf16 v[128:131], v[40:43], a[160:163], v[128:131]
    buffer_load_dwordx4 v8, s[84:87], s64 offen  lds
    s_add_u32 s64, s64, 81920
    v_mfma_f32_16x16x32_bf16 v[168:171], v[40:43], a[164:167], v[168:171]
    ds_read_b64_tr_b16 v[216:217], v9 offset:256
    ds_read_b64_tr_b16 v[218:219], v9 offset:5376
    v_mfma_f32_16x16x32_bf16 v[92:95], v[44:47], a[156:159], v[92:95]
    ds_read_b64_tr_b16 v[220:221], v10 offset:256
    v_mfma_f32_16x16x32_bf16 v[132:135], v[44:47], a[160:163], v[132:135]
    ds_read_b64_tr_b16 v[222:223], v10 offset:5376
    v_mfma_f32_16x16x32_bf16 v[172:175], v[44:47], a[164:167], v[172:175]
    s_cmp_eq_u32 s64, 1310720
    s_cselect_b32 s64, 0, s64
    v_mfma_f32_16x16x32_bf16 v[96:99], v[48:51], a[156:159], v[96:99]
    v_mfma_f32_16x16x32_bf16 v[136:139], v[48:51], a[160:163], v[136:139]
    v_mfma_f32_16x16x32_bf16 v[176:179], v[48:51], a[164:167], v[176:179]
    v_mfma_f32_16x16x32_bf16 v[100:103], v[52:55], a[156:159], v[100:103]
    v_mfma_f32_16x16x32_bf16 v[140:143], v[52:55], a[160:163], v[140:143]
    v_mfma_f32_16x16x32_bf16 v[180:183], v[52:55], a[164:167], v[180:183]
    s_waitcnt lgkmcnt(0)
    s_waitcnt vmcnt(5)
    v_cmp_ne_u64 s[22:23], v[228:229], v[56:57]
    s_nop 0
    s_and_b64 s[10:11], s[22:23], s[24:25]
    s_cbranch_scc0 L_PA_OK
    s_mov_b32 s79, 1048576
L_PA:
    global_load_dwordx2 v[228:229], v59, s[40:41] sc1
    s_waitcnt vmcnt(0)
    v_cmp_ne_u64 s[22:23], v[228:229], v[56:57]
    s_sub_u32 s79, s79, 1
    s_cbranch_scc1 L_PA_OK
    s_and_b64 s[10:11], s[22:23], s[24:25]
    s_cbranch_scc1 L_PA
L_PA_OK:
    v_mfma_f32_16x16x32_bf16 v[64:67], v[184:187], a[168:171], v[64:67]
    buffer_load_dwordx4 a[0:3], v0, s[88:91], s16 offen offset:0 sc1
    ds_read_b64_tr_b16 v[16:17], v9 offset:10240
    v_mfma_f32_16x16x32_bf16 v[104:107], v[184:187], a[172:175], v[104:107]
    ds_read_b64_tr_b16 v[18:19], v9 offset:15360
    v_mfma_f32_16x16x32_bf16 v[144:147], v[184:187], a[176:179], v[144:147]
    ds_read_b64_tr_b16 v[20:21], v10 offset:10240
    v_mfma_f32_16x16x32_bf16 v[68:71], v[188:191], a[168:171], v[68:71]
    ds_read_b64_tr_b16 v[22:23], v10 offset:15360
    v_mfma_f32_16x16x32_bf16 v[108:111], v[188:191], a[172:175], v[108:111]
    ds_read_b64_tr_b16 v[24:25], v9 offset:10304
    v_mfma_f32_16x16x32_bf16 v[148:151], v[188:191], a[176:179], v[148:151]
    v_mfma_f32_16x16x32_bf16 v[72:75], v[192:195], a[168:171], v[72:75]
    buffer_load_dwordx4 a[4:7], v11, s[88:91], s16 offen offset:0 sc1
    ds_read_b64_tr_b16 v[26:27], v9 offset:15424
    v_mfma_f32_16x16x32_bf16 v[112:115], v[192:195], a[172:175], v[112:115]
    ds_read_b64_tr_b16 v[28:29], v10 offset:10304
    v_mfma_f32_16x16x32_bf16 v[152:155], v[192:195], a[176:179], v[152:155]
    ds_read_b64_tr_b16 v[30:31], v10 offset:15424
    v_mfma_f32_16x16x32_bf16 v[76:79], v[196:199], a[168:171], v[76:79]
    ds_read_b64_tr_b16 v[32:33], v9 offset:10368
    v_mfma_f32_16x16x32_bf16 v[116:119], v[196:199], a[172:175], v[116:119]
    ds_read_b64_tr_b16 v[34:35], v9 offset:15488
    v_mfma_f32_16x16x32_bf16 v[156:159], v[196:199], a[176:179], v[156:159]
    v_mfma_f32_16x16x32_bf16 v[80:83], v[200:203], a[168:171], v[80:83]
    ds_read_b64_tr_b16 v[36:37], v10 offset:10368
    v_mfma_f32_16x16x32_bf16 v[120:123], v[200:203], a[172:175], v[120:123]
    buffer_load_dwordx4 a[8:11], v12, s[88:91], s16 offen offset:0 sc1
    ds_read_b64_tr_b16 v[38:39], v10 offset:15488
    v_mfma_f32_16x16x32_bf16 v[160:163], v[200:203], a[176:179], v[160:163]
    ds_read_b64_tr_b16 v[40:41], v9 offset:10432
    v_mfma_f32_16x16x32_bf16 v[84:87], v[204:207], a[168:171], v[84:87]
    ds_read_b64_tr_b16 v[42:43], v9 offset:15552
    v_mfma_f32_16x16x32_bf16 v[124:127], v[204:207], a[172:175], v[124:127]
    ds_read_b64_tr_b16 v[44:45], v10 offset:10432
    v_mfma_f32_16x16x32_bf16 v[164:167], v[204:207], a[176:179], v[164:167]
    v_mfma_f32_16x16x32_bf16 v[88:91], v[208:211], a[168:171], v[88:91]
    ds_read_b64_tr_b16 v[46:47], v10 offset:15552
    v_mfma_f32_16x16x32_bf16 v[128:131], v[208:211], a[172:175], v[128:131]
    ds_read_b64_tr_b16 v[48:49], v9 offset:10496
    v_mfma_f32_16x16x32_bf16 v[168:171], v[208:211], a[176:179], v[168:171]
    buffer_load_dwordx4 a[12:15], v0, s[88:91], s16 offen offset:1024 sc1
    ds_read_b64_tr_b16 v[50:51], v9 offset:15616
    v_mfma_f32_16x16x32_bf16 v[92:95], v[212:215], a[168:171], v[92:95]
    ds_read_b64_tr_b16 v[52:53], v10 offset:10496
    v_mfma_f32_16x16x32_bf16 v[132:135], v[212:215], a[172:175], v[132:135]
    ds_read_b64_tr_b16 v[54:55], v10 offset:15616
    v_mfma_f32_16x16x32_bf16 v[172:175], v[212:215], a[176:179], v[172:175]
    v_mfma_f32_16x16x32_bf16 v[96:99], v[216:219], a[168:171], v[96:99]
    v_mfma_f32_16x16x32_bf16 v[136:139], v[216:219], a[172:175], v[136:139]
    v_mfma_f32_16x16x32_bf16 v[176:179], v[216:219], a[176:179], v[176:179]
    v_mfma_f32_16x16x32_bf16 v[100:103], v[220:223], a[168:171], v[100:103]
    v_mfma_f32_16x16x32_bf16 v[140:143], v[220:223], a[172:175], v[140:143]
    v_mfma_f32_16x16x32_bf16 v[180:183], v[220:223], a[176:179], v[180:183]
    s_waitcnt vmcnt(10) lgkmcnt(0)
    s_barrier
    v_mfma_f32_16x16x32_bf16 v[64:67], v[16:19], a[180:183], v[64:67]
    s_add_u32 m0, s70, 0
    ds_read_b64_tr_b16 v[184:185], v9 offset:20480
    v_mfma_f32_16x16x32_bf16 v[104:107], v[16:19], a[184:187], v[104:107]
    ds_read_b64_tr_b16 v[186:187], v9 offset:25600
    v_mfma_f32_16x16x32_bf16 v[144:147], v[16:19], a[188:191], v[144:147]
    buffer_load_dwordx4 v4, s[84:87], s64 offen  lds
    s_add_u32 m0, s70, 1024
    v_mfma_f32_16x16x32_bf16 v[68:71], v[20:23], a[180:183], v[68:71]
    ds_read_b64_tr_b16 v[188:189], v10 offset:20480
    ds_read_b64_tr_b16 v[190:191], v10 offset:25600
    v_mfma_f32_16x16x32_bf16 v[108:111], v[20:23], a[184:187], v[108:111]
    buffer_load_dwordx4 v5, s[84:87], s64 offen  lds
    s_add_u32 m0, s70, 2048
    v_mfma_f32_16x16x32_bf16 v[148:151], v[20:23], a[188:191], v[148:151]
    ds_read_b64_tr_b16 v[192:193], v9 offset:20544
    v_mfma_f32_16x16x32_bf16 v[72:75], v[24:27], a[180:183], v[72:75]
    ds_read_b64_tr_b16 v[194:195], v9 offset:25664
    v_mfma_f32_16x16x32_bf16 v[112:115], v[24:27], a[184:187], v[112:115]
    buffer_load_dwordx4 v6, s[84:87], s64 offen  lds
    s_add_u32 m0, s70, 3072
    v_mfma_f32_16x16x32_bf16 v[152:155], v[24:27], a[188:191], v[152:155]
    ds_read_b64_tr_b16 v[196:197], v10 offset:20544
    ds_read_b64_tr_b16 v[198:199], v10 offset:25664
    v_mfma_f32_16x16x32_bf16 v[76:79], v[28:31], a[180:183], v[76:79]
    buffer_load_dwordx4 v7, s[84:87], s64 offen  lds
    s_add_u32 m0, s70, 4096
    v_mfma_f32_16x16x32_bf16 v[116:119], v[28:31], a[184:187], v[116:119]
    ds_read_b64_tr_b16 v[200:201], v9 offset:20608
    ds_read_b64_tr_b16 v[202:203], v9 offset:25728
    v_mfma_f32_16x16x32_bf16 v[156:159], v[28:31], a[188:191], v[156:159]
    v_mfma_f32_16x16x32_bf16 v[80:83], v[32:35], a[180:183], v[80:83]
    buffer_load_dwordx4 v8, s[84:87], s64 offen  lds
    s_add_u32 s64, s64, 81920
    v_mfma_f32_16x16x32_bf16 v[120:123], v[32:35], a[184:187], v[120:123]
    ds_read_b64_tr_b16 v[204:205], v10 offset:20608
    ds_read_b64_tr_b16 v[206:207], v10 offset:25728
    v_mfma_f32_16x16x32_bf16 v[160:163], v[32:35], a[188:191], v[160:163]
    s_cmp_eq_u32 s64, 1310720
    s_cselect_b32 s64, 0, s64
    v_mfma_f32_16x16x32_bf16 v[84:87], v[36:39], a[180:183], v[84:87]
    ds_read_b64_tr_b16 v[208:209], v9 offset:20672
    ds_read_b64_tr_b16 v[210:211], v9 offset:25792
    v_mfma_f32_16x16x32_bf16 v[124:127], v[36:39], a[184:187], v[124:127]
    ds_read_b64_tr_b16 v[212:213], v10 offset:20672
    v_mfma_f32_16x16x32_bf16 v[164:167], v[36:39], a[188:191], v[164:167]
    buffer_load_dwordx4 a[16:19], v11, s[88:91], s16 offen offset:1024 sc1
    v_mfma_f32_16x16x32_bf16 v[88:91], v[40:43], a[180:183], v[88:91]
    ds_read_b64_tr_b16 v[214:215], v10 offset:25792
    v_mfma_f32_16x16x32_bf16 v[128:131], v[40:43], a[184:187], v[128:131]
    buffer_load_dwordx4 a[20:23], v12, s[88:91], s16 offen offset:1024 sc1
    ds_read_b64_tr_b16 v[216:217], v9 offset:20736
    v_mfma_f32_16x16x32_bf16 v[168:171], v[40:43], a[188:191], v[168:171]
    ds_read_b64_tr_b16 v[218:219], v9 offset:25856
    v_mfma_f32_16x16x32_bf16 v[92:95], v[44:47], a[180:183], v[92:95]
    ds_read_b64_tr_b16 v[220:221], v10 offset:20736
    v_mfma_f32_16x16x32_bf16 v[132:135], v[44:47], a[184:187], v[132:135]
    buffer_load_dwordx4 a[24:27], v0, s[88:91], s16 offen offset:2048 sc1
    ds_read_b64_tr_b16 v[222:223], v10 offset:25856
    v_mfma_f32_16x16x32_bf16 v[172:175], v[44:47], a[188:191], v[172:175]
    v_mfma_f32_16x16x32_bf16 v[96:99], v[48:51], a[180:183], v[96:99]
    buffer_load_dwordx4 a[28:31], v11, s[88:91], s16 offen offset:2048 sc1
    v_mfma_f32_16x16x32_bf16 v[136:139], v[48:51], a[184:187], v[136:139]
    v_mfma_f32_16x16x32_bf16 v[176:179], v[48:51], a[188:191], v[176:179]
    v_mfma_f32_16x16x32_bf16 v[100:103], v[52:55], a[180:183], v[100:103]
    v_mfma_f32_16x16x32_bf16 v[140:143], v[52:55], a[184:187], v[140:143]
    v_mfma_f32_16x16x32_bf16 v[180:183], v[52:55], a[188:191], v[180:183]
    s_waitcnt vmcnt(10) lgkmcnt(0)
L_T1:
    v_mfma_f32_16x16x32_bf16 v[64:67], v[184:187], a[0:3], v[64:67]
    buffer_load_dwordx4 a[32:35], v12, s[88:91], s16 offen offset:2048 sc1
    ds_read_b64_tr_b16 v[16:17], v9 offset:30720
    v_mfma_f32_16x16x32_bf16 v[104:107], v[184:187], a[4:7], v[104:107]
    ds_read_b64_tr_b16 v[18:19], v9 offset:35840
    v_mfma_f32_16x16x32_bf16 v[144:147], v[184:187], a[8:11], v[144:147]
    ds_read_b64_tr_b16 v[20:21], v10 offset:30720
    v_mfma_f32_16x16x32_bf16 v[68:71], v[188:191], a[0:3], v[68:71]
    ds_read_b64_tr_b16 v[22:23], v10 offset:35840
    v_mfma_f32_16x16x32_bf16 v[108:111], v[188:191], a[4:7], v[108:111]
    ds_read_b64_tr_b16 v[24:25], v9 offset:30784
    v_mfma_f32_16x16x32_bf16 v[148:151], v[188:191], a[8:11], v[148:151]
    v_mfma_f32_16x16x32_bf16 v[72:75], v[192:195], a[0:3], v[72:75]
    buffer_load_dwordx4 a[36:39], v0, s[88:91], s16 offen offset:3072 sc1
    ds_read_b64_tr_b16 v[26:27], v9 offset:35904
    v_mfma_f32_16x16x32_bf16 v[112:115], v[192:195], a[4:7], v[112:115]
    ds_read_b64_tr_b16 v[28:29], v10 offset:30784
    v_mfma_f32_16x16x32_bf16 v[152:155], v[192:195], a[8:11], v[152:155]
    ds_read_b64_tr_b16 v[30:31], v10 offset:35904
    v_mfma_f32_16x16x32_bf16 v[76:79], v[196:199], a[0:3], v[76:79]
    ds_read_b64_tr_b16 v[32:33], v9 offset:30848
    v_mfma_f32_16x16x32_bf16 v[116:119], v[196:199], a[4:7], v[116:119]
    ds_read_b64_tr_b16 v[34:35], v9 offset:35968
    v_mfma_f32_16x16x32_bf16 v[156:159], v[196:199], a[8:11], v[156:159]
    v_mfma_f32_16x16x32_bf16 v[80:83], v[200:203], a[0:3], v[80:83]
    ds_read_b64_tr_b16 v[36:37], v10 offset:30848
    v_mfma_f32_16x16x32_bf16 v[120:123], v[200:203], a[4:7], v[120:123]
    buffer_load_dwordx4 a[40:43], v11, s[88:91], s16 offen offset:3072 sc1
    ds_read_b64_tr_b16 v[38:39], v10 offset:35968
    v_mfma_f32_16x16x32_bf16 v[160:163], v[200:203], a[8:11], v[160:163]
    ds_read_b64_tr_b16 v[40:41], v9 offset:30912
    v_mfma_f32_16x16x32_bf16 v[84:87], v[204:207], a[0:3], v[84:87]
    ds_read_b64_tr_b16 v[42:43], v9 offset:36032
    v_mfma_f32_16x16x32_bf16 v[124:127], v[204:207], a[4:7], v[124:127]
    ds_read_b64_tr_b16 v[44:45], v10 offset:30912
    v_mfma_f32_16x16x32_bf16 v[164:167], v[204:207], a[8:11], v[164:167]
    v_mfma_f32_16x16x32_bf16 v[88:91], v[208:211], a[0:3], v[88:91]
    ds_read_b64_tr_b16 v[46:47], v10 offset:36032
    v_mfma_f32_16x16x32_bf16 v[128:131], v[208:211], a[4:7], v[128:131]
    ds_read_b64_tr_b16 v[48:49], v9 offset:30976
    v_mfma_f32_16x16x32_bf16 v[168:171], v[208:211], a[8:11], v[168:171]
    buffer_load_dwordx4 a[44:47], v12, s[88:91], s16 offen offset:3072 sc1
    ds_read_b64_tr_b16 v[50:51], v9 offset:36096
    v_mfma_f32_16x16x32_bf16 v[92:95], v[212:215], a[0:3], v[92:95]
    ds_read_b64_tr_b16 v[52:53], v10 offset:30976
    v_mfma_f32_16x16x32_bf16 v[132:135], v[212:215], a[4:7], v[132:135]
    ds_read_b64_tr_b16 v[54:55], v10 offset:36096
    v_mfma_f32_16x16x32_bf16 v[172:175], v[212:215], a[8:11], v[172:175]
    v_mfma_f32_16x16x32_bf16 v[96:99], v[216:219], a[0:3], v[96:99]
    v_mfma_f32_16x16x32_bf16 v[136:139], v[216:219], a[4:7], v[136:139]
    v_mfma_f32_16x16x32_bf16 v[176:179], v[216:219], a[8:11], v[176:179]
    v_mfma_f32_16x16x32_bf16 v[100:103], v[220:223], a[0:3], v[100:103]
    v_mfma_f32_16x16x32_bf16 v[140:143], v[220:223], a[4:7], v[140:143]
    v_mfma_f32_16x16x32_bf16 v[180:183], v[220:223], a[8:11], v[180:183]
    s_waitcnt vmcnt(6) lgkmcnt(0)
    s_barrier
    v_mfma_f32_16x16x32_bf16 v[64:67], v[16:19], a[12:15], v[64:67]
    s_add_u32 m0, s70, 20480
    ds_read_b64_tr_b16 v[184:185], v9 offset:40960
    v_mfma_f32_16x16x32_bf16 v[104:107], v[16:19], a[16:19], v[104:107]
    ds_read_b64_tr_b16 v[186:187], v9 offset:46080
    v_mfma_f32_16x16x32_bf16 v[144:147], v[16:19], a[20:23], v[144:147]
    buffer_load_dwordx4 v4, s[84:87], s64 offen  lds
    s_add_u32 m0, s70, 21504
    v_mfma_f32_16x16x32_bf16 v[68:71], v[20:23], a[12:15], v[68:71]
    ds_read_b64_tr_b16 v[188:189], v10 offset:40960
    ds_read_b64_tr_b16 v[190:191], v10 offset:46080
    v_mfma_f32_16x16x32_bf16 v[108:111], v[20:23], a[16:19], v[108:111]
    buffer_load_dwordx4 v5, s[84:87], s64 offen  lds
    s_add_u32 m0, s70, 22528
    v_mfma_f32_16x16x32_bf16 v[148:151], v[20:23], a[20:23], v[148:151]
    ds_read_b64_tr_b16 v[192:193], v9 offset:41024
    v_mfma_f32_16x16x32_bf16 v[72:75], v[24:27], a[12:15], v[72:75]
    ds_read_b64_tr_b16 v[194:195], v9 offset:46144
    v_mfma_f32_16x16x32_bf16 v[112:115], v[24:27], a[16:19], v[112:115]
    buffer_load_dwordx4 v6, s[84:87], s64 offen  lds
    s_add_u32 m0, s70, 23552
    v_mfma_f32_16x16x32_bf16 v[152:155], v[24:27], a[20:23], v[152:155]
    ds_read_b64_tr_b16 v[196:197], v10 offset:41024
    ds_read_b64_tr_b16 v[198:199], v10 offset:46144
    v_mfma_f32_16x16x32_bf16 v[76:79], v[28:31], a[12:15], v[76:79]
    buffer_load_dwordx4 v7, s[84:87], s64 offen  lds
    s_add_u32 m0, s70, 24576
    v_mfma_f32_16x16x32_bf16 v[116:119], v[28:31], a[16:19], v[116:119]
    ds_read_b64_tr_b16 v[200:201], v9 offset:41088
    ds_read_b64_tr_b16 v[202:203], v9 offset:46208
    v_mfma_f32_16x16x32_bf16 v[156:159], v[28:31], a[20:23], v[156:159]
    v_mfma_f32_16x16x32_bf16 v[80:83], v[32:35], a[12:15], v[80:83]
    buffer_load_dwordx4 v8, s[84:87], s64 offen  lds
    s_add_u32 s64, s64, 81920
    v_mfma_f32_16x16x32_bf16 v[120:123], v[32:35], a[16:19], v[120:123]
    ds_read_b64_tr_b16 v[204:205], v10 offset:41088
    ds_read_b64_tr_b16 v[206:207], v10 offset:46208
    v_mfma_f32_16x16x32_bf16 v[160:163], v[32:35], a[20:23], v[160:163]
    s_cmp_eq_u32 s64, 1310720
    s_cselect_b32 s64, 0, s64
    v_mfma_f32_16x16x32_bf16 v[84:87], v[36:39], a[12:15], v[84:87]
    ds_read_b64_tr_b16 v[208:209], v9 offset:41152
    ds_read_b64_tr_b16 v[210:211], v9 offset:46272
    v_mfma_f32_16x16x32_bf16 v[124:127], v[36:39], a[16:19], v[124:127]
    ds_read_b64_tr_b16 v[212:213], v10 offset:41152
    v_mfma_f32_16x16x32_bf16 v[164:167], v[36:39], a[20:23], v[164:167]
    buffer_load_dwordx4 a[48:51], v0, s[88:91], s17 offen offset:0 sc1
    v_mfma_f32_16x16x32_bf16 v[88:91], v[40:43], a[12:15], v[88:91]
    ds_read_b64_tr_b16 v[214:215], v10 offset:46272
    v_mfma_f32_16x16x32_bf16 v[128:131], v[40:43], a[16:19], v[128:131]
    buffer_load_dwordx4 a[52:55], v11, s[88:91], s17 offen offset:0 sc1
    ds_read_b64_tr_b16 v[216:217], v9 offset:41216
    v_mfma_f32_16x16x32_bf16 v[168:171], v[40:43], a[20:23], v[168:171]
    ds_read_b64_tr_b16 v[218:219], v9 offset:46336
    v_mfma_f32_16x16x32_bf16 v[92:95], v[44:47], a[12:15], v[92:95]
    ds_read_b64_tr_b16 v[220:221], v10 offset:41216
    v_mfma_f32_16x16x32_bf16 v[132:135], v[44:47], a[16:19], v[132:135]
    buffer_load_dwordx4 a[56:59], v12, s[88:91], s17 offen offset:0 sc1
    ds_read_b64_tr_b16 v[222:223], v10 offset:46336
    v_mfma_f32_16x16x32_bf16 v[172:175], v[44:47], a[20:23], v[172:175]
    v_mfma_f32_16x16x32_bf16 v[96:99], v[48:51], a[12:15], v[96:99]
    buffer_load_dwordx4 a[60:63], v0, s[88:91], s17 offen offset:1024 sc1
    v_mfma_f32_16x16x32_bf16 v[136:139], v[48:51], a[16:19], v[136:139]
    v_mfma_f32_16x16x32_bf16 v[176:179], v[48:51], a[20:23], v[176:179]
    v_mfma_f32_16x16x32_bf16 v[100:103], v[52:55], a[12:15], v[100:103]
    v_mfma_f32_16x16x32_bf16 v[140:143], v[52:55], a[16:19], v[140:143]
    v_mfma_f32_16x16x32_bf16 v[180:183], v[52:55], a[20:23], v[180:183]
    s_waitcnt vmcnt(12) lgkmcnt(0)
    v_mfma_f32_16x16x32_bf16 v[64:67], v[184:187], a[24:27], v[64:67]
    buffer_load_dwordx4 a[64:67], v11, s[88:91], s17 offen offset:1024 sc1
    ds_read_b64_tr_b16 v[16:17], v9 offset:51200
    v_mfma_f32_16x16x32_bf16 v[104:107], v[184:187], a[28:31], v[104:107]
    ds_read_b64_tr_b16 v[18:19], v9 offset:56320
    v_mfma_f32_16x16x32_bf16 v[144:147], v[184:187], a[32:35], v[144:147]
    ds_read_b64_tr_b16 v[20:21], v10 offset:51200
    v_mfma_f32_16x16x32_bf16 v[68:71], v[188:191], a[24:27], v[68:71]
    ds_read_b64_tr_b16 v[22:23], v10 offset:56320
    v_mfma_f32_16x16x32_bf16 v[108:111], v[188:191], a[28:31], v[108:111]
    ds_read_b64_tr_b16 v[24:25], v9 offset:51264
    v_mfma_f32_16x16x32_bf16 v[148:151], v[188:191], a[32:35], v[148:151]
    v_mfma_f32_16x16x32_bf16 v[72:75], v[192:195], a[24:27], v[72:75]
    buffer_load_dwordx4 a[68:71], v12, s[88:91], s17 offen offset:1024 sc1
    ds_read_b64_tr_b16 v[26:27], v9 offset:56384
    v_mfma_f32_16x16x32_bf16 v[112:115], v[192:195], a[28:31], v[112:115]
    ds_read_b64_tr_b16 v[28:29], v10 offset:51264
    v_mfma_f32_16x16x32_bf16 v[152:155], v[192:195], a[32:35], v[152:155]
    ds_read_b64_tr_b16 v[30:31], v10 offset:56384
    v_mfma_f32_16x16x32_bf16 v[76:79], v[196:199], a[24:27], v[76:79]
    ds_read_b64_tr_b16 v[32:33], v9 offset:51328
    v_mfma_f32_16x16x32_bf16 v[116:119], v[196:199], a[28:31], v[116:119]
    ds_read_b64_tr_b16 v[34:35], v9 offset:56448
    v_mfma_f32_16x16x32_bf16 v[156:159], v[196:199], a[32:35], v[156:159]
    v_mfma_f32_16x16x32_bf16 v[80:83], v[200:203], a[24:27], v[80:83]
    ds_read_b64_tr_b16 v[36:37], v10 offset:51328
    v_mfma_f32_16x16x32_bf16 v[120:123], v[200:203], a[28:31], v[120:123]
    buffer_load_dwordx4 a[72:75], v0, s[88:91], s17 offen offset:2048 sc1
    ds_read_b64_tr_b16 v[38:39], v10 offset:56448
    v_mfma_f32_16x16x32_bf16 v[160:163], v[200:203], a[32:35], v[160:163]
    ds_read_b64_tr_b16 v[40:41], v9 offset:51392
    v_mfma_f32_16x16x32_bf16 v[84:87], v[204:207], a[24:27], v[84:87]
    ds_read_b64_tr_b16 v[42:43], v9 offset:56512
    v_mfma_f32_16x16x32_bf16 v[124:127], v[204:207], a[28:31], v[124:127]
    ds_read_b64_tr_b16 v[44:45], v10 offset:51392
    v_mfma_f32_16x16x32_bf16 v[164:167], v[204:207], a[32:35], v[164:167]
    v_mfma_f32_16x16x32_bf16 v[88:91], v[208:211], a[24:27], v[88:91]
    ds_read_b64_tr_b16 v[46:47], v10 offset:56512
    v_mfma_f32_16x16x32_bf16 v[128:131], v[208:211], a[28:31], v[128:131]
    ds_read_b64_tr_b16 v[48:49], v9 offset:51456
    v_mfma_f32_16x16x32_bf16 v[168:171], v[208:211], a[32:35], v[168:171]
    buffer_load_dwordx4 a[76:79], v11, s[88:91], s17 offen offset:2048 sc1
    ds_read_b64_tr_b16 v[50:51], v9 offset:56576
    v_mfma_f32_16x16x32_bf16 v[92:95], v[212:215], a[24:27], v[92:95]
    ds_read_b64_tr_b16 v[52:53], v10 offset:51456
    v_mfma_f32_16x16x32_bf16 v[132:135], v[212:215], a[28:31], v[132:135]
    ds_read_b64_tr_b16 v[54:55], v10 offset:56576
    v_mfma_f32_16x16x32_bf16 v[172:175], v[212:215], a[32:35], v[172:175]
    v_mfma_f32_16x16x32_bf16 v[96:99], v[216:219], a[24:27], v[96:99]
    v_mfma_f32_16x16x32_bf16 v[136:139], v[216:219], a[28:31], v[136:139]
    v_mfma_f32_16x16x32_bf16 v[176:179], v[216:219], a[32:35], v[176:179]
    v_mfma_f32_16x16x32_bf16 v[100:103], v[220:223], a[24:27], v[100:103]
    v_mfma_f32_16x16x32_bf16 v[140:143], v[220:223], a[28:31], v[140:143]
    v_mfma_f32_16x16x32_bf16 v[180:183], v[220:223], a[32:35], v[180:183]
    s_waitcnt vmcnt(13) lgkmcnt(0)
    s_barrier
    v_mfma_f32_16x16x32_bf16 v[64:67], v[16:19], a[36:39], v[64:67]
    s_add_u32 m0, s70, 40960
    ds_read_b64_tr_b16 v[184:185], v9 offset:0
    v_mfma_f32_16x16x32_bf16 v[104:107], v[16:19], a[40:43], v[104:107]
    ds_read_b64_tr_b16 v[186:187], v9 offset:5120
    v_mfma_f32_16x16x32_bf16 v[144:147], v[16:19], a[44:47], v[144:147]
    buffer_load_dwordx4 v4, s[84:87], s64 offen  lds
    s_add_u32 m0, s70, 41984
    v_mfma_f32_16x16x32_bf16 v[68:71], v[20:23], a[36:39], v[68:71]
    ds_read_b64_tr_b16 v[188:189], v10 offset:0
    ds_read_b64_tr_b16 v[190:191], v10 offset:5120
    v_mfma_f32_16x16x32_bf16 v[108:111], v[20:23], a[40:43], v[108:111]
    buffer_load_dwordx4 v5, s[84:87], s64 offen  lds
    s_add_u32 m0, s70, 43008
    v_mfma_f32_16x16x32_bf16 v[148:151], v[20:23], a[44:47], v[148:151]
    ds_read_b64_tr_b16 v[192:193], v9 offset:64
    v_mfma_f32_16x16x32_bf16 v[72:75], v[24:27], a[36:39], v[72:75]
    ds_read_b64_tr_b16 v[194:195], v9 offset:5184
    v_mfma_f32_16x16x32_bf16 v[112:115], v[24:27], a[40:43], v[112:115]
    buffer_load_dwordx4 v6, s[84:87], s64 offen  lds
    s_add_u32 m0, s70, 44032
    v_mfma_f32_16x16x32_bf16 v[152:155], v[24:27], a[44:47], v[152:155]
    ds_read_b64_tr_b16 v[196:197], v10 offset:64
    ds_read_b64_tr_b16 v[198:199], v10 offset:5184
    v_mfma_f32_16x16x32_bf16 v[76:79], v[28:31], a[36:39], v[76:79]
    buffer_load_dwordx4 v7, s[84:87], s64 offen  lds
    s_add_u32 m0, s70, 45056
    v_mfma_f32_16x16x32_bf16 v[116:119], v[28:31], a[40:43], v[116:119]
    ds_read_b64_tr_b16 v[200:201], v9 offset:128
    ds_read_b64_tr_b16 v[202:203], v9 offset:5248
    v_mfma_f32_16x16x32_bf16 v[156:159], v[28:31], a[44:47], v[156:159]
    v_mfma_f32_16x16x32_bf16 v[80:83], v[32:35], a[36:39], v[80:83]
    buffer_load_dwordx4 v8, s[84:87], s64 offen  lds
    s_add_u32 s64, s64, 81920
    v_mfma_f32_16x16x32_bf16 v[120:123], v[32:35], a[40:43], v[120:123]
    ds_read_b64_tr_b16 v[204:205], v10 offset:128
    ds_read_b64_tr_b16 v[206:207], v10 offset:5248
    v_mfma_f32_16x16x32_bf16 v[160:163], v[32:35], a[44:47], v[160:163]
    s_cmp_eq_u32 s64, 1310720
    s_cselect_b32 s64, 0, s64
    v_mfma_f32_16x16x32_bf16 v[84:87], v[36:39], a[36:39], v[84:87]
    ds_read_b64_tr_b16 v[208:209], v9 offset:192
    ds_read_b64_tr_b16 v[210:211], v9 offset:5312
    v_mfma_f32_16x16x32_bf16 v[124:127], v[36:39], a[40:43], v[124:127]
    ds_read_b64_tr_b16 v[212:213], v10 offset:192
    v_mfma_f32_16x16x32_bf16 v[164:167], v[36:39], a[44:47], v[164:167]
    buffer_load_dwordx4 a[80:83], v12, s[88:91], s17 offen offset:2048 sc1
    v_mfma_f32_16x16x32_bf16 v[88:91], v[40:43], a[36:39], v[88:91]
    ds_read_b64_tr_b16 v[214:215], v10 offset:5312
    v_mfma_f32_16x16x32_bf16 v[128:131], v[40:43], a[40:43], v[128:131]
    buffer_load_dwordx4 a[84:87], v0, s[88:91], s17 offen offset:3072 sc1
    ds_read_b64_tr_b16 v[216:217], v9 offset:256
    v_mfma_f32_16x16x32_bf16 v[168:171], v[40:43], a[44:47], v[168:171]
    ds_read_b64_tr_b16 v[218:219], v9 offset:5376
    v_mfma_f32_16x16x32_bf16 v[92:95], v[44:47], a[36:39], v[92:95]
    ds_read_b64_tr_b16 v[220:221], v10 offset:256
    v_mfma_f32_16x16x32_bf16 v[132:135], v[44:47], a[40:43], v[132:135]
    buffer_load_dwordx4 a[88:91], v11, s[88:91], s17 offen offset:3072 sc1
    ds_read_b64_tr_b16 v[222:223], v10 offset:5376
    v_mfma_f32_16x16x32_bf16 v[172:175], v[44:47], a[44:47], v[172:175]
    v_mfma_f32_16x16x32_bf16 v[96:99], v[48:51], a[36:39], v[96:99]
    buffer_load_dwordx4 a[92:95], v12, s[88:91], s17 offen offset:3072 sc1
    v_mfma_f32_16x16x32_bf16 v[136:139], v[48:51], a[40:43], v[136:139]
    v_mfma_f32_16x16x32_bf16 v[176:179], v[48:51], a[44:47], v[176:179]
    v_mfma_f32_16x16x32_bf16 v[100:103], v[52:55], a[36:39], v[100:103]
    v_mfma_f32_16x16x32_bf16 v[140:143], v[52:55], a[40:43], v[140:143]
    v_mfma_f32_16x16x32_bf16 v[180:183], v[52:55], a[44:47], v[180:183]
    s_waitcnt vmcnt(14) lgkmcnt(0)
    s_and_b64 s[10:11], s[22:23], s[26:27]
    s_cbranch_scc0 L_PA2_OK
    s_mov_b32 s79, 1048576
L_PA2:
    global_load_dwordx2 v[228:229], v59, s[40:41] sc1
    s_waitcnt vmcnt(0)
    v_cmp_ne_u64 s[22:23], v[228:229], v[56:57]
    s_sub_u32 s79, s79, 1
    s_cbranch_scc1 L_PA2_OK
    s_and_b64 s[10:11], s[22:23], s[26:27]
    s_cbranch_scc1 L_PA2
L_PA2_OK:
    v_mfma_f32_16x16x32_bf16 v[64:67], v[184:187], a[48:51], v[64:67]
    buffer_load_dwordx4 a[96:99], v0, s[88:91], s18 offen offset:0 sc1
    ds_read_b64_tr_b16 v[16:17], v9 offset:10240
    v_mfma_f32_16x16x32_bf16 v[104:107], v[184:187], a[52:55], v[104:107]
    ds_read_b64_tr_b16 v[18:19], v9 offset:15360
    v_mfma_f32_16x16x32_bf16 v[144:147], v[184:187], a[56:59], v[144:147]
    ds_read_b64_tr_b16 v[20:21], v10 offset:10240
    v_mfma_f32_16x16x32_bf16 v[68:71], v[188:191], a[48:51], v[68:71]
    ds_read_b64_tr_b16 v[22:23], v10 offset:15360
    v_mfma_f32_16x16x32_bf16 v[108:111], v[188:191], a[52:55], v[108:111]
    ds_read_b64_tr_b16 v[24:25], v9 offset:10304
    v_mfma_f32_16x16x32_bf16 v[148:151], v[188:191], a[56:59], v[148:151]
    v_mfma_f32_16x16x32_bf16 v[72:75], v[192:195], a[48:51], v[72:75]
    buffer_load_dwordx4 a[100:103], v11, s[88:91], s18 offen offset:0 sc1
    ds_read_b64_tr_b16 v[26:27], v9 offset:15424
    v_mfma_f32_16x16x32_bf16 v[112:115], v[192:195], a[52:55], v[112:115]
    ds_read_b64_tr_b16 v[28:29], v10 offset:10304
    v_mfma_f32_16x16x32_bf16 v[152:155], v[192:195], a[56:59], v[152:155]
    ds_read_b64_tr_b16 v[30:31], v10 offset:15424
    v_mfma_f32_16x16x32_bf16 v[76:79], v[196:199], a[48:51], v[76:79]
    ds_read_b64_tr_b16 v[32:33], v9 offset:10368
    v_mfma_f32_16x16x32_bf16 v[116:119], v[196:199], a[52:55], v[116:119]
    ds_read_b64_tr_b16 v[34:35], v9 offset:15488
    v_mfma_f32_16x16x32_bf16 v[156:159], v[196:199], a[56:59], v[156:159]
    v_mfma_f32_16x16x32_bf16 v[80:83], v[200:203], a[48:51], v[80:83]
    ds_read_b64_tr_b16 v[36:37], v10 offset:10368
    v_mfma_f32_16x16x32_bf16 v[120:123], v[200:203], a[52:55], v[120:123]
    buffer_load_dwordx4 a[104:107], v12, s[88:91], s18 offen offset:0 sc1
    ds_read_b64_tr_b16 v[38:39], v10 offset:15488
    v_mfma_f32_16x16x32_bf16 v[160:163], v[200:203], a[56:59], v[160:163]
    ds_read_b64_tr_b16 v[40:41], v9 offset:10432
    v_mfma_f32_16x16x32_bf16 v[84:87], v[204:207], a[48:51], v[84:87]
    ds_read_b64_tr_b16 v[42:43], v9 offset:15552
    v_mfma_f32_16x16x32_bf16 v[124:127], v[204:207], a[52:55], v[124:127]
    ds_read_b64_tr_b16 v[44:45], v10 offset:10432
    v_mfma_f32_16x16x32_bf16 v[164:167], v[204:207], a[56:59], v[164:167]
    v_mfma_f32_16x16x32_bf16 v[88:91], v[208:211], a[48:51], v[88:91]
    ds_read_b64_tr_b16 v[46:47], v10 offset:15552
    v_mfma_f32_16x16x32_bf16 v[128:131], v[208:211], a[52:55], v[128:131]
    ds_read_b64_tr_b16 v[48:49], v9 offset:10496
    v_mfma_f32_16x16x32_bf16 v[168:171], v[208:211], a[56:59], v[168:171]
    buffer_load_dwordx4 a[108:111], v0, s[88:91], s18 offen offset:1024 sc1
    ds_read_b64_tr_b16 v[50:51], v9 offset:15616
    v_mfma_f32_16x16x32_bf16 v[92:95], v[212:215], a[48:51], v[92:95]
    ds_read_b64_tr_b16 v[52:53], v10 offset:10496
    v_mfma_f32_16x16x32_bf16 v[132:135], v[212:215], a[52:55], v[132:135]
    ds_read_b64_tr_b16 v[54:55], v10 offset:15616
    v_mfma_f32_16x16x32_bf16 v[172:175], v[212:215], a[56:59], v[172:175]
    v_mfma_f32_16x16x32_bf16 v[96:99], v[216:219], a[48:51], v[96:99]
    v_mfma_f32_16x16x32_bf16 v[136:139], v[216:219], a[52:55], v[136:139]
    v_mfma_f32_16x16x32_bf16 v[176:179], v[216:219], a[56:59], v[176:179]
    v_mfma_f32_16x16x32_bf16 v[100:103], v[220:223], a[48:51], v[100:103]
    v_mfma_f32_16x16x32_bf16 v[140:143], v[220:223], a[52:55], v[140:143]
    v_mfma_f32_16x16x32_bf16 v[180:183], v[220:223], a[56:59], v[180:183]
    s_waitcnt vmcnt(15) lgkmcnt(0)
    s_barrier
    v_mfma_f32_16x16x32_bf16 v[64:67], v[16:19], a[60:63], v[64:67]
    s_add_u32 m0, s70, 0
    ds_read_b64_tr_b16 v[184:185], v9 offset:20480
    v_mfma_f32_16x16x32_bf16 v[104:107], v[16:19], a[64:67], v[104:107]
    ds_read_b64_tr_b16 v[186:187], v9 offset:25600
    v_mfma_f32_16x16x32_bf16 v[144:147], v[16:19], a[68:71], v[144:147]
    buffer_load_dwordx4 v4, s[84:87], s64 offen  lds
    s_add_u32 m0, s70, 1024
    v_mfma_f32_16x16x32_bf16 v[68:71], v[20:23], a[60:63], v[68:71]
    ds_read_b64_tr_b16 v[188:189], v10 offset:20480
    ds_read_b64_tr_b16 v[190:191], v10 offset:25600
    v_mfma_f32_16x16x32_bf16 v[108:111], v[20:23], a[64:67], v[108:111]
    buffer_load_dwordx4 v5, s[84:87], s64 offen  lds
    s_add_u32 m0, s70, 2048
    v_mfma_f32_16x16x32_bf16 v[148:151], v[20:23], a[68:71], v[148:151]
    ds_read_b64_tr_b16 v[192:193], v9 offset:20544
    v_mfma_f32_16x16x32_bf16 v[72:75], v[24:27], a[60:63], v[72:75]
    ds_read_b64_tr_b16 v[194:195], v9 offset:25664
    v_mfma_f32_16x16x32_bf16 v[112:115], v[24:27], a[64:67], v[112:115]
    buffer_load_dwordx4 v6, s[84:87], s64 offen  lds
    s_add_u32 m0, s70, 3072
    v_mfma_f32_16x16x32_bf16 v[152:155], v[24:27], a[68:71], v[152:155]
    ds_read_b64_tr_b16 v[196:197], v10 offset:20544
    ds_read_b64_tr_b16 v[198:199], v10 offset:25664
    v_mfma_f32_16x16x32_bf16 v[76:79], v[28:31], a[60:63], v[76:79]
    buffer_load_dwordx4 v7, s[84:87], s64 offen  lds
    s_add_u32 m0, s70, 4096
    v_mfma_f32_16x16x32_bf16 v[116:119], v[28:31], a[64:67], v[116:119]
    ds_read_b64_tr_b16 v[200:201], v9 offset:20608
    ds_read_b64_tr_b16 v[202:203], v9 offset:25728
    v_mfma_f32_16x16x32_bf16 v[156:159], v[28:31], a[68:71], v[156:159]
    v_mfma_f32_16x16x32_bf16 v[80:83], v[32:35], a[60:63], v[80:83]
    buffer_load_dwordx4 v8, s[84:87], s64 offen  lds
    s_add_u32 s64, s64, 81920
    v_mfma_f32_16x16x32_bf16 v[120:123], v[32:35], a[64:67], v[120:123]
    ds_read_b64_tr_b16 v[204:205], v10 offset:20608
    ds_read_b64_tr_b16 v[206:207], v10 offset:25728
    v_mfma_f32_16x16x32_bf16 v[160:163], v[32:35], a[68:71], v[160:163]
    s_cmp_eq_u32 s64, 1310720
    s_cselect_b32 s64, 0, s64
    v_mfma_f32_16x16x32_bf16 v[84:87], v[36:39], a[60:63], v[84:87]
    ds_read_b64_tr_b16 v[208:209], v9 offset:20672
    ds_read_b64_tr_b16 v[210:211], v9 offset:25792
    v_mfma_f32_16x16x32_bf16 v[124:127], v[36:39], a[64:67], v[124:127]
    ds_read_b64_tr_b16 v[212:213], v10 offset:20672
    v_mfma_f32_16x16x32_bf16 v[164:167], v[36:39], a[68:71], v[164:167]
    buffer_load_dwordx4 a[112:115], v11, s[88:91], s18 offen offset:1024 sc1
    v_mfma_f32_16x16x32_bf16 v[88:91], v[40:43], a[60:63], v[88:91]
    ds_read_b64_tr_b16 v[214:215], v10 offset:25792
    v_mfma_f32_16x16x32_bf16 v[128:131], v[40:43], a[64:67], v[128:131]
    buffer_load_dwordx4 a[116:119], v12, s[88:91], s18 offen offset:1024 sc1
    ds_read_b64_tr_b16 v[216:217], v9 offset:20736
    v_mfma_f32_16x16x32_bf16 v[168:171], v[40:43], a[68:71], v[168:171]
    ds_read_b64_tr_b16 v[218:219], v9 offset:25856
    v_mfma_f32_16x16x32_bf16 v[92:95], v[44:47], a[60:63], v[92:95]
    ds_read_b64_tr_b16 v[220:221], v10 offset:20736
    v_mfma_f32_16x16x32_bf16 v[132:135], v[44:47], a[64:67], v[132:135]
    buffer_load_dwordx4 a[120:123], v0, s[88:91], s18 offen offset:2048 sc1
    ds_read_b64_tr_b16 v[222:223], v10 offset:25856
    v_mfma_f32_16x16x32_bf16 v[172:175], v[44:47], a[68:71], v[172:175]
    v_mfma_f32_16x16x32_bf16 v[96:99], v[48:51], a[60:63], v[96:99]
    buffer_load_dwordx4 a[124:127], v11, s[88:91], s18 offen offset:2048 sc1
    v_mfma_f32_16x16x32_bf16 v[136:139], v[48:51], a[64:67], v[136:139]
    v_mfma_f32_16x16x32_bf16 v[176:179], v[48:51], a[68:71], v[176:179]
    v_mfma_f32_16x16x32_bf16 v[100:103], v[52:55], a[60:63], v[100:103]
    v_mfma_f32_16x16x32_bf16 v[140:143], v[52:55], a[64:67], v[140:143]
    v_mfma_f32_16x16x32_bf16 v[180:183], v[52:55], a[68:71], v[180:183]
    s_waitcnt vmcnt(16) lgkmcnt(0)
    v_mfma_f32_16x16x32_bf16 v[64:67], v[184:187], a[72:75], v[64:67]
    buffer_load_dwordx4 a[128:131], v12, s[88:91], s18 offen offset:2048 sc1
    ds_read_b64_tr_b16 v[16:17], v9 offset:30720
    v_mfma_f32_16x16x32_bf16 v[104:107], v[184:187], a[76:79], v[104:107]
    ds_read_b64_tr_b16 v[18:19], v9 offset:35840
    v_mfma_f32_16x16x32_bf16 v[144:147], v[184:187], a[80:83], v[144:147]
    ds_read_b64_tr_b16 v[20:21], v10 offset:30720
    v_mfma_f32_16x16x32_bf16 v[68:71], v[188:191], a[72:75], v[68:71]
    ds_read_b64_tr_b16 v[22:23], v10 offset:35840
    v_mfma_f32_16x16x32_bf16 v[108:111], v[188:191], a[76:79], v[108:111]
    ds_read_b64_tr_b16 v[24:25], v9 offset:30784
    v_mfma_f32_16x16x32_bf16 v[148:151], v[188:191], a[80:83], v[148:151]
    v_mfma_f32_16x16x32_bf16 v[72:75], v[192:195], a[72:75], v[72:75]
    buffer_load_dwordx4 a[132:135], v0, s[88:91], s18 offen offset:3072 sc1
    ds_read_b64_tr_b16 v[26:27], v9 offset:35904
    v_mfma_f32_16x16x32_bf16 v[112:115], v[192:195], a[76:79], v[112:115]
    ds_read_b64_tr_b16 v[28:29], v10 offset:30784
    v_mfma_f32_16x16x32_bf16 v[152:155], v[192:195], a[80:83], v[152:155]
    ds_read_b64_tr_b16 v[30:31], v10 offset:35904
    v_mfma_f32_16x16x32_bf16 v[76:79], v[196:199], a[72:75], v[76:79]
    ds_read_b64_tr_b16 v[32:33], v9 offset:30848
    v_mfma_f32_16x16x32_bf16 v[116:119], v[196:199], a[76:79], v[116:119]
    ds_read_b64_tr_b16 v[34:35], v9 offset:35968
    v_mfma_f32_16x16x32_bf16 v[156:159], v[196:199], a[80:83], v[156:159]
    v_mfma_f32_16x16x32_bf16 v[80:83], v[200:203], a[72:75], v[80:83]
    ds_read_b64_tr_b16 v[36:37], v10 offset:30848
    v_mfma_f32_16x16x32_bf16 v[120:123], v[200:203], a[76:79], v[120:123]
    buffer_load_dwordx4 a[136:139], v11, s[88:91], s18 offen offset:3072 sc1
    ds_read_b64_tr_b16 v[38:39], v10 offset:35968
    v_mfma_f32_16x16x32_bf16 v[160:163], v[200:203], a[80:83], v[160:163]
    ds_read_b64_tr_b16 v[40:41], v9 offset:30912
    v_mfma_f32_16x16x32_bf16 v[84:87], v[204:207], a[72:75], v[84:87]
    ds_read_b64_tr_b16 v[42:43], v9 offset:36032
    v_mfma_f32_16x16x32_bf16 v[124:127], v[204:207], a[76:79], v[124:127]
    ds_read_b64_tr_b16 v[44:45], v10 offset:30912
    v_mfma_f32_16x16x32_bf16 v[164:167], v[204:207], a[80:83], v[164:167]
    v_mfma_f32_16x16x32_bf16 v[88:91], v[208:211], a[72:75], v[88:91]
    ds_read_b64_tr_b16 v[46:47], v10 offset:36032
    v_mfma_f32_16x16x32_bf16 v[128:131], v[208:211], a[76:79], v[128:131]
    ds_read_b64_tr_b16 v[48:49], v9 offset:30976
    v_mfma_f32_16x16x32_bf16 v[168:171], v[208:211], a[80:83], v[168:171]
    buffer_load_dwordx4 a[140:143], v12, s[88:91], s18 offen offset:3072 sc1
    ds_read_b64_tr_b16 v[50:51], v9 offset:36096
    v_mfma_f32_16x16x32_bf16 v[92:95], v[212:215], a[72:75], v[92:95]
    ds_read_b64_tr_b16 v[52:53], v10 offset:30976
    v_mfma_f32_16x16x32_bf16 v[132:135], v[212:215], a[76:79], v[132:135]
    ds_read_b64_tr_b16 v[54:55], v10 offset:36096
    v_mfma_f32_16x16x32_bf16 v[172:175], v[212:215], a[80:83], v[172:175]
    v_mfma_f32_16x16x32_bf16 v[96:99], v[216:219], a[72:75], v[96:99]
    v_mfma_f32_16x16x32_bf16 v[136:139], v[216:219], a[76:79], v[136:139]
    v_mfma_f32_16x16x32_bf16 v[176:179], v[216:219], a[80:83], v[176:179]
    v_mfma_f32_16x16x32_bf16 v[100:103], v[220:223], a[72:75], v[100:103]
    v_mfma_f32_16x16x32_bf16 v[140:143], v[220:223], a[76:79], v[140:143]
    v_mfma_f32_16x16x32_bf16 v[180:183], v[220:223], a[80:83], v[180:183]
    s_waitcnt vmcnt(17) lgkmcnt(0)
    s_barrier
    v_mfma_f32_16x16x32_bf16 v[64:67], v[16:19], a[84:87], v[64:67]
    s_add_u32 m0, s70, 20480
    ds_read_b64_tr_b16 v[184:185], v9 offset:40960
    v_mfma_f32_16x16x32_bf16 v[104:107], v[16:19], a[88:91], v[104:107]
    ds_read_b64_tr_b16 v[186:187], v9 offset:46080
    v_mfma_f32_16x16x32_bf16 v[144:147], v[16:19], a[92:95], v[144:147]
    buffer_load_dwordx4 v4, s[84:87], s64 offen  lds
    s_add_u32 m0, s70, 21504
    v_mfma_f32_16x16x32_bf16 v[68:71], v[20:23], a[84:87], v[68:71]
    ds_read_b64_tr_b16 v[188:189], v10 offset:40960
    ds_read_b64_tr_b16 v[190:191], v10 offset:46080
    v_mfma_f32_16x16x32_bf16 v[108:111], v[20:23], a[88:91], v[108:111]
    buffer_load_dwordx4 v5, s[84:87], s64 offen  lds
    s_add_u32 m0, s70, 22528
    v_mfma_f32_16x16x32_bf16 v[148:151], v[20:23], a[92:95], v[148:151]
    ds_read_b64_tr_b16 v[192:193], v9 offset:41024
    v_mfma_f32_16x16x32_bf16 v[72:75], v[24:27], a[84:87], v[72:75]
    ds_read_b64_tr_b16 v[194:195], v9 offset:46144
    v_mfma_f32_16x16x32_bf16 v[112:115], v[24:27], a[88:91], v[112:115]
    buffer_load_dwordx4 v6, s[84:87], s64 offen  lds
    s_add_u32 m0, s70, 23552
    v_mfma_f32_16x16x32_bf16 v[152:155], v[24:27], a[92:95], v[152:155]
    ds_read_b64_tr_b16 v[196:197], v10 offset:41024
    ds_read_b64_tr_b16 v[198:199], v10 offset:46144
    v_mfma_f32_16x16x32_bf16 v[76:79], v[28:31], a[84:87], v[76:79]
    buffer_load_dwordx4 v7, s[84:87], s64 offen  lds
    s_add_u32 m0, s70, 24576
    v_mfma_f32_16x16x32_bf16 v[116:119], v[28:31], a[88:91], v[116:119]
    ds_read_b64_tr_b16 v[200:201], v9 offset:41088
    ds_read_b64_tr_b16 v[202:203], v9 offset:46208
    v_mfma_f32_16x16x32_bf16 v[156:159], v[28:31], a[92:95], v[156:159]
    v_mfma_f32_16x16x32_bf16 v[80:83], v[32:35], a[84:87], v[80:83]
    buffer_load_dwordx4 v8, s[84:87], s64 offen  lds
    s_add_u32 s64, s64, 81920
    v_mfma_f32_16x16x32_bf16 v[120:123], v[32:35], a[88:91], v[120:123]
    ds_read_b64_tr_b16 v[204:205], v10 offset:41088
    ds_read_b64_tr_b16 v[206:207], v10 offset:46208
    v_mfma_f32_16x16x32_bf16 v[160:163], v[32:35], a[92:95], v[160:163]
    s_cmp_eq_u32 s64, 1310720
    s_cselect_b32 s64, 0, s64
    v_mfma_f32_16x16x32_bf16 v[84:87], v[36:39], a[84:87], v[84:87]
    ds_read_b64_tr_b16 v[208:209], v9 offset:41152
    ds_read_b64_tr_b16 v[210:211], v9 offset:46272
    v_mfma_f32_16x16x32_bf16 v[124:127], v[36:39], a[88:91], v[124:127]
    ds_read_b64_tr_b16 v[212:213], v10 offset:41152
    v_mfma_f32_16x16x32_bf16 v[164:167], v[36:39], a[92:95], v[164:167]
    buffer_load_dwordx4 a[144:147], v0, s[88:91], s19 offen offset:0 sc1
    v_mfma_f32_16x16x32_bf16 v[88:91], v[40:43], a[84:87], v[88:91]
    ds_read_b64_tr_b16 v[214:215], v10 offset:46272
    v_mfma_f32_16x16x32_bf16 v[128:131], v[40:43], a[88:91], v[128:131]
    buffer_load_dwordx4 a[148:151], v11, s[88:91], s19 offen offset:0 sc1
    ds_read_b64_tr_b16 v[216:217], v9 offset:41216
    v_mfma_f32_16x16x32_bf16 v[168:171], v[40:43], a[92:95], v[168:171]
    ds_read_b64_tr_b16 v[218:219], v9 offset:46336
    v_mfma_f32_16x16x32_bf16 v[92:95], v[44:47], a[84:87], v[92:95]
    ds_read_b64_tr_b16 v[220:221], v10 offset:41216
    v_mfma_f32_16x16x32_bf16 v[132:135], v[44:47], a[88:91], v[132:135]
    buffer_load_dwordx4 a[152:155], v12, s[88:91], s19 offen offset:0 sc1
    ds_read_b64_tr_b16 v[222:223], v10 offset:46336
    v_mfma_f32_16x16x32_bf16 v[172:175], v[44:47], a[92:95], v[172:175]
    v_mfma_f32_16x16x32_bf16 v[96:99], v[48:51], a[84:87], v[96:99]
    buffer_load_dwordx4 a[156:159], v0, s[88:91], s19 offen offset:1024 sc1
    v_mfma_f32_16x16x32_bf16 v[136:139], v[48:51], a[88:91], v[136:139]
    v_mfma_f32_16x16x32_bf16 v[176:179], v[48:51], a[92:95], v[176:179]
    v_mfma_f32_16x16x32_bf16 v[100:103], v[52:55], a[84:87], v[100:103]
    v_mfma_f32_16x16x32_bf16 v[140:143], v[52:55], a[88:91], v[140:143]
    v_mfma_f32_16x16x32_bf16 v[180:183], v[52:55], a[92:95], v[180:183]
    s_waitcnt vmcnt(23) lgkmcnt(0)
    v_mfma_f32_16x16x32_bf16 v[64:67], v[184:187], a[96:99], v[64:67]
    buffer_load_dwordx4 a[160:163], v11, s[88:91], s19 offen offset:1024 sc1
    ds_read_b64_tr_b16 v[16:17], v9 offset:51200
    v_mfma_f32_16x16x32_bf16 v[104:107], v[184:187], a[100:103], v[104:107]
    ds_read_b64_tr_b16 v[18:19], v9 offset:56320
    v_mfma_f32_16x16x32_bf16 v[144:147], v[184:187], a[104:107], v[144:147]
    ds_read_b64_tr_b16 v[20:21], v10 offset:51200
    v_mfma_f32_16x16x32_bf16 v[68:71], v[188:191], a[96:99], v[68:71]
    ds_read_b64_tr_b16 v[22:23], v10 offset:56320
    v_mfma_f32_16x16x32_bf16 v[108:111], v[188:191], a[100:103], v[108:111]
    ds_read_b64_tr_b16 v[24:25], v9 offset:51264
    v_mfma_f32_16x16x32_bf16 v[148:151], v[188:191], a[104:107], v[148:151]
    v_mfma_f32_16x16x32_bf16 v[72:75], v[192:195], a[96:99], v[72:75]
    buffer_load_dwordx4 a[164:167], v12, s[88:91], s19 offen offset:1024 sc1
    ds_read_b64_tr_b16 v[26:27], v9 offset:56384
    v_mfma_f32_16x16x32_bf16 v[112:115], v[192:195], a[100:103], v[112:115]
    ds_read_b64_tr_b16 v[28:29], v10 offset:51264
    v_mfma_f32_16x16x32_bf16 v[152:155], v[192:195], a[104:107], v[152:155]
    ds_read_b64_tr_b16 v[30:31], v10 offset:56384
    v_mfma_f32_16x16x32_bf16 v[76:79], v[196:199], a[96:99], v[76:79]
    ds_read_b64_tr_b16 v[32:33], v9 offset:51328
    v_mfma_f32_16x16x32_bf16 v[116:119], v[196:199], a[100:103], v[116:119]
    ds_read_b64_tr_b16 v[34:35], v9 offset:56448
    v_mfma_f32_16x16x32_bf16 v[156:159], v[196:199], a[104:107], v[156:159]
    v_mfma_f32_16x16x32_bf16 v[80:83], v[200:203], a[96:99], v[80:83]
    ds_read_b64_tr_b16 v[36:37], v10 offset:51328
    v_mfma_f32_16x16x32_bf16 v[120:123], v[200:203], a[100:103], v[120:123]
    buffer_load_dwordx4 a[168:171], v0, s[88:91], s19 offen offset:2048 sc1
    ds_read_b64_tr_b16 v[38:39], v10 offset:56448
    v_mfma_f32_16x16x32_bf16 v[160:163], v[200:203], a[104:107], v[160:163]
    ds_read_b64_tr_b16 v[40:41], v9 offset:51392
    v_mfma_f32_16x16x32_bf16 v[84:87], v[204:207], a[96:99], v[84:87]
    ds_read_b64_tr_b16 v[42:43], v9 offset:56512
    v_mfma_f32_16x16x32_bf16 v[124:127], v[204:207], a[100:103], v[124:127]
    ds_read_b64_tr_b16 v[44:45], v10 offset:51392
    v_mfma_f32_16x16x32_bf16 v[164:167], v[204:207], a[104:107], v[164:167]
    v_mfma_f32_16x16x32_bf16 v[88:91], v[208:211], a[96:99], v[88:91]
    ds_read_b64_tr_b16 v[46:47], v10 offset:56512
    v_mfma_f32_16x16x32_bf16 v[128:131], v[208:211], a[100:103], v[128:131]
    ds_read_b64_tr_b16 v[48:49], v9 offset:51456
    v_mfma_f32_16x16x32_bf16 v[168:171], v[208:211], a[104:107], v[168:171]
    buffer_load_dwordx4 a[172:175], v11, s[88:91], s19 offen offset:2048 sc1
    ds_read_b64_tr_b16 v[50:51], v9 offset:56576
    v_mfma_f32_16x16x32_bf16 v[92:95], v[212:215], a[96:99], v[92:95]
    ds_read_b64_tr_b16 v[52:53], v10 offset:51456
    v_mfma_f32_16x16x32_bf16 v[132:135], v[212:215], a[100:103], v[132:135]
    ds_read_b64_tr_b16 v[54:55], v10 offset:56576
    v_mfma_f32_16x16x32_bf16 v[172:175], v[212:215], a[104:107], v[172:175]
    v_mfma_f32_16x16x32_bf16 v[96:99], v[216:219], a[96:99], v[96:99]
    v_mfma_f32_16x16x32_bf16 v[136:139], v[216:219], a[100:103], v[136:139]
    v_mfma_f32_16x16x32_bf16 v[176:179], v[216:219], a[104:107], v[176:179]
    v_mfma_f32_16x16x32_bf16 v[100:103], v[220:223], a[96:99], v[100:103]
    v_mfma_f32_16x16x32_bf16 v[140:143], v[220:223], a[100:103], v[140:143]
    v_mfma_f32_16x16x32_bf16 v[180:183], v[220:223], a[104:107], v[180:183]
    s_waitcnt vmcnt(19) lgkmcnt(0)
    s_barrier
    v_mfma_f32_16x16x32_bf16 v[64:67], v[16:19], a[108:111], v[64:67]
    s_add_u32 m0, s70, 40960
    ds_read_b64_tr_b16 v[184:185], v9 offset:0
    v_mfma_f32_16x16x32_bf16 v[104:107], v[16:19], a[112:115], v[104:107]
    ds_read_b64_tr_b16 v[186:187], v9 offset:5120
    v_mfma_f32_16x16x32_bf16 v[144:147], v[16:19], a[116:119], v[144:147]
    buffer_load_dwordx4 v4, s[84:87], s64 offen  lds
    s_add_u32 m0, s70, 41984
    v_mfma_f32_16x16x32_bf16 v[68:71], v[20:23], a[108:111], v[68:71]
    ds_read_b64_tr_b16 v[188:189], v10 offset:0
    ds_read_b64_tr_b16 v[190:191], v10 offset:5120
    v_mfma_f32_16x16x32_bf16 v[108:111], v[20:23], a[112:115], v[108:111]
    buffer_load_dwordx4 v5, s[84:87], s64 offen  lds
    s_add_u32 m0, s70, 43008
    v_mfma_f32_16x16x32_bf16 v[148:151], v[20:23], a[116:119], v[148:151]
    ds_read_b64_tr_b16 v[192:193], v9 offset:64
    v_mfma_f32_16x16x32_bf16 v[72:75], v[24:27], a[108:111], v[72:75]
    ds_read_b64_tr_b16 v[194:195], v9 offset:5184
    v_mfma_f32_16x16x32_bf16 v[112:115], v[24:27], a[112:115], v[112:115]
    buffer_load_dwordx4 v6, s[84:87], s64 offen  lds
    s_add_u32 m0, s70, 44032
    v_mfma_f32_16x16x32_bf16 v[152:155], v[24:27], a[116:119], v[152:155]
    ds_read_b64_tr_b16 v[196:197], v10 offset:64
    ds_read_b64_tr_b16 v[198:199], v10 offset:5184
    v_mfma_f32_16x16x32_bf16 v[76:79], v[28:31], a[108:111], v[76:79]
    buffer_load_dwordx4 v7, s[84:87], s64 offen  lds
    s_add_u32 m0, s70, 45056
    v_mfma_f32_16x16x32_bf16 v[116:119], v[28:31], a[112:115], v[116:119]
    ds_read_b64_tr_b16 v[200:201], v9 offset:128
    ds_read_b64_tr_b16 v[202:203], v9 offset:5248
    v_mfma_f32_16x16x32_bf16 v[156:159], v[28:31], a[116:119], v[156:159]
    v_mfma_f32_16x16x32_bf16 v[80:83], v[32:35], a[108:111], v[80:83]
    buffer_load_dwordx4 v8, s[84:87], s64 offen  lds
    s_add_u32 s64, s64, 81920
    v_mfma_f32_16x16x32_bf16 v[120:123], v[32:35], a[112:115], v[120:123]
    ds_read_b64_tr_b16 v[204:205], v10 offset:128
    ds_read_b64_tr_b16 v[206:207], v10 offset:5248
    v_mfma_f32_16x16x32_bf16 v[160:163], v[32:35], a[116:119], v[160:163]
    s_cmp_eq_u32 s64, 1310720
    s_cselect_b32 s64, 0, s64
    v_mfma_f32_16x16x32_bf16 v[84:87], v[36:39], a[108:111], v[84:87]
    ds_read_b64_tr_b16 v[208:209], v9 offset:192
    ds_read_b64_tr_b16 v[210:211], v9 offset:5312
    v_mfma_f32_16x16x32_bf16 v[124:127], v[36:39], a[112:115], v[124:127]
    ds_read_b64_tr_b16 v[212:213], v10 offset:192
    v_mfma_f32_16x16x32_bf16 v[164:167], v[36:39], a[116:119], v[164:167]
    buffer_load_dwordx4 a[176:179], v12, s[88:91], s19 offen offset:2048 sc1
    v_mfma_f32_16x16x32_bf16 v[88:91], v[40:43], a[108:111], v[88:91]
    ds_read_b64_tr_b16 v[214:215], v10 offset:5312
    v_mfma_f32_16x16x32_bf16 v[128:131], v[40:43], a[112:115], v[128:131]
    buffer_load_dwordx4 a[180:183], v0, s[88:91], s19 offen offset:3072 sc1
    ds_read_b64_tr_b16 v[216:217], v9 offset:256
    v_mfma_f32_16x16x32_bf16 v[168:171], v[40:43], a[116:119], v[168:171]
    ds_read_b64_tr_b16 v[218:219], v9 offset:5376
    v_mfma_f32_16x16x32_bf16 v[92:95], v[44:47], a[108:111], v[92:95]
    ds_read_b64_tr_b16 v[220:221], v10 offset:256
    v_mfma_f32_16x16x32_bf16 v[132:135], v[44:47], a[112:115], v[132:135]
    buffer_load_dwordx4 a[184:187], v11, s[88:91], s19 offen offset:3072 sc1
    ds_read_b64_tr_b16 v[222:223], v10 offset:5376
    v_mfma_f32_16x16x32_bf16 v[172:175], v[44:47], a[116:119], v[172:175]
    v_mfma_f32_16x16x32_bf16 v[96:99], v[48:51], a[108:111], v[96:99]
    buffer_load_dwordx4 a[188:191], v12, s[88:91], s19 offen offset:3072 sc1
    v_mfma_f32_16x16x32_bf16 v[136:139], v[48:51], a[112:115], v[136:139]
    v_mfma_f32_16x16x32_bf16 v[176:179], v[48:51], a[116:119], v[176:179]
    v_mfma_f32_16x16x32_bf16 v[100:103], v[52:55], a[108:111], v[100:103]
    v_mfma_f32_16x16x32_bf16 v[140:143], v[52:55], a[112:115], v[140:143]
    v_mfma_f32_16x16x32_bf16 v[180:183], v[52:55], a[116:119], v[180:183]
    s_waitcnt vmcnt(25) lgkmcnt(0)
    s_and_b64 s[10:11], s[22:23], s[28:29]
    s_cbranch_scc0 L_PA3_OK
    s_mov_b32 s79, 1048576
L_PA3:
    global_load_dwordx2 v[228:229], v59, s[40:41] sc1
    s_waitcnt vmcnt(0)
    v_cmp_ne_u64 s[22:23], v[228:229], v[56:57]
    s_sub_u32 s79, s79, 1
    s_cbranch_scc1 L_PA3_OK
    s_and_b64 s[10:11], s[22:23], s[28:29]
    s_cbranch_scc1 L_PA3
L_PA3_OK:
    v_mfma_f32_16x16x32_bf16 v[64:67], v[184:187], a[120:123], v[64:67]
    buffer_load_dwordx4 a[0:3], v0, s[88:91], s20 offen offset:0 sc1
    ds_read_b64_tr_b16 v[16:17], v9 offset:10240
    v_mfma_f32_16x16x32_bf16 v[104:107], v[184:187], a[124:127], v[104:107]
    ds_read_b64_tr_b16 v[18:19], v9 offset:15360
    v_mfma_f32_16x16x32_bf16 v[144:147], v[184:187], a[128:131], v[144:147]
    ds_read_b64_tr_b16 v[20:21], v10 offset:10240
    v_mfma_f32_16x16x32_bf16 v[68:71], v[188:191], a[120:123], v[68:71]
    ds_read_b64_tr_b16 v[22:23], v10 offset:15360
    v_mfma_f32_16x16x32_bf16 v[108:111], v[188:191], a[124:127], v[108:111]
    ds_read_b64_tr_b16 v[24:25], v9 offset:10304
    v_mfma_f32_16x16x32_bf16 v[148:151], v[188:191], a[128:131], v[148:151]
    v_mfma_f32_16x16x32_bf16 v[72:75], v[192:195], a[120:123], v[72:75]
    buffer_load_dwordx4 a[4:7], v11, s[88:91], s20 offen offset:0 sc1
    ds_read_b64_tr_b16 v[26:27], v9 offset:15424
    v_mfma_f32_16x16x32_bf16 v[112:115], v[192:195], a[124:127], v[112:115]
    ds_read_b64_tr_b16 v[28:29], v10 offset:10304
    v_mfma_f32_16x16x32_bf16 v[152:155], v[192:195], a[128:131], v[152:155]
    ds_read_b64_tr_b16 v[30:31], v10 offset:15424
    v_mfma_f32_16x16x32_bf16 v[76:79], v[196:199], a[120:123], v[76:79]
    ds_read_b64_tr_b16 v[32:33], v9 offset:10368
    v_mfma_f32_16x16x32_bf16 v[116:119], v[196:199], a[124:127], v[116:119]
    ds_read_b64_tr_b16 v[34:35], v9 offset:15488
    v_mfma_f32_16x16x32_bf16 v[156:159], v[196:199], a[128:131], v[156:159]
    v_mfma_f32_16x16x32_bf16 v[80:83], v[200:203], a[120:123], v[80:83]
    ds_read_b64_tr_b16 v[36:37], v10 offset:10368
    v_mfma_f32_16x16x32_bf16 v[120:123], v[200:203], a[124:127], v[120:123]
    buffer_load_dwordx4 a[8:11], v12, s[88:91], s20 offen offset:0 sc1
    ds_read_b64_tr_b16 v[38:39], v10 offset:15488
    v_mfma_f32_16x16x32_bf16 v[160:163], v[200:203], a[128:131], v[160:163]
    ds_read_b64_tr_b16 v[40:41], v9 offset:10432
    v_mfma_f32_16x16x32_bf16 v[84:87], v[204:207], a[120:123], v[84:87]
    ds_read_b64_tr_b16 v[42:43], v9 offset:15552
    v_mfma_f32_16x16x32_bf16 v[124:127], v[204:207], a[124:127], v[124:127]
    ds_read_b64_tr_b16 v[44:45], v10 offset:10432
    v_mfma_f32_16x16x32_bf16 v[164:167], v[204:207], a[128:131], v[164:167]
    v_mfma_f32_16x16x32_bf16 v[88:91], v[208:211], a[120:123], v[88:91]
    ds_read_b64_tr_b16 v[46:47], v10 offset:15552
    v_mfma_f32_16x16x32_bf16 v[128:131], v[208:211], a[124:127], v[128:131]
    ds_read_b64_tr_b16 v[48:49], v9 offset:10496
    v_mfma_f32_16x16x32_bf16 v[168:171], v[208:211], a[128:131], v[168:171]
    buffer_load_dwordx4 a[12:15], v0, s[88:91], s20 offen offset:1024 sc1
    ds_read_b64_tr_b16 v[50:51], v9 offset:15616
    v_mfma_f32_16x16x32_bf16 v[92:95], v[212:215], a[120:123], v[92:95]
    ds_read_b64_tr_b16 v[52:53], v10 offset:10496
    v_mfma_f32_16x16x32_bf16 v[132:135], v[212:215], a[124:127], v[132:135]
    ds_read_b64_tr_b16 v[54:55], v10 offset:15616
    v_mfma_f32_16x16x32_bf16 v[172:175], v[212:215], a[128:131], v[172:175]
    v_mfma_f32_16x16x32_bf16 v[96:99], v[216:219], a[120:123], v[96:99]
    v_mfma_f32_16x16x32_bf16 v[136:139], v[216:219], a[124:127], v[136:139]
    v_mfma_f32_16x16x32_bf16 v[176:179], v[216:219], a[128:131], v[176:179]
    v_mfma_f32_16x16x32_bf16 v[100:103], v[220:223], a[120:123], v[100:103]
    v_mfma_f32_16x16x32_bf16 v[140:143], v[220:223], a[124:127], v[140:143]
    v_mfma_f32_16x16x32_bf16 v[180:183], v[220:223], a[128:131], v[180:183]
    s_waitcnt vmcnt(21) lgkmcnt(0)
    s_barrier
    v_mfma_f32_16x16x32_bf16 v[64:67], v[16:19], a[132:135], v[64:67]
    s_add_u32 m0, s70, 0
    ds_read_b64_tr_b16 v[184:185], v9 offset:20480
    v_mfma_f32_16x16x32_bf16 v[104:107], v[16:19], a[136:139], v[104:107]
    ds_read_b64_tr_b16 v[186:187], v9 offset:25600
    v_mfma_f32_16x16x32_bf16 v[144:147], v[16:19], a[140:143], v[144:147]
    buffer_load_dwordx4 v4, s[84:87], s64 offen  lds
    s_add_u32 m0, s70, 1024
    v_mfma_f32_16x16x32_bf16 v[68:71], v[20:23], a[132:135], v[68:71]
    ds_read_b64_tr_b16 v[188:189], v10 offset:20480
    ds_read_b64_tr_b16 v[190:191], v10 offset:25600
    v_mfma_f32_16x16x32_bf16 v[108:111], v[20:23], a[136:139], v[108:111]
    buffer_load_dwordx4 v5, s[84:87], s64 offen  lds
    s_add_u32 m0, s70, 2048
    v_mfma_f32_16x16x32_bf16 v[148:151], v[20:23], a[140:143], v[148:151]
    ds_read_b64_tr_b16 v[192:193], v9 offset:20544
    v_mfma_f32_16x16x32_bf16 v[72:75], v[24:27], a[132:135], v[72:75]
    ds_read_b64_tr_b16 v[194:195], v9 offset:25664
    v_mfma_f32_16x16x32_bf16 v[112:115], v[24:27], a[136:139], v[112:115]
    buffer_load_dwordx4 v6, s[84:87], s64 offen  lds
    s_add_u32 m0, s70, 3072
    v_mfma_f32_16x16x32_bf16 v[152:155], v[24:27], a[140:143], v[152:155]
    ds_read_b64_tr_b16 v[196:197], v10 offset:20544
    ds_read_b64_tr_b16 v[198:199], v10 offset:25664
    v_mfma_f32_16x16x32_bf16 v[76:79], v[28:31], a[132:135], v[76:79]
    buffer_load_dwordx4 v7, s[84:87], s64 offen  lds
    s_add_u32 m0, s70, 4096
    v_mfma_f32_16x16x32_bf16 v[116:119], v[28:31], a[136:139], v[116:119]
    ds_read_b64_tr_b16 v[200:201], v9 offset:20608
    ds_read_b64_tr_b16 v[202:203], v9 offset:25728
    v_mfma_f32_16x16x32_bf16 v[156:159], v[28:31], a[140:143], v[156:159]
    v_mfma_f32_16x16x32_bf16 v[80:83], v[32:35], a[132:135], v[80:83]
    buffer_load_dwordx4 v8, s[84:87], s64 offen  lds
    s_add_u32 s64, s64, 81920
    v_mfma_f32_16x16x32_bf16 v[120:123], v[32:35], a[136:139], v[120:123]
    ds_read_b64_tr_b16 v[204:205], v10 offset:20608
    ds_read_b64_tr_b16 v[206:207], v10 offset:25728
    v_mfma_f32_16x16x32_bf16 v[160:163], v[32:35], a[140:143], v[160:163]
    s_cmp_eq_u32 s64, 1310720
    s_cselect_b32 s64, 0, s64
    v_mfma_f32_16x16x32_bf16 v[84:87], v[36:39], a[132:135], v[84:87]
    ds_read_b64_tr_b16 v[208:209], v9 offset:20672
    ds_read_b64_tr_b16 v[210:211], v9 offset:25792
    v_mfma_f32_16x16x32_bf16 v[124:127], v[36:39], a[136:139], v[124:127]
    ds_read_b64_tr_b16 v[212:213], v10 offset:20672
    v_mfma_f32_16x16x32_bf16 v[164:167], v[36:39], a[140:143], v[164:167]
    buffer_load_dwordx4 a[16:19], v11, s[88:91], s20 offen offset:1024 sc1
    v_mfma_f32_16x16x32_bf16 v[88:91], v[40:43], a[132:135], v[88:91]
    ds_read_b64_tr_b16 v[214:215], v10 offset:25792
    v_mfma_f32_16x16x32_bf16 v[128:131], v[40:43], a[136:139], v[128:131]
    buffer_load_dwordx4 a[20:23], v12, s[88:91], s20 offen offset:1024 sc1
    ds_read_b64_tr_b16 v[216:217], v9 offset:20736
    v_mfma_f32_16x16x32_bf16 v[168:171], v[40:43], a[140:143], v[168:171]
    ds_read_b64_tr_b16 v[218:219], v9 offset:25856
    v_mfma_f32_16x16x32_bf16 v[92:95], v[44:47], a[132:135], v[92:95]
    ds_read_b64_tr_b16 v[220:221], v10 offset:20736
    v_mfma_f32_16x16x32_bf16 v[132:135], v[44:47], a[136:139], v[132:135]
    buffer_load_dwordx4 a[24:27], v0, s[88:91], s20 offen offset:2048 sc1
    ds_read_b64_tr_b16 v[222:223], v10 offset:25856
    v_mfma_f32_16x16x32_bf16 v[172:175], v[44:47], a[140:143], v[172:175]
    v_mfma_f32_16x16x32_bf16 v[96:99], v[48:51], a[132:135], v[96:99]
    buffer_load_dwordx4 a[28:31], v11, s[88:91], s20 offen offset:2048 sc1
    v_mfma_f32_16x16x32_bf16 v[136:139], v[48:51], a[136:139], v[136:139]
    v_mfma_f32_16x16x32_bf16 v[176:179], v[48:51], a[140:143], v[176:179]
    v_mfma_f32_16x16x32_bf16 v[100:103], v[52:55], a[132:135], v[100:103]
    v_mfma_f32_16x16x32_bf16 v[140:143], v[52:55], a[136:139], v[140:143]
    v_mfma_f32_16x16x32_bf16 v[180:183], v[52:55], a[140:143], v[180:183]
    s_waitcnt vmcnt(27) lgkmcnt(0)
    v_mfma_f32_16x16x32_bf16 v[64:67], v[184:187], a[144:147], v[64:67]
    buffer_load_dwordx4 a[32:35], v12, s[88:91], s20 offen offset:2048 sc1
    ds_read_b64_tr_b16 v[16:17], v9 offset:30720
    v_mfma_f32_16x16x32_bf16 v[104:107], v[184:187], a[148:151], v[104:107]
    ds_read_b64_tr_b16 v[18:19], v9 offset:35840
    v_mfma_f32_16x16x32_bf16 v[144:147], v[184:187], a[152:155], v[144:147]
    ds_read_b64_tr_b16 v[20:21], v10 offset:30720
    v_mfma_f32_16x16x32_bf16 v[68:71], v[188:191], a[144:147], v[68:71]
    ds_read_b64_tr_b16 v[22:23], v10 offset:35840
    v_mfma_f32_16x16x32_bf16 v[108:111], v[188:191], a[148:151], v[108:111]
    ds_read_b64_tr_b16 v[24:25], v9 offset:30784
    v_mfma_f32_16x16x32_bf16 v[148:151], v[188:191], a[152:155], v[148:151]
    v_mfma_f32_16x16x32_bf16 v[72:75], v[192:195], a[144:147], v[72:75]
    buffer_load_dwordx4 a[36:39], v0, s[88:91], s20 offen offset:3072 sc1
    ds_read_b64_tr_b16 v[26:27], v9 offset:35904
    v_mfma_f32_16x16x32_bf16 v[112:115], v[192:195], a[148:151], v[112:115]
    ds_read_b64_tr_b16 v[28:29], v10 offset:30784
    v_mfma_f32_16x16x32_bf16 v[152:155], v[192:195], a[152:155], v[152:155]
    ds_read_b64_tr_b16 v[30:31], v10 offset:35904
    v_mfma_f32_16x16x32_bf16 v[76:79], v[196:199], a[144:147], v[76:79]
    ds_read_b64_tr_b16 v[32:33], v9 offset:30848
    v_mfma_f32_16x16x32_bf16 v[116:119], v[196:199], a[148:151], v[116:119]
    ds_read_b64_tr_b16 v[34:35], v9 offset:35968
    v_mfma_f32_16x16x32_bf16 v[156:159], v[196:199], a[152:155], v[156:159]
    v_mfma_f32_16x16x32_bf16 v[80:83], v[200:203], a[144:147], v[80:83]
    ds_read_b64_tr_b16 v[36:37], v10 offset:30848
    v_mfma_f32_16x16x32_bf16 v[120:123], v[200:203], a[148:151], v[120:123]
    buffer_load_dwordx4 a[40:43], v11, s[88:91], s20 offen offset:3072 sc1
    ds_read_b64_tr_b16 v[38:39], v10 offset:35968
    v_mfma_f32_16x16x32_bf16 v[160:163], v[200:203], a[152:155], v[160:163]
    ds_read_b64_tr_b16 v[40:41], v9 offset:30912
    v_mfma_f32_16x16x32_bf16 v[84:87], v[204:207], a[144:147], v[84:87]
    ds_read_b64_tr_b16 v[42:43], v9 offset:36032
    v_mfma_f32_16x16x32_bf16 v[124:127], v[204:207], a[148:151], v[124:127]
    ds_read_b64_tr_b16 v[44:45], v10 offset:30912
    v_mfma_f32_16x16x32_bf16 v[164:167], v[204:207], a[152:155], v[164:167]
    v_mfma_f32_16x16x32_bf16 v[88:91], v[208:211], a[144:147], v[88:91]
    ds_read_b64_tr_b16 v[46:47], v10 offset:36032
    v_mfma_f32_16x16x32_bf16 v[128:131], v[208:211], a[148:151], v[128:131]
    ds_read_b64_tr_b16 v[48:49], v9 offset:30976
    v_mfma_f32_16x16x32_bf16 v[168:171], v[208:211], a[152:155], v[168:171]
    buffer_load_dwordx4 a[44:47], v12, s[88:91], s20 offen offset:3072 sc1
    ds_read_b64_tr_b16 v[50:51], v9 offset:36096
    v_mfma_f32_16x16x32_bf16 v[92:95], v[212:215], a[144:147], v[92:95]
    ds_read_b64_tr_b16 v[52:53], v10 offset:30976
    v_mfma_f32_16x16x32_bf16 v[132:135], v[212:215], a[148:151], v[132:135]
    ds_read_b64_tr_b16 v[54:55], v10 offset:36096
    v_mfma_f32_16x16x32_bf16 v[172:175], v[212:215], a[152:155], v[172:175]
    v_mfma_f32_16x16x32_bf16 v[96:99], v[216:219], a[144:147], v[96:99]
    v_mfma_f32_16x16x32_bf16 v[136:139], v[216:219], a[148:151], v[136:139]
    v_mfma_f32_16x16x32_bf16 v[176:179], v[216:219], a[152:155], v[176:179]
    v_mfma_f32_16x16x32_bf16 v[100:103], v[220:223], a[144:147], v[100:103]
    v_mfma_f32_16x16x32_bf16 v[140:143], v[220:223], a[148:151], v[140:143]
    v_mfma_f32_16x16x32_bf16 v[180:183], v[220:223], a[152:155], v[180:183]
    s_waitcnt vmcnt(21) lgkmcnt(0)
    s_barrier
    v_mfma_f32_16x16x32_bf16 v[64:67], v[16:19], a[156:159], v[64:67]
    s_add_u32 m0, s70, 20480
    ds_read_b64_tr_b16 v[184:185], v9 offset:40960
    v_mfma_f32_16x16x32_bf16 v[104:107], v[16:19], a[160:163], v[104:107]
    ds_read_b64_tr_b16 v[186:187], v9 offset:46080
    v_mfma_f32_16x16x32_bf16 v[144:147], v[16:19], a[164:167], v[144:147]
    buffer_load_dwordx4 v4, s[84:87], s64 offen  lds
    s_add_u32 m0, s70, 21504
    v_mfma_f32_16x16x32_bf16 v[68:71], v[20:23], a[156:159], v[68:71]
    ds_read_b64_tr_b16 v[188:189], v10 offset:40960
    ds_read_b64_tr_b16 v[190:191], v10 offset:46080
    v_mfma_f32_16x16x32_bf16 v[108:111], v[20:23], a[160:163], v[108:111]
    buffer_load_dwordx4 v5, s[84:87], s64 offen  lds
    s_add_u32 m0, s70, 22528
    v_mfma_f32_16x16x32_bf16 v[148:151], v[20:23], a[164:167], v[148:151]
    ds_read_b64_tr_b16 v[192:193], v9 offset:41024
    v_mfma_f32_16x16x32_bf16 v[72:75], v[24:27], a[156:159], v[72:75]
    ds_read_b64_tr_b16 v[194:195], v9 offset:46144
    v_mfma_f32_16x16x32_bf16 v[112:115], v[24:27], a[160:163], v[112:115]
    buffer_load_dwordx4 v6, s[84:87], s64 offen  lds
    s_add_u32 m0, s70, 23552
    v_mfma_f32_16x16x32_bf16 v[152:155], v[24:27], a[164:167], v[152:155]
    ds_read_b64_tr_b16 v[196:197], v10 offset:41024
    ds_read_b64_tr_b16 v[198:199], v10 offset:46144
    v_mfma_f32_16x16x32_bf16 v[76:79], v[28:31], a[156:159], v[76:79]
    buffer_load_dwordx4 v7, s[84:87], s64 offen  lds
    s_add_u32 m0, s70, 24576
    v_mfma_f32_16x16x32_bf16 v[116:119], v[28:31], a[160:163], v[116:119]
    ds_read_b64_tr_b16 v[200:201], v9 offset:41088
    ds_read_b64_tr_b16 v[202:203], v9 offset:46208
    v_mfma_f32_16x16x32_bf16 v[156:159], v[28:31], a[164:167], v[156:159]
    v_mfma_f32_16x16x32_bf16 v[80:83], v[32:35], a[156:159], v[80:83]
    buffer_load_dwordx4 v8, s[84:87], s64 offen  lds
    s_add_u32 s64, s64, 81920
    v_mfma_f32_16x16x32_bf16 v[120:123], v[32:35], a[160:163], v[120:123]
    ds_read_b64_tr_b16 v[204:205], v10 offset:41088
    ds_read_b64_tr_b16 v[206:207], v10 offset:46208
    v_mfma_f32_16x16x32_bf16 v[160:163], v[32:35], a[164:167], v[160:163]
    s_cmp_eq_u32 s64, 1310720
    s_cselect_b32 s64, 0, s64
    v_mfma_f32_16x16x32_bf16 v[84:87], v[36:39], a[156:159], v[84:87]
    ds_read_b64_tr_b16 v[208:209], v9 offset:41152
    ds_read_b64_tr_b16 v[210:211], v9 offset:46272
    v_mfma_f32_16x16x32_bf16 v[124:127], v[36:39], a[160:163], v[124:127]
    ds_read_b64_tr_b16 v[212:213], v10 offset:41152
    v_mfma_f32_16x16x32_bf16 v[164:167], v[36:39], a[164:167], v[164:167]
    buffer_load_dwordx4 a[48:51], v0, s[88:91], s21 offen offset:0 sc1
    v_mfma_f32_16x16x32_bf16 v[88:91], v[40:43], a[156:159], v[88:91]
    ds_read_b64_tr_b16 v[214:215], v10 offset:46272
    v_mfma_f32_16x16x32_bf16 v[128:131], v[40:43], a[160:163], v[128:131]
    buffer_load_dwordx4 a[52:55], v11, s[88:91], s21 offen offset:0 sc1
    ds_read_b64_tr_b16 v[216:217], v9 offset:41216
    v_mfma_f32_16x16x32_bf16 v[168:171], v[40:43], a[164:167], v[168:171]
    ds_read_b64_tr_b16 v[218:219], v9 offset:46336
    v_mfma_f32_16x16x32_bf16 v[92:95], v[44:47], a[156:159], v[92:95]
    ds_read_b64_tr_b16 v[220:221], v10 offset:41216
    v_mfma_f32_16x16x32_bf16 v[132:135], v[44:47], a[160:163], v[132:135]
    buffer_load_dwordx4 a[56:59], v12, s[88:91], s21 offen offset:0 sc1
    ds_read_b64_tr_b16 v[222:223], v10 offset:46336
    v_mfma_f32_16x16x32_bf16 v[172:175], v[44:47], a[164:167], v[172:175]
    v_mfma_f32_16x16x32_bf16 v[96:99], v[48:51], a[156:159], v[96:99]
    buffer_load_dwordx4 a[60:63], v0, s[88:91], s21 offen offset:1024 sc1
    v_mfma_f32_16x16x32_bf16 v[136:139], v[48:51], a[160:163], v[136:139]
    v_mfma_f32_16x16x32_bf16 v[176:179], v[48:51], a[164:167], v[176:179]
    v_mfma_f32_16x16x32_bf16 v[100:103], v[52:55], a[156:159], v[100:103]
    v_mfma_f32_16x16x32_bf16 v[140:143], v[52:55], a[160:163], v[140:143]
    v_mfma_f32_16x16x32_bf16 v[180:183], v[52:55], a[164:167], v[180:183]
    s_waitcnt vmcnt(29) lgkmcnt(0)
    v_mfma_f32_16x16x32_bf16 v[64:67], v[184:187], a[168:171], v[64:67]
    buffer_load_dwordx4 a[64:67], v11, s[88:91], s21 offen offset:1024 sc1
    ds_read_b64_tr_b16 v[16:17], v9 offset:51200
    v_mfma_f32_16x16x32_bf16 v[104:107], v[184:187], a[172:175], v[104:107]
    ds_read_b64_tr_b16 v[18:19], v9 offset:56320
    v_mfma_f32_16x16x32_bf16 v[144:147], v[184:187], a[176:179], v[144:147]
    ds_read_b64_tr_b16 v[20:21], v10 offset:51200
    v_mfma_f32_16x16x32_bf16 v[68:71], v[188:191], a[168:171], v[68:71]
    ds_read_b64_tr_b16 v[22:23], v10 offset:56320
    v_mfma_f32_16x16x32_bf16 v[108:111], v[188:191], a[172:175], v[108:111]
    ds_read_b64_tr_b16 v[24:25], v9 offset:51264
    v_mfma_f32_16x16x32_bf16 v[148:151], v[188:191], a[176:179], v[148:151]
    v_mfma_f32_16x16x32_bf16 v[72:75], v[192:195], a[168:171], v[72:75]
    buffer_load_dwordx4 a[68:71], v12, s[88:91], s21 offen offset:1024 sc1
    ds_read_b64_tr_b16 v[26:27], v9 offset:56384
    v_mfma_f32_16x16x32_bf16 v[112:115], v[192:195], a[172:175], v[112:115]
    ds_read_b64_tr_b16 v[28:29], v10 offset:51264
    v_mfma_f32_16x16x32_bf16 v[152:155], v[192:195], a[176:179], v[152:155]
    ds_read_b64_tr_b16 v[30:31], v10 offset:56384
    v_mfma_f32_16x16x32_bf16 v[76:79], v[196:199], a[168:171], v[76:79]
    ds_read_b64_tr_b16 v[32:33], v9 offset:51328
    v_mfma_f32_16x16x32_bf16 v[116:119], v[196:199], a[172:175], v[116:119]
    ds_read_b64_tr_b16 v[34:35], v9 offset:56448
    v_mfma_f32_16x16x32_bf16 v[156:159], v[196:199], a[176:179], v[156:159]
    v_mfma_f32_16x16x32_bf16 v[80:83], v[200:203], a[168:171], v[80:83]
    ds_read_b64_tr_b16 v[36:37], v10 offset:51328
    v_mfma_f32_16x16x32_bf16 v[120:123], v[200:203], a[172:175], v[120:123]
    buffer_load_dwordx4 a[72:75], v0, s[88:91], s21 offen offset:2048 sc1
    ds_read_b64_tr_b16 v[38:39], v10 offset:56448
    v_mfma_f32_16x16x32_bf16 v[160:163], v[200:203], a[176:179], v[160:163]
    ds_read_b64_tr_b16 v[40:41], v9 offset:51392
    v_mfma_f32_16x16x32_bf16 v[84:87], v[204:207], a[168:171], v[84:87]
    ds_read_b64_tr_b16 v[42:43], v9 offset:56512
    v_mfma_f32_16x16x32_bf16 v[124:127], v[204:207], a[172:175], v[124:127]
    ds_read_b64_tr_b16 v[44:45], v10 offset:51392
    v_mfma_f32_16x16x32_bf16 v[164:167], v[204:207], a[176:179], v[164:167]
    v_mfma_f32_16x16x32_bf16 v[88:91], v[208:211], a[168:171], v[88:91]
    ds_read_b64_tr_b16 v[46:47], v10 offset:56512
    v_mfma_f32_16x16x32_bf16 v[128:131], v[208:211], a[172:175], v[128:131]
    ds_read_b64_tr_b16 v[48:49], v9 offset:51456
    v_mfma_f32_16x16x32_bf16 v[168:171], v[208:211], a[176:179], v[168:171]
    buffer_load_dwordx4 a[76:79], v11, s[88:91], s21 offen offset:2048 sc1
    ds_read_b64_tr_b16 v[50:51], v9 offset:56576
    v_mfma_f32_16x16x32_bf16 v[92:95], v[212:215], a[168:171], v[92:95]
    ds_read_b64_tr_b16 v[52:53], v10 offset:51456
    v_mfma_f32_16x16x32_bf16 v[132:135], v[212:215], a[172:175], v[132:135]
    ds_read_b64_tr_b16 v[54:55], v10 offset:56576
    v_mfma_f32_16x16x32_bf16 v[172:175], v[212:215], a[176:179], v[172:175]
    v_mfma_f32_16x16x32_bf16 v[96:99], v[216:219], a[168:171], v[96:99]
    v_mfma_f32_16x16x32_bf16 v[136:139], v[216:219], a[172:175], v[136:139]
    v_mfma_f32_16x16x32_bf16 v[176:179], v[216:219], a[176:179], v[176:179]
    v_mfma_f32_16x16x32_bf16 v[100:103], v[220:223], a[168:171], v[100:103]
    v_mfma_f32_16x16x32_bf16 v[140:143], v[220:223], a[172:175], v[140:143]
    v_mfma_f32_16x16x32_bf16 v[180:183], v[220:223], a[176:179], v[180:183]
    s_waitcnt vmcnt(21) lgkmcnt(0)
    s_barrier
    v_mfma_f32_16x16x32_bf16 v[64:67], v[16:19], a[180:183], v[64:67]
    s_add_u32 m0, s70, 40960
    ds_read_b64_tr_b16 v[184:185], v9 offset:0
    v_mfma_f32_16x16x32_bf16 v[104:107], v[16:19], a[184:187], v[104:107]
    ds_read_b64_tr_b16 v[186:187], v9 offset:5120
    v_mfma_f32_16x16x32_bf16 v[144:147], v[16:19], a[188:191], v[144:147]
    buffer_load_dwordx4 v4, s[84:87], s64 offen  lds
    s_add_u32 m0, s70, 41984
    v_mfma_f32_16x16x32_bf16 v[68:71], v[20:23], a[180:183], v[68:71]
    ds_read_b64_tr_b16 v[188:189], v10 offset:0
    ds_read_b64_tr_b16 v[190:191], v10 offset:5120
    v_mfma_f32_16x16x32_bf16 v[108:111], v[20:23], a[184:187], v[108:111]
    buffer_load_dwordx4 v5, s[84:87], s64 offen  lds
    s_add_u32 m0, s70, 43008
    v_mfma_f32_16x16x32_bf16 v[148:151], v[20:23], a[188:191], v[148:151]
    ds_read_b64_tr_b16 v[192:193], v9 offset:64
    v_mfma_f32_16x16x32_bf16 v[72:75], v[24:27], a[180:183], v[72:75]
    ds_read_b64_tr_b16 v[194:195], v9 offset:5184
    v_mfma_f32_16x16x32_bf16 v[112:115], v[24:27], a[184:187], v[112:115]
    buffer_load_dwordx4 v6, s[84:87], s64 offen  lds
    s_add_u32 m0, s70, 44032
    v_mfma_f32_16x16x32_bf16 v[152:155], v[24:27], a[188:191], v[152:155]
    ds_read_b64_tr_b16 v[196:197], v10 offset:64
    ds_read_b64_tr_b16 v[198:199], v10 offset:5184
    v_mfma_f32_16x16x32_bf16 v[76:79], v[28:31], a[180:183], v[76:79]
    buffer_load_dwordx4 v7, s[84:87], s64 offen  lds
    s_add_u32 m0, s70, 45056
    v_mfma_f32_16x16x32_bf16 v[116:119], v[28:31], a[184:187], v[116:119]
    ds_read_b64_tr_b16 v[200:201], v9 offset:128
    ds_read_b64_tr_b16 v[202:203], v9 offset:5248
    v_mfma_f32_16x16x32_bf16 v[156:159], v[28:31], a[188:191], v[156:159]
    v_mfma_f32_16x16x32_bf16 v[80:83], v[32:35], a[180:183], v[80:83]
    buffer_load_dwordx4 v8, s[84:87], s64 offen  lds
    s_add_u32 s64, s64, 81920
    v_mfma_f32_16x16x32_bf16 v[120:123], v[32:35], a[184:187], v[120:123]
    ds_read_b64_tr_b16 v[204:205], v10 offset:128
    ds_read_b64_tr_b16 v[206:207], v10 offset:5248
    v_mfma_f32_16x16x32_bf16 v[160:163], v[32:35], a[188:191], v[160:163]
    s_cmp_eq_u32 s64, 1310720
    s_cselect_b32 s64, 0, s64
    v_mfma_f32_16x16x32_bf16 v[84:87], v[36:39], a[180:183], v[84:87]
    ds_read_b64_tr_b16 v[208:209], v9 offset:192
    ds_read_b64_tr_b16 v[210:211], v9 offset:5312
    v_mfma_f32_16x16x32_bf16 v[124:127], v[36:39], a[184:187], v[124:127]
    ds_read_b64_tr_b16 v[212:213], v10 offset:192
    v_mfma_f32_16x16x32_bf16 v[164:167], v[36:39], a[188:191], v[164:167]
    buffer_load_dwordx4 a[80:83], v12, s[88:91], s21 offen offset:2048 sc1
    v_mfma_f32_16x16x32_bf16 v[88:91], v[40:43], a[180:183], v[88:91]
    ds_read_b64_tr_b16 v[214:215], v10 offset:5312
    v_mfma_f32_16x16x32_bf16 v[128:131], v[40:43], a[184:187], v[128:131]
    buffer_load_dwordx4 a[84:87], v0, s[88:91], s21 offen offset:3072 sc1
    ds_read_b64_tr_b16 v[216:217], v9 offset:256
    v_mfma_f32_16x16x32_bf16 v[168:171], v[40:43], a[188:191], v[168:171]
    ds_read_b64_tr_b16 v[218:219], v9 offset:5376
    v_mfma_f32_16x16x32_bf16 v[92:95], v[44:47], a[180:183], v[92:95]
    ds_read_b64_tr_b16 v[220:221], v10 offset:256
    v_mfma_f32_16x16x32_bf16 v[132:135], v[44:47], a[184:187], v[132:135]
    buffer_load_dwordx4 a[88:91], v11, s[88:91], s21 offen offset:3072 sc1
    ds_read_b64_tr_b16 v[222:223], v10 offset:5376
    v_mfma_f32_16x16x32_bf16 v[172:175], v[44:47], a[188:191], v[172:175]
    v_mfma_f32_16x16x32_bf16 v[96:99], v[48:51], a[180:183], v[96:99]
    buffer_load_dwordx4 a[92:95], v12, s[88:91], s21 offen offset:3072 sc1
    v_mfma_f32_16x16x32_bf16 v[136:139], v[48:51], a[184:187], v[136:139]
    v_mfma_f32_16x16x32_bf16 v[176:179], v[48:51], a[188:191], v[176:179]
    v_mfma_f32_16x16x32_bf16 v[100:103], v[52:55], a[180:183], v[100:103]
    v_mfma_f32_16x16x32_bf16 v[140:143], v[52:55], a[184:187], v[140:143]
    v_mfma_f32_16x16x32_bf16 v[180:183], v[52:55], a[188:191], v[180:183]
    s_waitcnt lgkmcnt(0)
    v_mfma_f32_16x16x32_bf16 v[64:67], v[184:187], a[0:3], v[64:67]
    ds_read_b64_tr_b16 v[16:17], v9 offset:10240
    v_mfma_f32_16x16x32_bf16 v[104:107], v[184:187], a[4:7], v[104:107]
    ds_read_b64_tr_b16 v[18:19], v9 offset:15360
    v_mfma_f32_16x16x32_bf16 v[144:147], v[184:187], a[8:11], v[144:147]
    ds_read_b64_tr_b16 v[20:21], v10 offset:10240
    v_mfma_f32_16x16x32_bf16 v[68:71], v[188:191], a[0:3], v[68:71]
    ds_read_b64_tr_b16 v[22:23], v10 offset:15360
    v_mfma_f32_16x16x32_bf16 v[108:111], v[188:191], a[4:7], v[108:111]
    ds_read_b64_tr_b16 v[24:25], v9 offset:10304
    v_mfma_f32_16x16x32_bf16 v[148:151], v[188:191], a[8:11], v[148:151]
    v_mfma_f32_16x16x32_bf16 v[72:75], v[192:195], a[0:3], v[72:75]
    ds_read_b64_tr_b16 v[26:27], v9 offset:15424
    v_mfma_f32_16x16x32_bf16 v[112:115], v[192:195], a[4:7], v[112:115]
    ds_read_b64_tr_b16 v[28:29], v10 offset:10304
    v_mfma_f32_16x16x32_bf16 v[152:155], v[192:195], a[8:11], v[152:155]
    ds_read_b64_tr_b16 v[30:31], v10 offset:15424
    v_mfma_f32_16x16x32_bf16 v[76:79], v[196:199], a[0:3], v[76:79]
    ds_read_b64_tr_b16 v[32:33], v9 offset:10368
    v_mfma_f32_16x16x32_bf16 v[116:119], v[196:199], a[4:7], v[116:119]
    ds_read_b64_tr_b16 v[34:35], v9 offset:15488
    v_mfma_f32_16x16x32_bf16 v[156:159], v[196:199], a[8:11], v[156:159]
    v_mfma_f32_16x16x32_bf16 v[80:83], v[200:203], a[0:3], v[80:83]
    ds_read_b64_tr_b16 v[36:37], v10 offset:10368
    v_mfma_f32_16x16x32_bf16 v[120:123], v[200:203], a[4:7], v[120:123]
    ds_read_b64_tr_b16 v[38:39], v10 offset:15488
    v_mfma_f32_16x16x32_bf16 v[160:163], v[200:203], a[8:11], v[160:163]
    ds_read_b64_tr_b16 v[40:41], v9 offset:10432
    v_mfma_f32_16x16x32_bf16 v[84:87], v[204:207], a[0:3], v[84:87]
    ds_read_b64_tr_b16 v[42:43], v9 offset:15552
    v_mfma_f32_16x16x32_bf16 v[124:127], v[204:207], a[4:7], v[124:127]
    ds_read_b64_tr_b16 v[44:45], v10 offset:10432
    v_mfma_f32_16x16x32_bf16 v[164:167], v[204:207], a[8:11], v[164:167]
    v_mfma_f32_16x16x32_bf16 v[88:91], v[208:211], a[0:3], v[88:91]
    ds_read_b64_tr_b16 v[46:47], v10 offset:15552
    v_mfma_f32_16x16x32_bf16 v[128:131], v[208:211], a[4:7], v[128:131]
    ds_read_b64_tr_b16 v[48:49], v9 offset:10496
    v_mfma_f32_16x16x32_bf16 v[168:171], v[208:211], a[8:11], v[168:171]
    ds_read_b64_tr_b16 v[50:51], v9 offset:15616
    v_mfma_f32_16x16x32_bf16 v[92:95], v[212:215], a[0:3], v[92:95]
    ds_read_b64_tr_b16 v[52:53], v10 offset:10496
    v_mfma_f32_16x16x32_bf16 v[132:135], v[212:215], a[4:7], v[132:135]
    ds_read_b64_tr_b16 v[54:55], v10 offset:15616
    v_mfma_f32_16x16x32_bf16 v[172:175], v[212:215], a[8:11], v[172:175]
    v_mfma_f32_16x16x32_bf16 v[96:99], v[216:219], a[0:3], v[96:99]
    v_mfma_f32_16x16x32_bf16 v[136:139], v[216:219], a[4:7], v[136:139]
    v_mfma_f32_16x16x32_bf16 v[176:179], v[216:219], a[8:11], v[176:179]
    v_mfma_f32_16x16x32_bf16 v[100:103], v[220:223], a[0:3], v[100:103]
    v_mfma_f32_16x16x32_bf16 v[140:143], v[220:223], a[4:7], v[140:143]
    v_mfma_f32_16x16x32_bf16 v[180:183], v[220:223], a[8:11], v[180:183]
    s_waitcnt vmcnt(17) lgkmcnt(0)
    s_barrier
    v_mfma_f32_16x16x32_bf16 v[64:67], v[16:19], a[12:15], v[64:67]
    s_add_u32 m0, s70, 0
    ds_read_b64_tr_b16 v[184:185], v9 offset:20480
    v_mfma_f32_16x16x32_bf16 v[104:107], v[16:19], a[16:19], v[104:107]
    ds_read_b64_tr_b16 v[186:187], v9 offset:25600
    v_mfma_f32_16x16x32_bf16 v[144:147], v[16:19], a[20:23], v[144:147]
    ds_read_b64_tr_b16 v[188:189], v10 offset:20480
    v_mfma_f32_16x16x32_bf16 v[68:71], v[20:23], a[12:15], v[68:71]
    buffer_load_dwordx4 v4, s[84:87], s64 offen  lds
    s_add_u32 m0, s70, 1024
    v_mfma_f32_16x16x32_bf16 v[108:111], v[20:23], a[16:19], v[108:111]
    ds_read_b64_tr_b16 v[190:191], v10 offset:25600
    ds_read_b64_tr_b16 v[192:193], v9 offset:20544
    v_mfma_f32_16x16x32_bf16 v[148:151], v[20:23], a[20:23], v[148:151]
    v_mfma_f32_16x16x32_bf16 v[72:75], v[24:27], a[12:15], v[72:75]
    ds_read_b64_tr_b16 v[194:195], v9 offset:25664
    v_mfma_f32_16x16x32_bf16 v[112:115], v[24:27], a[16:19], v[112:115]
    buffer_load_dwordx4 v5, s[84:87], s64 offen  lds
    s_add_u32 m0, s70, 2048
    v_mfma_f32_16x16x32_bf16 v[152:155], v[24:27], a[20:23], v[152:155]
    ds_read_b64_tr_b16 v[196:197], v10 offset:20544
    ds_read_b64_tr_b16 v[198:199], v10 offset:25664
    v_mfma_f32_16x16x32_bf16 v[76:79], v[28:31], a[12:15], v[76:79]
    ds_read_b64_tr_b16 v[200:201], v9 offset:20608
    v_mfma_f32_16x16x32_bf16 v[116:119], v[28:31], a[16:19], v[116:119]
    ds_read_b64_tr_b16 v[202:203], v9 offset:25728
    v_mfma_f32_16x16x32_bf16 v[156:159], v[28:31], a[20:23], v[156:159]
    buffer_load_dwordx4 v6, s[84:87], s64 offen  lds
    s_add_u32 m0, s70, 3072
    v_mfma_f32_16x16x32_bf16 v[80:83], v[32:35], a[12:15], v[80:83]
    ds_read_b64_tr_b16 v[204:205], v10 offset:20608
    v_mfma_f32_16x16x32_bf16 v[120:123], v[32:35], a[16:19], v[120:123]
    ds_read_b64_tr_b16 v[206:207], v10 offset:25728
    v_mfma_f32_16x16x32_bf16 v[160:163], v[32:35], a[20:23], v[160:163]
    ds_read_b64_tr_b16 v[208:209], v9 offset:20672
    v_mfma_f32_16x16x32_bf16 v[84:87], v[36:39], a[12:15], v[84:87]
    buffer_load_dwordx4 v7, s[84:87], s64 offen  lds
    s_add_u32 m0, s70, 4096
    v_mfma_f32_16x16x32_bf16 v[124:127], v[36:39], a[16:19], v[124:127]
    ds_read_b64_tr_b16 v[210:211], v9 offset:25792
    ds_read_b64_tr_b16 v[212:213], v10 offset:20672
    v_mfma_f32_16x16x32_bf16 v[164:167], v[36:39], a[20:23], v[164:167]
    v_mfma_f32_16x16x32_bf16 v[88:91], v[40:43], a[12:15], v[88:91]
    ds_read_b64_tr_b16 v[214:215], v10 offset:25792
    v_mfma_f32_16x16x32_bf16 v[128:131], v[40:43], a[16:19], v[128:131]
    buffer_load_dwordx4 v8, s[84:87], s64 offen  lds
    s_add_u32 s64, s64, 81920
    v_mfma_f32_16x16x32_bf16 v[168:171], v[40:43], a[20:23], v[168:171]
    ds_read_b64_tr_b16 v[216:217], v9 offset:20736
    ds_read_b64_tr_b16 v[218:219], v9 offset:25856
    v_mfma_f32_16x16x32_bf16 v[92:95], v[44:47], a[12:15], v[92:95]
    ds_read_b64_tr_b16 v[220:221], v10 offset:20736
    v_mfma_f32_16x16x32_bf16 v[132:135], v[44:47], a[16:19], v[132:135]
    ds_read_b64_tr_b16 v[222:223], v10 offset:25856
    v_mfma_f32_16x16x32_bf16 v[172:175], v[44:47], a[20:23], v[172:175]
    s_cmp_eq_u32 s64, 1310720
    s_cselect_b32 s64, 0, s64
    v_mfma_f32_16x16x32_bf16 v[96:99], v[48:51], a[12:15], v[96:99]
    v_mfma_f32_16x16x32_bf16 v[136:139], v[48:51], a[16:19], v[136:139]
    v_mfma_f32_16x16x32_bf16 v[176:179], v[48:51], a[20:23], v[176:179]
    v_mfma_f32_16x16x32_bf16 v[100:103], v[52:55], a[12:15], v[100:103]
    v_mfma_f32_16x16x32_bf16 v[140:143], v[52:55], a[16:19], v[140:143]
    v_mfma_f32_16x16x32_bf16 v[180:183], v[52:55], a[20:23], v[180:183]
    s_waitcnt lgkmcnt(0)
    v_mfma_f32_16x16x32_bf16 v[64:67], v[184:187], a[24:27], v[64:67]
    ds_read_b64_tr_b16 v[16:17], v9 offset:30720
    v_mfma_f32_16x16x32_bf16 v[104:107], v[184:187], a[28:31], v[104:107]
    ds_read_b64_tr_b16 v[18:19], v9 offset:35840
    v_mfma_f32_16x16x32_bf16 v[144:147], v[184:187], a[32:35], v[144:147]
    ds_read_b64_tr_b16 v[20:21], v10 offset:30720
    v_mfma_f32_16x16x32_bf16 v[68:71], v[188:191], a[24:27], v[68:71]
    ds_read_b64_tr_b16 v[22:23], v10 offset:35840
    v_mfma_f32_16x16x32_bf16 v[108:111], v[188:191], a[28:31], v[108:111]
    ds_read_b64_tr_b16 v[24:25], v9 offset:30784
    v_mfma_f32_16x16x32_bf16 v[148:151], v[188:191], a[32:35], v[148:151]
    v_mfma_f32_16x16x32_bf16 v[72:75], v[192:195], a[24:27], v[72:75]
    ds_read_b64_tr_b16 v[26:27], v9 offset:35904
    v_mfma_f32_16x16x32_bf16 v[112:115], v[192:195], a[28:31], v[112:115]
    ds_read_b64_tr_b16 v[28:29], v10 offset:30784
    v_mfma_f32_16x16x32_bf16 v[152:155], v[192:195], a[32:35], v[152:155]
    ds_read_b64_tr_b16 v[30:31], v10 offset:35904
    v_mfma_f32_16x16x32_bf16 v[76:79], v[196:199], a[24:27], v[76:79]
    ds_read_b64_tr_b16 v[32:33], v9 offset:30848
    v_mfma_f32_16x16x32_bf16 v[116:119], v[196:199], a[28:31], v[116:119]
    ds_read_b64_tr_b16 v[34:35], v9 offset:35968
    v_mfma_f32_16x16x32_bf16 v[156:159], v[196:199], a[32:35], v[156:159]
    v_mfma_f32_16x16x32_bf16 v[80:83], v[200:203], a[24:27], v[80:83]
    ds_read_b64_tr_b16 v[36:37], v10 offset:30848
    v_mfma_f32_16x16x32_bf16 v[120:123], v[200:203], a[28:31], v[120:123]
    ds_read_b64_tr_b16 v[38:39], v10 offset:35968
    v_mfma_f32_16x16x32_bf16 v[160:163], v[200:203], a[32:35], v[160:163]
    ds_read_b64_tr_b16 v[40:41], v9 offset:30912
    v_mfma_f32_16x16x32_bf16 v[84:87], v[204:207], a[24:27], v[84:87]
    ds_read_b64_tr_b16 v[42:43], v9 offset:36032
    v_mfma_f32_16x16x32_bf16 v[124:127], v[204:207], a[28:31], v[124:127]
    ds_read_b64_tr_b16 v[44:45], v10 offset:30912
    v_mfma_f32_16x16x32_bf16 v[164:167], v[204:207], a[32:35], v[164:167]
    v_mfma_f32_16x16x32_bf16 v[88:91], v[208:211], a[24:27], v[88:91]
    ds_read_b64_tr_b16 v[46:47], v10 offset:36032
    v_mfma_f32_16x16x32_bf16 v[128:131], v[208:211], a[28:31], v[128:131]
    ds_read_b64_tr_b16 v[48:49], v9 offset:30976
    v_mfma_f32_16x16x32_bf16 v[168:171], v[208:211], a[32:35], v[168:171]
    ds_read_b64_tr_b16 v[50:51], v9 offset:36096
    v_mfma_f32_16x16x32_bf16 v[92:95], v[212:215], a[24:27], v[92:95]
    ds_read_b64_tr_b16 v[52:53], v10 offset:30976
    v_mfma_f32_16x16x32_bf16 v[132:135], v[212:215], a[28:31], v[132:135]
    ds_read_b64_tr_b16 v[54:55], v10 offset:36096
    v_mfma_f32_16x16x32_bf16 v[172:175], v[212:215], a[32:35], v[172:175]
    v_mfma_f32_16x16x32_bf16 v[96:99], v[216:219], a[24:27], v[96:99]
    v_mfma_f32_16x16x32_bf16 v[136:139], v[216:219], a[28:31], v[136:139]
    v_mfma_f32_16x16x32_bf16 v[176:179], v[216:219], a[32:35], v[176:179]
    v_mfma_f32_16x16x32_bf16 v[100:103], v[220:223], a[24:27], v[100:103]
    v_mfma_f32_16x16x32_bf16 v[140:143], v[220:223], a[28:31], v[140:143]
    v_mfma_f32_16x16x32_bf16 v[180:183], v[220:223], a[32:35], v[180:183]
    s_waitcnt vmcnt(9) lgkmcnt(0)
    s_barrier
    v_mfma_f32_16x16x32_bf16 v[64:67], v[16:19], a[36:39], v[64:67]
    s_lshl_b32 s34, s7, 2
    ds_read_b64_tr_b16 v[184:185], v9 offset:40960
    v_mfma_f32_16x16x32_bf16 v[104:107], v[16:19], a[40:43], v[104:107]
    s_add_u32 s34, s34, s6
    ds_read_b64_tr_b16 v[186:187], v9 offset:46080
    v_mfma_f32_16x16x32_bf16 v[144:147], v[16:19], a[44:47], v[144:147]
    s_lshl_b32 s34, s34, 2
    ds_read_b64_tr_b16 v[188:189], v10 offset:40960
    v_mfma_f32_16x16x32_bf16 v[68:71], v[20:23], a[36:39], v[68:71]
    s_add_u32 s35, s34, s60
    ds_read_b64_tr_b16 v[190:191], v10 offset:46080
    v_mfma_f32_16x16x32_bf16 v[108:111], v[20:23], a[40:43], v[108:111]
    s_lshl_b32 s35, s35, 2
    ds_read_b64_tr_b16 v[192:193], v9 offset:41024
    v_mfma_f32_16x16x32_bf16 v[148:151], v[20:23], a[44:47], v[148:151]
    s_add_u32 s35, s35, s4
    v_mfma_f32_16x16x32_bf16 v[72:75], v[24:27], a[36:39], v[72:75]
    ds_read_b64_tr_b16 v[194:195], v9 offset:46144
    v_mfma_f32_16x16x32_bf16 v[112:115], v[24:27], a[40:43], v[112:115]
    s_mul_i32 s35, s35, 15360
    ds_read_b64_tr_b16 v[196:197], v10 offset:41024
    v_mfma_f32_16x16x32_bf16 v[152:155], v[24:27], a[44:47], v[152:155]
    s_add_u32 s35, s35, 33554432
    ds_read_b64_tr_b16 v[198:199], v10 offset:46144
    v_mfma_f32_16x16x32_bf16 v[76:79], v[28:31], a[36:39], v[76:79]
    s_add_u32 s52, s40, s35
    s_addc_u32 s53, s41, 0
    ds_read_b64_tr_b16 v[200:201], v9 offset:41088
    v_mfma_f32_16x16x32_bf16 v[116:119], v[28:31], a[40:43], v[116:119]
    s_and_b32 s53, s53, 0xffff
    ds_read_b64_tr_b16 v[202:203], v9 offset:46208
    v_mfma_f32_16x16x32_bf16 v[156:159], v[28:31], a[44:47], v[156:159]
    s_mov_b32 s54, 15360
    v_mfma_f32_16x16x32_bf16 v[80:83], v[32:35], a[36:39], v[80:83]
    v_add_u32 v231, 65536, v0
    ds_read_b64_tr_b16 v[204:205], v10 offset:41088
    v_mfma_f32_16x16x32_bf16 v[120:123], v[32:35], a[40:43], v[120:123]
    ds_read_b64_tr_b16 v[206:207], v10 offset:46208
    v_mfma_f32_16x16x32_bf16 v[160:163], v[32:35], a[44:47], v[160:163]
    s_add_u32 s35, s34, s4
    ds_read_b64_tr_b16 v[208:209], v9 offset:41152
    v_mfma_f32_16x16x32_bf16 v[84:87], v[36:39], a[36:39], v[84:87]
    s_mul_i32 s35, s35, 61440
    ds_read_b64_tr_b16 v[210:211], v9 offset:46272
    v_mfma_f32_16x16x32_bf16 v[124:127], v[36:39], a[40:43], v[124:127]
    s_add_u32 s35, s35, 33554432
    ds_read_b64_tr_b16 v[212:213], v10 offset:41152
    v_mfma_f32_16x16x32_bf16 v[164:167], v[36:39], a[44:47], v[164:167]
    s_add_u32 s56, s40, s35
    s_addc_u32 s57, s41, 0
    v_mfma_f32_16x16x32_bf16 v[88:91], v[40:43], a[36:39], v[88:91]
    s_and_b32 s57, s57, 0xffff
    ds_read_b64_tr_b16 v[214:215], v10 offset:46272
    v_mfma_f32_16x16x32_bf16 v[128:131], v[40:43], a[40:43], v[128:131]
    s_mov_b32 s58, 61440
    ds_read_b64_tr_b16 v[216:217], v9 offset:41216
    v_mfma_f32_16x16x32_bf16 v[168:171], v[40:43], a[44:47], v[168:171]
    ds_read_b64_tr_b16 v[218:219], v9 offset:46336
    v_mfma_f32_16x16x32_bf16 v[92:95], v[44:47], a[36:39], v[92:95]
    s_mul_i32 s34, s62, 192
    ds_read_b64_tr_b16 v[220:221], v10 offset:41216
    v_mfma_f32_16x16x32_bf16 v[132:135], v[44:47], a[40:43], v[132:135]
    s_mul_i32 s35, s4, 48
    ds_read_b64_tr_b16 v[222:223], v10 offset:46336
    v_mfma_f32_16x16x32_bf16 v[172:175], v[44:47], a[44:47], v[172:175]
    s_add_u32 s34, s34, s35
    v_mfma_f32_16x16x32_bf16 v[96:99], v[48:51], a[36:39], v[96:99]
    s_mul_i32 s34, s34, 2560
    v_mfma_f32_16x16x32_bf16 v[136:139], v[48:51], a[40:43], v[136:139]
    s_mul_i32 s35, s61, 1280
    v_mfma_f32_16x16x32_bf16 v[176:179], v[48:51], a[44:47], v[176:179]
    v_mfma_f32_16x16x32_bf16 v[100:103], v[52:55], a[36:39], v[100:103]
    v_mfma_f32_16x16x32_bf16 v[140:143], v[52:55], a[40:43], v[140:143]
    v_mfma_f32_16x16x32_bf16 v[180:183], v[52:55], a[44:47], v[180:183]
    s_waitcnt lgkmcnt(0)
    v_mfma_f32_16x16x32_bf16 v[64:67], v[184:187], a[48:51], v[64:67]
    s_add_u32 s34, s34, s35
    ds_read_b64_tr_b16 v[16:17], v9 offset:51200
    v_mfma_f32_16x16x32_bf16 v[104:107], v[184:187], a[52:55], v[104:107]
    s_mul_i32 s35, s6, 320
    ds_read_b64_tr_b16 v[18:19], v9 offset:56320
    v_mfma_f32_16x16x32_bf16 v[144:147], v[184:187], a[56:59], v[144:147]
    s_add_u32 s34, s34, s35
    ds_read_b64_tr_b16 v[20:21], v10 offset:51200
    v_mfma_f32_16x16x32_bf16 v[68:71], v[188:191], a[48:51], v[68:71]
    s_add_u32 s44, s36, s34
    s_addc_u32 s45, s37, 0
    ds_read_b64_tr_b16 v[22:23], v10 offset:56320
    v_mfma_f32_16x16x32_bf16 v[108:111], v[188:191], a[52:55], v[108:111]
    s_and_b32 s45, s45, 0xffff
    ds_read_b64_tr_b16 v[24:25], v9 offset:51264
    v_mfma_f32_16x16x32_bf16 v[148:151], v[188:191], a[56:59], v[148:151]
    s_sub_u32 s46, 3932160, s34
    v_mfma_f32_16x16x32_bf16 v[72:75], v[192:195], a[48:51], v[72:75]
    ds_read_b64_tr_b16 v[26:27], v9 offset:56384
    v_mfma_f32_16x16x32_bf16 v[112:115], v[192:195], a[52:55], v[112:115]
    v_and_b32 v237, 15, v1
    ds_read_b64_tr_b16 v[28:29], v10 offset:51264
    v_mfma_f32_16x16x32_bf16 v[152:155], v[192:195], a[56:59], v[152:155]
    v_mul_u32_u24 v237, 2560, v237
    ds_read_b64_tr_b16 v[30:31], v10 offset:56384
    v_mfma_f32_16x16x32_bf16 v[76:79], v[196:199], a[48:51], v[76:79]
    v_bfe_u32 v238, v1, 4, 1
    ds_read_b64_tr_b16 v[32:33], v9 offset:51328
    v_mfma_f32_16x16x32_bf16 v[116:119], v[196:199], a[52:55], v[116:119]
    v_lshl_add_u32 v237, v238, 5, v237
    ds_read_b64_tr_b16 v[34:35], v9 offset:56448
    v_mfma_f32_16x16x32_bf16 v[156:159], v[196:199], a[56:59], v[156:159]
    v_lshrrev_b32 v238, 5, v1
    v_mfma_f32_16x16x32_bf16 v[80:83], v[200:203], a[48:51], v[80:83]
    v_lshl_add_u32 v233, v238, 4, v237
    ds_read_b64_tr_b16 v[36:37], v10 offset:51328
    v_mfma_f32_16x16x32_bf16 v[120:123], v[200:203], a[52:55], v[120:123]
    ds_read_b64_tr_b16 v[38:39], v10 offset:56448
    v_mfma_f32_16x16x32_bf16 v[160:163], v[200:203], a[56:59], v[160:163]
    s_lshl_b32 s34, s60, 10
    ds_read_b64_tr_b16 v[40:41], v9 offset:51392
    v_mfma_f32_16x16x32_bf16 v[84:87], v[204:207], a[48:51], v[84:87]
    v_add_u32 v237, s34, v0
    ds_read_b64_tr_b16 v[42:43], v9 offset:56512
    v_mfma_f32_16x16x32_bf16 v[124:127], v[204:207], a[52:55], v[124:127]
    s_add_u32 s34, s4, 1
    ds_read_b64_tr_b16 v[44:45], v10 offset:51392
    v_mfma_f32_16x16x32_bf16 v[164:167], v[204:207], a[56:59], v[164:167]
    s_and_b32 s34, s34, 3
    v_mfma_f32_16x16x32_bf16 v[88:91], v[208:211], a[48:51], v[88:91]
    s_mul_i32 s34, s34, 15360
    ds_read_b64_tr_b16 v[46:47], v10 offset:56512
    v_mfma_f32_16x16x32_bf16 v[128:131], v[208:211], a[52:55], v[128:131]
    v_add_u32 v234, s34, v237
    ds_read_b64_tr_b16 v[48:49], v9 offset:51456
    v_mfma_f32_16x16x32_bf16 v[168:171], v[208:211], a[56:59], v[168:171]
    ds_read_b64_tr_b16 v[50:51], v9 offset:56576
    v_mfma_f32_16x16x32_bf16 v[92:95], v[212:215], a[48:51], v[92:95]
    s_add_u32 s34, s4, 2
    ds_read_b64_tr_b16 v[52:53], v10 offset:51456
    v_mfma_f32_16x16x32_bf16 v[132:135], v[212:215], a[52:55], v[132:135]
    s_and_b32 s34, s34, 3
    ds_read_b64_tr_b16 v[54:55], v10 offset:56576
    v_mfma_f32_16x16x32_bf16 v[172:175], v[212:215], a[56:59], v[172:175]
    s_mul_i32 s34, s34, 15360
    v_mfma_f32_16x16x32_bf16 v[96:99], v[216:219], a[48:51], v[96:99]
    v_add_u32 v235, s34, v237
    v_mfma_f32_16x16x32_bf16 v[136:139], v[216:219], a[52:55], v[136:139]
    s_add_u32 s34, s4, 3
    v_mfma_f32_16x16x32_bf16 v[176:179], v[216:219], a[56:59], v[176:179]
    v_mfma_f32_16x16x32_bf16 v[100:103], v[220:223], a[48:51], v[100:103]
    v_mfma_f32_16x16x32_bf16 v[140:143], v[220:223], a[52:55], v[140:143]
    v_mfma_f32_16x16x32_bf16 v[180:183], v[220:223], a[56:59], v[180:183]
    s_waitcnt vmcnt(0) lgkmcnt(0)
    s_barrier
    v_mfma_f32_16x16x32_bf16 v[64:67], v[16:19], a[60:63], v[64:67]
    s_and_b32 s34, s34, 3
    ds_read_b64_tr_b16 v[184:185], v9 offset:0
    v_mfma_f32_16x16x32_bf16 v[104:107], v[16:19], a[64:67], v[104:107]
    s_mul_i32 s34, s34, 15360
    ds_read_b64_tr_b16 v[186:187], v9 offset:5120
    v_mfma_f32_16x16x32_bf16 v[144:147], v[16:19], a[68:71], v[144:147]
    v_add_u32 v236, s34, v237
    ds_read_b64_tr_b16 v[188:189], v10 offset:0
    v_mfma_f32_16x16x32_bf16 v[68:71], v[20:23], a[60:63], v[68:71]
    s_lshl_b32 s34, s60, 11
    ds_read_b64_tr_b16 v[190:191], v10 offset:5120
    v_mfma_f32_16x16x32_bf16 v[108:111], v[20:23], a[64:67], v[108:111]
    v_add_u32 v232, s34, v231
    ds_read_b64_tr_b16 v[192:193], v9 offset:64
    v_mfma_f32_16x16x32_bf16 v[148:151], v[20:23], a[68:71], v[148:151]
    s_mov_b32 s12, 4096
    v_mfma_f32_16x16x32_bf16 v[72:75], v[24:27], a[60:63], v[72:75]
    ds_read_b64_tr_b16 v[194:195], v9 offset:5184
    v_mfma_f32_16x16x32_bf16 v[112:115], v[24:27], a[64:67], v[112:115]
    s_mov_b32 s13, 8192
    ds_read_b64_tr_b16 v[196:197], v10 offset:64
    v_mfma_f32_16x16x32_bf16 v[152:155], v[24:27], a[68:71], v[152:155]
    s_mov_b32 s15, 12288
    ds_read_b64_tr_b16 v[198:199], v10 offset:5184
    v_mfma_f32_16x16x32_bf16 v[76:79], v[28:31], a[60:63], v[76:79]
    s_cmp_eq_u32 s60, 3
    s_cselect_b32 s14, 0x40000000, 12288
    ds_read_b64_tr_b16 v[200:201], v9 offset:128
    v_mfma_f32_16x16x32_bf16 v[116:119], v[28:31], a[64:67], v[116:119]
    s_mov_b32 s67, 0xffff0000
    ds_read_b64_tr_b16 v[202:203], v9 offset:5248
    v_mfma_f32_16x16x32_bf16 v[156:159], v[28:31], a[68:71], v[156:159]
    s_add_u32 s34, s60, 0
    v_mfma_f32_16x16x32_bf16 v[80:83], v[32:35], a[60:63], v[80:83]
    s_mul_i32 s35, s34, 13
    ds_read_b64_tr_b16 v[204:205], v10 offset:128
    v_mfma_f32_16x16x32_bf16 v[120:123], v[32:35], a[64:67], v[120:123]
    ds_read_b64_tr_b16 v[206:207], v10 offset:5248
    v_mfma_f32_16x16x32_bf16 v[160:163], v[32:35], a[68:71], v[160:163]
    s_lshr_b32 s35, s35, 6
    ds_read_b64_tr_b16 v[208:209], v9 offset:192
    v_mfma_f32_16x16x32_bf16 v[84:87], v[36:39], a[60:63], v[84:87]
    s_mul_i32 s3, s35, 5
    ds_read_b64_tr_b16 v[210:211], v9 offset:5312
    v_mfma_f32_16x16x32_bf16 v[124:127], v[36:39], a[64:67], v[124:127]
    s_sub_u32 s3, s34, s3
    ds_read_b64_tr_b16 v[212:213], v10 offset:192
    v_mfma_f32_16x16x32_bf16 v[164:167], v[36:39], a[68:71], v[164:167]
    s_mul_i32 s35, s35, 40960
    v_mfma_f32_16x16x32_bf16 v[88:91], v[40:43], a[60:63], v[88:91]
    s_lshl_b32 s3, s3, 6
    ds_read_b64_tr_b16 v[214:215], v10 offset:5312
    v_mfma_f32_16x16x32_bf16 v[128:131], v[40:43], a[64:67], v[128:131]
    s_add_u32 s80, s35, s3
    ds_read_b64_tr_b16 v[216:217], v9 offset:256
    v_mfma_f32_16x16x32_bf16 v[168:171], v[40:43], a[68:71], v[168:171]
    ds_read_b64_tr_b16 v[218:219], v9 offset:5376
    v_mfma_f32_16x16x32_bf16 v[92:95], v[44:47], a[60:63], v[92:95]
    s_add_u32 s34, s60, 4
    ds_read_b64_tr_b16 v[220:221], v10 offset:256
    v_mfma_f32_16x16x32_bf16 v[132:135], v[44:47], a[64:67], v[132:135]
    s_mul_i32 s35, s34, 13
    ds_read_b64_tr_b16 v[222:223], v10 offset:5376
    v_mfma_f32_16x16x32_bf16 v[172:175], v[44:47], a[68:71], v[172:175]
    s_lshr_b32 s35, s35, 6
    v_mfma_f32_16x16x32_bf16 v[96:99], v[48:51], a[60:63], v[96:99]
    s_mul_i32 s3, s35, 5
    v_mfma_f32_16x16x32_bf16 v[136:139], v[48:51], a[64:67], v[136:139]
    s_sub_u32 s3, s34, s3
    v_mfma_f32_16x16x32_bf16 v[176:179], v[48:51], a[68:71], v[176:179]
    v_mfma_f32_16x16x32_bf16 v[100:103], v[52:55], a[60:63], v[100:103]
    v_mfma_f32_16x16x32_bf16 v[140:143], v[52:55], a[64:67], v[140:143]
    v_mfma_f32_16x16x32_bf16 v[180:183], v[52:55], a[68:71], v[180:183]
    s_waitcnt lgkmcnt(0)
    v_mfma_f32_16x16x32_bf16 v[64:67], v[184:187], a[72:75], v[64:67]
    s_mul_i32 s35, s35, 40960
    ds_read_b64_tr_b16 v[16:17], v9 offset:10240
    v_mfma_f32_16x16x32_bf16 v[104:107], v[184:187], a[76:79], v[104:107]
    s_lshl_b32 s3, s3, 6
    ds_read_b64_tr_b16 v[18:19], v9 offset:15360
    v_mfma_f32_16x16x32_bf16 v[144:147], v[184:187], a[80:83], v[144:147]
    s_add_u32 s81, s35, s3
    ds_read_b64_tr_b16 v[20:21], v10 offset:10240
    v_mfma_f32_16x16x32_bf16 v[68:71], v[188:191], a[72:75], v[68:71]
    ds_read_b64_tr_b16 v[22:23], v10 offset:15360
    v_mfma_f32_16x16x32_bf16 v[108:111], v[188:191], a[76:79], v[108:111]
    s_add_u32 s34, s60, 8
    ds_read_b64_tr_b16 v[24:25], v9 offset:10304
    v_mfma_f32_16x16x32_bf16 v[148:151], v[188:191], a[80:83], v[148:151]
    s_mul_i32 s35, s34, 13
    v_mfma_f32_16x16x32_bf16 v[72:75], v[192:195], a[72:75], v[72:75]
    s_lshr_b32 s35, s35, 6
    ds_read_b64_tr_b16 v[26:27], v9 offset:15424
    v_mfma_f32_16x16x32_bf16 v[112:115], v[192:195], a[76:79], v[112:115]
    ds_read_b64_tr_b16 v[28:29], v10 offset:10304
    v_mfma_f32_16x16x32_bf16 v[152:155], v[192:195], a[80:83], v[152:155]
    s_mul_i32 s3, s35, 5
    ds_read_b64_tr_b16 v[30:31], v10 offset:15424
    v_mfma_f32_16x16x32_bf16 v[76:79], v[196:199], a[72:75], v[76:79]
    s_sub_u32 s3, s34, s3
    ds_read_b64_tr_b16 v[32:33], v9 offset:10368
    v_mfma_f32_16x16x32_bf16 v[116:119], v[196:199], a[76:79], v[116:119]
    s_mul_i32 s35, s35, 40960
    ds_read_b64_tr_b16 v[34:35], v9 offset:15488
    v_mfma_f32_16x16x32_bf16 v[156:159], v[196:199], a[80:83], v[156:159]
    v_mfma_f32_16x16x32_bf16 v[80:83], v[200:203], a[72:75], v[80:83]
    s_lshl_b32 s3, s3, 6
    ds_read_b64_tr_b16 v[36:37], v10 offset:10368
    v_mfma_f32_16x16x32_bf16 v[120:123], v[200:203], a[76:79], v[120:123]
    s_add_u32 s82, s35, s3
    ds_read_b64_tr_b16 v[38:39], v10 offset:15488
    v_mfma_f32_16x16x32_bf16 v[160:163], v[200:203], a[80:83], v[160:163]
    s_add_u32 s34, s60, 12
    ds_read_b64_tr_b16 v[40:41], v9 offset:10432
    v_mfma_f32_16x16x32_bf16 v[84:87], v[204:207], a[72:75], v[84:87]
    ds_read_b64_tr_b16 v[42:43], v9 offset:15552
    v_mfma_f32_16x16x32_bf16 v[124:127], v[204:207], a[76:79], v[124:127]
    s_mul_i32 s35, s34, 13
    ds_read_b64_tr_b16 v[44:45], v10 offset:10432
    v_mfma_f32_16x16x32_bf16 v[164:167], v[204:207], a[80:83], v[164:167]
    s_lshr_b32 s35, s35, 6
    v_mfma_f32_16x16x32_bf16 v[88:91], v[208:211], a[72:75], v[88:91]
    s_mul_i32 s3, s35, 5
    ds_read_b64_tr_b16 v[46:47], v10 offset:15552
    v_mfma_f32_16x16x32_bf16 v[128:131], v[208:211], a[76:79], v[128:131]
    ds_read_b64_tr_b16 v[48:49], v9 offset:10496
    v_mfma_f32_16x16x32_bf16 v[168:171], v[208:211], a[80:83], v[168:171]
    s_sub_u32 s3, s34, s3
    ds_read_b64_tr_b16 v[50:51], v9 offset:15616
    v_mfma_f32_16x16x32_bf16 v[92:95], v[212:215], a[72:75], v[92:95]
    s_mul_i32 s35, s35, 40960
    ds_read_b64_tr_b16 v[52:53], v10 offset:10496
    v_mfma_f32_16x16x32_bf16 v[132:135], v[212:215], a[76:79], v[132:135]
    s_lshl_b32 s3, s3, 6
    ds_read_b64_tr_b16 v[54:55], v10 offset:15616
    v_mfma_f32_16x16x32_bf16 v[172:175], v[212:215], a[80:83], v[172:175]
    v_mfma_f32_16x16x32_bf16 v[96:99], v[216:219], a[72:75], v[96:99]
    s_add_u32 s83, s35, s3
    v_mfma_f32_16x16x32_bf16 v[136:139], v[216:219], a[76:79], v[136:139]
    s_cmp_eq_u32 s60, 3
    s_cselect_b32 s83, 0x40000000, s83
    v_mfma_f32_16x16x32_bf16 v[176:179], v[216:219], a[80:83], v[176:179]
    v_mfma_f32_16x16x32_bf16 v[100:103], v[220:223], a[72:75], v[100:103]
    v_mfma_f32_16x16x32_bf16 v[140:143], v[220:223], a[76:79], v[140:143]
    v_mfma_f32_16x16x32_bf16 v[180:183], v[220:223], a[80:83], v[180:183]
    s_waitcnt lgkmcnt(0)
    s_cmp_eq_u32 s60, s4
    s_cbranch_scc1 L_OWNSLAB
    v_mfma_f32_16x16x32_bf16 v[64:67], v[16:19], a[84:87], v[64:67]
    v_mfma_f32_16x16x32_bf16 v[104:107], v[16:19], a[88:91], v[104:107]
    v_mfma_f32_16x16x32_bf16 v[144:147], v[16:19], a[92:95], v[144:147]
    v_mfma_f32_16x16x32_bf16 v[68:71], v[20:23], a[84:87], v[68:71]
    v_mfma_f32_16x16x32_bf16 v[108:111], v[20:23], a[88:91], v[108:111]
    v_mfma_f32_16x16x32_bf16 v[148:151], v[20:23], a[92:95], v[148:151]
    v_mfma_f32_16x16x32_bf16 v[72:75], v[24:27], a[84:87], v[72:75]
    v_mfma_f32_16x16x32_bf16 v[112:115], v[24:27], a[88:91], v[112:115]
    v_mfma_f32_16x16x32_bf16 v[152:155], v[24:27], a[92:95], v[152:155]
    v_cvt_pk_bf16_f32 v64, v64, v65
    v_cvt_pk_bf16_f32 v65, v66, v67
    s_nop 0
    v_cvt_pk_bf16_f32 v66, v68, v69
    v_mfma_f32_16x16x32_bf16 v[76:79], v[28:31], a[84:87], v[76:79]
    v_cvt_pk_bf16_f32 v67, v70, v71
    buffer_store_dwordx4 v[64:67], v0, s[52:55], 0 offen offset:0 sc1
    v_mfma_f32_16x16x32_bf16 v[116:119], v[28:31], a[88:91], v[116:119]
    v_cvt_pk_bf16_f32 v104, v104, v105
    v_cvt_pk_bf16_f32 v105, v106, v107
    v_cvt_pk_bf16_f32 v106, v108, v109
    v_mfma_f32_16x16x32_bf16 v[156:159], v[28:31], a[92:95], v[156:159]
    v_cvt_pk_bf16_f32 v107, v110, v111
    buffer_store_dwordx4 v[104:107], v0, s[52:55], s12 offen offset:1024 sc1
    v_mfma_f32_16x16x32_bf16 v[80:83], v[32:35], a[84:87], v[80:83]
    v_cvt_pk_bf16_f32 v144, v144, v145
    v_cvt_pk_bf16_f32 v145, v146, v147
    v_cvt_pk_bf16_f32 v146, v148, v149
    v_mfma_f32_16x16x32_bf16 v[120:123], v[32:35], a[88:91], v[120:123]
    v_cvt_pk_bf16_f32 v147, v150, v151
    buffer_store_dwordx4 v[144:147], v0, s[52:55], s13 offen offset:2048 sc1
    v_mfma_f32_16x16x32_bf16 v[160:163], v[32:35], a[92:95], v[160:163]
    v_cvt_pk_bf16_f32 v72, v72, v73
    v_cvt_pk_bf16_f32 v73, v74, v75
    v_cvt_pk_bf16_f32 v74, v76, v77
    v_mfma_f32_16x16x32_bf16 v[84:87], v[36:39], a[84:87], v[84:87]
    v_cvt_pk_bf16_f32 v75, v78, v79
    buffer_store_dwordx4 v[72:75], v0, s[52:55], 0 offen offset:1024 sc1
    v_mfma_f32_16x16x32_bf16 v[124:127], v[36:39], a[88:91], v[124:127]
    v_cvt_pk_bf16_f32 v112, v112, v113
    v_cvt_pk_bf16_f32 v113, v114, v115
    v_cvt_pk_bf16_f32 v114, v116, v117
    v_mfma_f32_16x16x32_bf16 v[164:167], v[36:39], a[92:95], v[164:167]
    v_cvt_pk_bf16_f32 v115, v118, v119
    buffer_store_dwordx4 v[112:115], v0, s[52:55], s12 offen offset:2048 sc1
    v_mfma_f32_16x16x32_bf16 v[88:91], v[40:43], a[84:87], v[88:91]
    v_cvt_pk_bf16_f32 v152, v152, v153
    v_cvt_pk_bf16_f32 v153, v154, v155
    v_cvt_pk_bf16_f32 v154, v156, v157
    v_mfma_f32_16x16x32_bf16 v[128:131], v[40:43], a[88:91], v[128:131]
    v_cvt_pk_bf16_f32 v155, v158, v159
    buffer_store_dwordx4 v[152:155], v0, s[52:55], s13 offen offset:3072 sc1
    v_mfma_f32_16x16x32_bf16 v[168:171], v[40:43], a[92:95], v[168:171]
    v_cvt_pk_bf16_f32 v80, v80, v81
    v_cvt_pk_bf16_f32 v81, v82, v83
    v_cvt_pk_bf16_f32 v82, v84, v85
    v_mfma_f32_16x16x32_bf16 v[92:95], v[44:47], a[84:87], v[92:95]
    v_cvt_pk_bf16_f32 v83, v86, v87
    buffer_store_dwordx4 v[80:83], v0, s[52:55], 0 offen offset:2048 sc1
    v_mfma_f32_16x16x32_bf16 v[132:135], v[44:47], a[88:91], v[132:135]
    v_cvt_pk_bf16_f32 v120, v120, v121
    v_cvt_pk_bf16_f32 v121, v122, v123
    v_cvt_pk_bf16_f32 v122, v124, v125
    v_mfma_f32_16x16x32_bf16 v[172:175], v[44:47], a[92:95], v[172:175]
    v_cvt_pk_bf16_f32 v123, v126, v127
    buffer_store_dwordx4 v[120:123], v0, s[52:55], s12 offen offset:3072 sc1
    v_mfma_f32_16x16x32_bf16 v[96:99], v[48:51], a[84:87], v[96:99]
    v_cvt_pk_bf16_f32 v160, v160, v161
    v_cvt_pk_bf16_f32 v161, v162, v163
    v_cvt_pk_bf16_f32 v162, v164, v165
    v_mfma_f32_16x16x32_bf16 v[136:139], v[48:51], a[88:91], v[136:139]
    v_cvt_pk_bf16_f32 v163, v166, v167
    buffer_store_dwordx4 v[160:163], v0, s[52:55], s15 offen offset:0 sc1
    v_mfma_f32_16x16x32_bf16 v[176:179], v[48:51], a[92:95], v[176:179]
    v_cvt_pk_bf16_f32 v88, v88, v89
    v_cvt_pk_bf16_f32 v89, v90, v91
    v_cvt_pk_bf16_f32 v90, v92, v93
    v_mfma_f32_16x16x32_bf16 v[100:103], v[52:55], a[84:87], v[100:103]
    v_cvt_pk_bf16_f32 v91, v94, v95
    buffer_store_dwordx4 v[88:91], v0, s[52:55], 0 offen offset:3072 sc1
    v_mfma_f32_16x16x32_bf16 v[140:143], v[52:55], a[88:91], v[140:143]
    v_cvt_pk_bf16_f32 v128, v128, v129
    v_cvt_pk_bf16_f32 v129, v130, v131
    v_cvt_pk_bf16_f32 v130, v132, v133
    v_mfma_f32_16x16x32_bf16 v[180:183], v[52:55], a[92:95], v[180:183]
    v_cvt_pk_bf16_f32 v131, v134, v135
    buffer_store_dwordx4 v[128:131], v0, s[52:55], s13 offen offset:0 sc1
    v_cvt_pk_bf16_f32 v168, v168, v169
    v_cvt_pk_bf16_f32 v169, v170, v171
    v_cvt_pk_bf16_f32 v170, v172, v173
    v_cvt_pk_bf16_f32 v171, v174, v175
    buffer_store_dwordx4 v[168:171], v0, s[52:55], s15 offen offset:1024 sc1
    v_cvt_pk_bf16_f32 v96, v96, v97
    v_cvt_pk_bf16_f32 v97, v98, v99
    v_cvt_pk_bf16_f32 v98, v100, v101
    v_cvt_pk_bf16_f32 v99, v102, v103
    buffer_store_dwordx4 v[96:99], v0, s[52:55], s12 offen offset:0 sc1
    v_cvt_pk_bf16_f32 v136, v136, v137
    v_cvt_pk_bf16_f32 v137, v138, v139
    v_cvt_pk_bf16_f32 v138, v140, v141
    v_cvt_pk_bf16_f32 v139, v142, v143
    buffer_store_dwordx4 v[136:139], v0, s[52:55], s13 offen offset:1024 sc1
    v_cvt_pk_bf16_f32 v176, v176, v177
    v_cvt_pk_bf16_f32 v177, v178, v179
    v_cvt_pk_bf16_f32 v178, v180, v181
    v_cvt_pk_bf16_f32 v179, v182, v183
    buffer_store_dwordx4 v[176:179], v0, s[52:55], s15 offen offset:2048 sc1
    s_branch L_SLABDONE
L_OWNSLAB:
    v_mfma_f32_16x16x32_bf16 v[64:67], v[16:19], a[84:87], v[64:67]
    v_mfma_f32_16x16x32_bf16 v[104:107], v[16:19], a[88:91], v[104:107]
    v_mfma_f32_16x16x32_bf16 v[144:147], v[16:19], a[92:95], v[144:147]
    v_mfma_f32_16x16x32_bf16 v[68:71], v[20:23], a[84:87], v[68:71]
    v_mfma_f32_16x16x32_bf16 v[108:111], v[20:23], a[88:91], v[108:111]
    v_mfma_f32_16x16x32_bf16 v[148:151], v[20:23], a[92:95], v[148:151]
    v_mfma_f32_16x16x32_bf16 v[72:75], v[24:27], a[84:87], v[72:75]
    v_mfma_f32_16x16x32_bf16 v[112:115], v[24:27], a[88:91], v[112:115]
    v_mfma_f32_16x16x32_bf16 v[152:155], v[24:27], a[92:95], v[152:155]
    ds_write_b128 v231, v[64:67] offset:0
    v_mfma_f32_16x16x32_bf16 v[76:79], v[28:31], a[84:87], v[76:79]
    s_nop 0
    ds_write_b128 v231, v[68:71] offset:1024
    v_mfma_f32_16x16x32_bf16 v[116:119], v[28:31], a[88:91], v[116:119]
    ds_write_b128 v231, v[104:107] offset:10240
    v_mfma_f32_16x16x32_bf16 v[156:159], v[28:31], a[92:95], v[156:159]
    ds_write_b128 v231, v[108:111] offset:11264
    v_mfma_f32_16x16x32_bf16 v[80:83], v[32:35], a[84:87], v[80:83]
    ds_write_b128 v231, v[144:147] offset:20480
    v_mfma_f32_16x16x32_bf16 v[120:123], v[32:35], a[88:91], v[120:123]
    ds_write_b128 v231, v[148:151] offset:21504
    v_mfma_f32_16x16x32_bf16 v[160:163], v[32:35], a[92:95], v[160:163]
    ds_write_b128 v231, v[72:75] offset:2048
    v_mfma_f32_16x16x32_bf16 v[84:87], v[36:39], a[84:87], v[84:87]
    ds_write_b128 v231, v[76:79] offset:3072
    v_mfma_f32_16x16x32_bf16 v[124:127], v[36:39], a[88:91], v[124:127]
    ds_write_b128 v231, v[112:115] offset:12288
    v_mfma_f32_16x16x32_bf16 v[164:167], v[36:39], a[92:95], v[164:167]
    ds_write_b128 v231, v[116:119] offset:13312
    v_mfma_f32_16x16x32_bf16 v[88:91], v[40:43], a[84:87], v[88:91]
    ds_write_b128 v231, v[152:155] offset:22528
    v_mfma_f32_16x16x32_bf16 v[128:131], v[40:43], a[88:91], v[128:131]
    ds_write_b128 v231, v[156:159] offset:23552
    v_mfma_f32_16x16x32_bf16 v[168:171], v[40:43], a[92:95], v[168:171]
    ds_write_b128 v231, v[80:83] offset:4096
    v_mfma_f32_16x16x32_bf16 v[92:95], v[44:47], a[84:87], v[92:95]
    ds_write_b128 v231, v[84:87] offset:5120
    v_mfma_f32_16x16x32_bf16 v[132:135], v[44:47], a[88:91], v[132:135]
    ds_write_b128 v231, v[120:123] offset:14336
    v_mfma_f32_16x16x32_bf16 v[172:175], v[44:47], a[92:95], v[172:175]
    ds_write_b128 v231, v[124:127] offset:15360
    v_mfma_f32_16x16x32_bf16 v[96:99], v[48:51], a[84:87], v[96:99]
    ds_write_b128 v231, v[160:163] offset:24576
    v_mfma_f32_16x16x32_bf16 v[136:139], v[48:51], a[88:91], v[136:139]
    ds_write_b128 v231, v[164:167] offset:25600
    v_mfma_f32_16x16x32_bf16 v[176:179], v[48:51], a[92:95], v[176:179]
    ds_write_b128 v231, v[88:91] offset:6144
    v_mfma_f32_16x16x32_bf16 v[100:103], v[52:55], a[84:87], v[100:103]
    ds_write_b128 v231, v[92:95] offset:7168
    v_mfma_f32_16x16x32_bf16 v[140:143], v[52:55], a[88:91], v[140:143]
    ds_write_b128 v231, v[128:131] offset:16384
    v_mfma_f32_16x16x32_bf16 v[180:183], v[52:55], a[92:95], v[180:183]
    ds_write_b128 v231, v[132:135] offset:17408
    ds_write_b128 v231, v[168:171] offset:26624
    ds_write_b128 v231, v[172:175] offset:27648
    ds_write_b128 v231, v[96:99] offset:8192
    ds_write_b128 v231, v[100:103] offset:9216
    ds_write_b128 v231, v[136:139] offset:18432
    ds_write_b128 v231, v[140:143] offset:19456
    ds_write_b128 v231, v[176:179] offset:28672
    ds_write_b128 v231, v[180:183] offset:29696
L_SLABDONE:
    s_waitcnt vmcnt(0) lgkmcnt(0)
    global_store_dwordx2 v60, v[56:57], s[40:41] sc1
    s_barrier
    ds_read_b128 v[64:67], v232 offset:0
    ds_read_b128 v[68:71], v232 offset:1024
    ds_read_b128 v[96:99], v232 offset:8192
    ds_read_b128 v[100:103], v232 offset:9216
    ds_read_b128 v[128:131], v232 offset:16384
    ds_read_b128 v[132:135], v232 offset:17408
    ds_read_b128 v[160:163], v232 offset:24576
    ds_read_b128 v[164:167], v232 offset:25600
    s_mov_b32 s79, 1048576
L_PB:
    global_load_dwordx2 v[228:229], v61, s[40:41] sc1
L_PB_C:
    s_waitcnt vmcnt(0)
    v_cmp_ne_u64 vcc, v[228:229], v[56:57]
    s_sub_u32 s79, s79, 1
    s_cbranch_scc1 L_PB_OK
    s_cmp_lg_u64 vcc, 0
    s_cbranch_scc1 L_PB
L_PB_OK:
    buffer_load_dwordx4 v[72:75], v234, s[56:59], 0 offen sc1
    buffer_load_dwordx4 v[76:79], v235, s[56:59], 0 offen sc1
    buffer_load_dwordx4 v[80:83], v236, s[56:59], 0 offen sc1
    buffer_load_dwordx4 v[104:107], v234, s[56:59], s12 offen sc1
    buffer_load_dwordx4 v[108:111], v235, s[56:59], s12 offen sc1
    buffer_load_dwordx4 v[112:115], v236, s[56:59], s12 offen sc1
    buffer_load_dwordx4 v[136:139], v234, s[56:59], s13 offen sc1
    buffer_load_dwordx4 v[140:143], v235, s[56:59], s13 offen sc1
    buffer_load_dwordx4 v[144:147], v236, s[56:59], s13 offen sc1
    buffer_load_dwordx4 v[168:171], v234, s[56:59], s14 offen sc1
    buffer_load_dwordx4 v[172:175], v235, s[56:59], s14 offen sc1
    buffer_load_dwordx4 v[176:179], v236, s[56:59], s14 offen sc1
    s_waitcnt lgkmcnt(0)
    s_waitcnt vmcnt(9)
    v_lshlrev_b32 v84, 16, v72
    v_and_b32 v85, s67, v72
    v_lshlrev_b32 v86, 16, v73
    v_and_b32 v87, s67, v73
    v_lshlrev_b32 v88, 16, v74
    v_and_b32 v89, s67, v74
    v_lshlrev_b32 v90, 16, v75
    v_and_b32 v91, s67, v75
    v_pk_add_f32 v[64:65], v[64:65], v[84:85]
    v_pk_add_f32 v[66:67], v[66:67], v[86:87]
    v_pk_add_f32 v[68:69], v[68:69], v[88:89]
    v_pk_add_f32 v[70:71], v[70:71], v[90:91]
    v_lshlrev_b32 v84, 16, v76
    v_and_b32 v85, s67, v76
    v_lshlrev_b32 v86, 16, v77
    v_and_b32 v87, s67, v77
    v_lshlrev_b32 v88, 16, v78
    v_and_b32 v89, s67, v78
    v_lshlrev_b32 v90, 16, v79
    v_and_b32 v91, s67, v79
    v_pk_add_f32 v[64:65], v[64:65], v[84:85]
    v_pk_add_f32 v[66:67], v[66:67], v[86:87]
    v_pk_add_f32 v[68:69], v[68:69], v[88:89]
    v_pk_add_f32 v[70:71], v[70:71], v[90:91]
    v_lshlrev_b32 v84, 16, v80
    v_and_b32 v85, s67, v80
    v_lshlrev_b32 v86, 16, v81
    v_and_b32 v87, s67, v81
    v_lshlrev_b32 v88, 16, v82
    v_and_b32 v89, s67, v82
    v_lshlrev_b32 v90, 16, v83
    v_and_b32 v91, s67, v83
    v_pk_add_f32 v[64:65], v[64:65], v[84:85]
    v_pk_add_f32 v[66:67], v[66:67], v[86:87]
    v_pk_add_f32 v[68:69], v[68:69], v[88:89]
    v_pk_add_f32 v[70:71], v[70:71], v[90:91]
    v_cvt_pk_bf16_f32 v64, v64, v65
    v_cvt_pk_bf16_f32 v65, v66, v67
    v_cvt_pk_bf16_f32 v66, v68, v69
    v_cvt_pk_bf16_f32 v67, v70, v71
    s_nop 0
    v_permlane16_swap_b32 v64, v66
    v_permlane16_swap_b32 v65, v67
    buffer_store_dwordx4 v[64:67], v233, s[44:47], s80 offen sc1
    s_waitcnt vmcnt(7)
    v_lshlrev_b32 v116, 16, v104
    v_and_b32 v117, s67, v104
    v_lshlrev_b32 v118, 16, v105
    v_and_b32 v119, s67, v105
    v_lshlrev_b32 v120, 16, v106
    v_and_b32 v121, s67, v106
    v_lshlrev_b32 v122, 16, v107
    v_and_b32 v123, s67, v107
    v_pk_add_f32 v[96:97], v[96:97], v[116:117]
    v_pk_add_f32 v[98:99], v[98:99], v[118:119]
    v_pk_add_f32 v[100:101], v[100:101], v[120:121]
    v_pk_add_f32 v[102:103], v[102:103], v[122:123]
    v_lshlrev_b32 v116, 16, v108
    v_and_b32 v117, s67, v108
    v_lshlrev_b32 v118, 16, v109
    v_and_b32 v119, s67, v109
    v_lshlrev_b32 v120, 16, v110
    v_and_b32 v121, s67, v110
    v_lshlrev_b32 v122, 16, v111
    v_and_b32 v123, s67, v111
    v_pk_add_f32 v[96:97], v[96:97], v[116:117]
    v_pk_add_f32 v[98:99], v[98:99], v[118:119]
    v_pk_add_f32 v[100:101], v[100:101], v[120:121]
    v_pk_add_f32 v[102:103], v[102:103], v[122:123]
    v_lshlrev_b32 v116, 16, v112
    v_and_b32 v117, s67, v112
    v_lshlrev_b32 v118, 16, v113
    v_and_b32 v119, s67, v113
    v_lshlrev_b32 v120, 16, v114
    v_and_b32 v121, s67, v114
    v_lshlrev_b32 v122, 16, v115
    v_and_b32 v123, s67, v115
    v_pk_add_f32 v[96:97], v[96:97], v[116:117]
    v_pk_add_f32 v[98:99], v[98:99], v[118:119]
    v_pk_add_f32 v[100:101], v[100:101], v[120:121]
    v_pk_add_f32 v[102:103], v[102:103], v[122:123]
    v_cvt_pk_bf16_f32 v96, v96, v97
    v_cvt_pk_bf16_f32 v97, v98, v99
    v_cvt_pk_bf16_f32 v98, v100, v101
    v_cvt_pk_bf16_f32 v99, v102, v103
    s_nop 0
    v_permlane16_swap_b32 v96, v98
    v_permlane16_swap_b32 v97, v99
    buffer_store_dwordx4 v[96:99], v233, s[44:47], s81 offen sc1
    s_waitcnt vmcnt(5)
    v_lshlrev_b32 v148, 16, v136
    v_and_b32 v149, s67, v136
    v_lshlrev_b32 v150, 16, v137
    v_and_b32 v151, s67, v137
    v_lshlrev_b32 v152, 16, v138
    v_and_b32 v153, s67, v138
    v_lshlrev_b32 v154, 16, v139
    v_and_b32 v155, s67, v139
    v_pk_add_f32 v[128:129], v[128:129], v[148:149]
    v_pk_add_f32 v[130:131], v[130:131], v[150:151]
    v_pk_add_f32 v[132:133], v[132:133], v[152:153]
    v_pk_add_f32 v[134:135], v[134:135], v[154:155]
    v_lshlrev_b32 v148, 16, v140
    v_and_b32 v149, s67, v140
    v_lshlrev_b32 v150, 16, v141
    v_and_b32 v151, s67, v141
    v_lshlrev_b32 v152, 16, v142
    v_and_b32 v153, s67, v142
    v_lshlrev_b32 v154, 16, v143
    v_and_b32 v155, s67, v143
    v_pk_add_f32 v[128:129], v[128:129], v[148:149]
    v_pk_add_f32 v[130:131], v[130:131], v[150:151]
    v_pk_add_f32 v[132:133], v[132:133], v[152:153]
    v_pk_add_f32 v[134:135], v[134:135], v[154:155]
    v_lshlrev_b32 v148, 16, v144
    v_and_b32 v149, s67, v144
    v_lshlrev_b32 v150, 16, v145
    v_and_b32 v151, s67, v145
    v_lshlrev_b32 v152, 16, v146
    v_and_b32 v153, s67, v146
    v_lshlrev_b32 v154, 16, v147
    v_and_b32 v155, s67, v147
    v_pk_add_f32 v[128:129], v[128:129], v[148:149]
    v_pk_add_f32 v[130:131], v[130:131], v[150:151]
    v_pk_add_f32 v[132:133], v[132:133], v[152:153]
    v_pk_add_f32 v[134:135], v[134:135], v[154:155]
    v_cvt_pk_bf16_f32 v128, v128, v129
    v_cvt_pk_bf16_f32 v129, v130, v131
    v_cvt_pk_bf16_f32 v130, v132, v133
    v_cvt_pk_bf16_f32 v131, v134, v135
    s_nop 0
    v_permlane16_swap_b32 v128, v130
    v_permlane16_swap_b32 v129, v131
    buffer_store_dwordx4 v[128:131], v233, s[44:47], s82 offen sc1
    s_waitcnt vmcnt(3)
    v_lshlrev_b32 v180, 16, v168
    v_and_b32 v181, s67, v168
    v_lshlrev_b32 v182, 16, v169
    v_and_b32 v183, s67, v169
    v_lshlrev_b32 v184, 16, v170
    v_and_b32 v185, s67, v170
    v_lshlrev_b32 v186, 16, v171
    v_and_b32 v187, s67, v171
    v_pk_add_f32 v[160:161], v[160:161], v[180:181]
    v_pk_add_f32 v[162:163], v[162:163], v[182:183]
    v_pk_add_f32 v[164:165], v[164:165], v[184:185]
    v_pk_add_f32 v[166:167], v[166:167], v[186:187]
    v_lshlrev_b32 v180, 16, v172
    v_and_b32 v181, s67, v172
    v_lshlrev_b32 v182, 16, v173
    v_and_b32 v183, s67, v173
    v_lshlrev_b32 v184, 16, v174
    v_and_b32 v185, s67, v174
    v_lshlrev_b32 v186, 16, v175
    v_and_b32 v187, s67, v175
    v_pk_add_f32 v[160:161], v[160:161], v[180:181]
    v_pk_add_f32 v[162:163], v[162:163], v[182:183]
    v_pk_add_f32 v[164:165], v[164:165], v[184:185]
    v_pk_add_f32 v[166:167], v[166:167], v[186:187]
    v_lshlrev_b32 v180, 16, v176
    v_and_b32 v181, s67, v176
    v_lshlrev_b32 v182, 16, v177
    v_and_b32 v183, s67, v177
    v_lshlrev_b32 v184, 16, v178
    v_and_b32 v185, s67, v178
    v_lshlrev_b32 v186, 16, v179
    v_and_b32 v187, s67, v179
    v_pk_add_f32 v[160:161], v[160:161], v[180:181]
    v_pk_add_f32 v[162:163], v[162:163], v[182:183]
    v_pk_add_f32 v[164:165], v[164:165], v[184:185]
    v_pk_add_f32 v[166:167], v[166:167], v[186:187]
    v_cvt_pk_bf16_f32 v160, v160, v161
    v_cvt_pk_bf16_f32 v161, v162, v163
    v_cvt_pk_bf16_f32 v162, v164, v165
    v_cvt_pk_bf16_f32 v163, v166, v167
    s_nop 0
    v_permlane16_swap_b32 v160, v162
    v_permlane16_swap_b32 v161, v163
    buffer_store_dwordx4 v[160:163], v233, s[44:47], s83 offen sc1
L_END:
    s_endpgm
L_T0F:
    v_mfma_f32_16x16x32_bf16 v[64:67], v[184:187], a[120:123], v[64:67]
    ds_read_b128 a[168:171], v63 offset:24576
    ds_read_b64_tr_b16 v[16:17], v9 offset:30720
    v_mfma_f32_16x16x32_bf16 v[104:107], v[184:187], a[124:127], v[104:107]
    ds_read_b64_tr_b16 v[18:19], v9 offset:35840
    v_mfma_f32_16x16x32_bf16 v[144:147], v[184:187], a[128:131], v[144:147]
    ds_read_b64_tr_b16 v[20:21], v10 offset:30720
    v_mfma_f32_16x16x32_bf16 v[68:71], v[188:191], a[120:123], v[68:71]
    ds_read_b128 a[172:175], v63 offset:25600
    ds_read_b64_tr_b16 v[22:23], v10 offset:35840
    v_mfma_f32_16x16x32_bf16 v[108:111], v[188:191], a[124:127], v[108:111]
    ds_read_b64_tr_b16 v[24:25], v9 offset:30784
    v_mfma_f32_16x16x32_bf16 v[148:151], v[188:191], a[128:131], v[148:151]
    v_mfma_f32_16x16x32_bf16 v[72:75], v[192:195], a[120:123], v[72:75]
    ds_read_b64_tr_b16 v[26:27], v9 offset:35904
    v_mfma_f32_16x16x32_bf16 v[112:115], v[192:195], a[124:127], v[112:115]
    ds_read_b128 a[176:179], v63 offset:26624
    ds_read_b64_tr_b16 v[28:29], v10 offset:30784
    v_mfma_f32_16x16x32_bf16 v[152:155], v[192:195], a[128:131], v[152:155]
    ds_read_b64_tr_b16 v[30:31], v10 offset:35904
    v_mfma_f32_16x16x32_bf16 v[76:79], v[196:199], a[120:123], v[76:79]
    ds_read_b64_tr_b16 v[32:33], v9 offset:30848
    v_mfma_f32_16x16x32_bf16 v[116:119], v[196:199], a[124:127], v[116:119]
    ds_read_b64_tr_b16 v[34:35], v9 offset:35968
    v_mfma_f32_16x16x32_bf16 v[156:159], v[196:199], a[128:131], v[156:159]
    ds_read_b128 a[180:183], v63 offset:36864
    v_mfma_f32_16x16x32_bf16 v[80:83], v[200:203], a[120:123], v[80:83]
    ds_read_b64_tr_b16 v[36:37], v10 offset:30848
    v_mfma_f32_16x16x32_bf16 v[120:123], v[200:203], a[124:127], v[120:123]
    ds_read_b64_tr_b16 v[38:39], v10 offset:35968
    v_mfma_f32_16x16x32_bf16 v[160:163], v[200:203], a[128:131], v[160:163]
    ds_read_b64_tr_b16 v[40:41], v9 offset:30912
    v_mfma_f32_16x16x32_bf16 v[84:87], v[204:207], a[120:123], v[84:87]
    ds_read_b128 a[184:187], v63 offset:37888
    ds_read_b64_tr_b16 v[42:43], v9 offset:36032
    v_mfma_f32_16x16x32_bf16 v[124:127], v[204:207], a[124:127], v[124:127]
    ds_read_b64_tr_b16 v[44:45], v10 offset:30912
    v_mfma_f32_16x16x32_bf16 v[164:167], v[204:207], a[128:131], v[164:167]
    v_mfma_f32_16x16x32_bf16 v[88:91], v[208:211], a[120:123], v[88:91]
    ds_read_b64_tr_b16 v[46:47], v10 offset:36032
    v_mfma_f32_16x16x32_bf16 v[128:131], v[208:211], a[124:127], v[128:131]
    ds_read_b128 a[188:191], v63 offset:38912
    ds_read_b64_tr_b16 v[48:49], v9 offset:30976
    v_mfma_f32_16x16x32_bf16 v[168:171], v[208:211], a[128:131], v[168:171]
    ds_read_b64_tr_b16 v[50:51], v9 offset:36096
    v_mfma_f32_16x16x32_bf16 v[92:95], v[212:215], a[120:123], v[92:95]
    ds_read_b64_tr_b16 v[52:53], v10 offset:30976
    v_mfma_f32_16x16x32_bf16 v[132:135], v[212:215], a[124:127], v[132:135]
    ds_read_b64_tr_b16 v[54:55], v10 offset:36096
    v_mfma_f32_16x16x32_bf16 v[172:175], v[212:215], a[128:131], v[172:175]
    buffer_load_dwordx4 a[0:3], v0, s[88:91], s16 offen offset:0 sc1
    v_mfma_f32_16x16x32_bf16 v[96:99], v[216:219], a[120:123], v[96:99]
    v_mfma_f32_16x16x32_bf16 v[136:139], v[216:219], a[124:127], v[136:139]
    v_mfma_f32_16x16x32_bf16 v[176:179], v[216:219], a[128:131], v[176:179]
    v_mfma_f32_16x16x32_bf16 v[100:103], v[220:223], a[120:123], v[100:103]
    v_mfma_f32_16x16x32_bf16 v[140:143], v[220:223], a[124:127], v[140:143]
    v_mfma_f32_16x16x32_bf16 v[180:183], v[220:223], a[128:131], v[180:183]
    s_waitcnt lgkmcnt(0)
    s_barrier
    v_mfma_f32_16x16x32_bf16 v[64:67], v[16:19], a[132:135], v[64:67]
    s_add_u32 m0, s70, 20480
    ds_read_b64_tr_b16 v[184:185], v9 offset:40960
    v_mfma_f32_16x16x32_bf16 v[104:107], v[16:19], a[136:139], v[104:107]
    ds_read_b64_tr_b16 v[186:187], v9 offset:46080
    v_mfma_f32_16x16x32_bf16 v[144:147], v[16:19], a[140:143], v[144:147]
    ds_read_b64_tr_b16 v[188:189], v10 offset:40960
    v_mfma_f32_16x16x32_bf16 v[68:71], v[20:23], a[132:135], v[68:71]
    buffer_load_dwordx4 v4, s[84:87], s64 offen  lds
    s_add_u32 m0, s70, 21504
    v_mfma_f32_16x16x32_bf16 v[108:111], v[20:23], a[136:139], v[108:111]
    ds_read_b64_tr_b16 v[190:191], v10 offset:46080
    ds_read_b64_tr_b16 v[192:193], v9 offset:41024
    v_mfma_f32_16x16x32_bf16 v[148:151], v[20:23], a[140:143], v[148:151]
    v_mfma_f32_16x16x32_bf16 v[72:75], v[24:27], a[132:135], v[72:75]
    buffer_load_dwordx4 v5, s[84:87], s64 offen  lds
    s_add_u32 m0, s70, 22528
    v_mfma_f32_16x16x32_bf16 v[112:115], v[24:27], a[136:139], v[112:115]
    ds_read_b64_tr_b16 v[194:195], v9 offset:46144
    ds_read_b64_tr_b16 v[196:197], v10 offset:41024
    v_mfma_f32_16x16x32_bf16 v[152:155], v[24:27], a[140:143], v[152:155]
    ds_read_b64_tr_b16 v[198:199], v10 offset:46144
    v_mfma_f32_16x16x32_bf16 v[76:79], v[28:31], a[132:135], v[76:79]
    buffer_load_dwordx4 v6, s[84:87], s64 offen  lds
    s_add_u32 m0, s70, 23552
    v_mfma_f32_16x16x32_bf16 v[116:119], v[28:31], a[136:139], v[116:119]
    ds_read_b64_tr_b16 v[200:201], v9 offset:41088
    ds_read_b64_tr_b16 v[202:203], v9 offset:46208
    v_mfma_f32_16x16x32_bf16 v[156:159], v[28:31], a[140:143], v[156:159]
    v_mfma_f32_16x16x32_bf16 v[80:83], v[32:35], a[132:135], v[80:83]
    buffer_load_dwordx4 v7, s[84:87], s64 offen  lds
    s_add_u32 m0, s70, 24576
    v_mfma_f32_16x16x32_bf16 v[120:123], v[32:35], a[136:139], v[120:123]
    ds_read_b64_tr_b16 v[204:205], v10 offset:41088
    ds_read_b64_tr_b16 v[206:207], v10 offset:46208
    v_mfma_f32_16x16x32_bf16 v[160:163], v[32:35], a[140:143], v[160:163]
    ds_read_b64_tr_b16 v[208:209], v9 offset:41152
    v_mfma_f32_16x16x32_bf16 v[84:87], v[36:39], a[132:135], v[84:87]
    buffer_load_dwordx4 v8, s[84:87], s64 offen  lds
    s_add_u32 s64, s64, 81920
    v_mfma_f32_16x16x32_bf16 v[124:127], v[36:39], a[136:139], v[124:127]
    ds_read_b64_tr_b16 v[210:211], v9 offset:46272
    ds_read_b64_tr_b16 v[212:213], v10 offset:41152
    v_mfma_f32_16x16x32_bf16 v[164:167], v[36:39], a[140:143], v[164:167]
    v_mfma_f32_16x16x32_bf16 v[88:91], v[40:43], a[132:135], v[88:91]
    s_cmp_eq_u32 s64, 1310720
    s_cselect_b32 s64, 0, s64
    v_mfma_f32_16x16x32_bf16 v[128:131], v[40:43], a[136:139], v[128:131]
    ds_read_b64_tr_b16 v[214:215], v10 offset:46272
    ds_read_b64_tr_b16 v[216:217], v9 offset:41216
    v_mfma_f32_16x16x32_bf16 v[168:171], v[40:43], a[140:143], v[168:171]
    ds_read_b64_tr_b16 v[218:219], v9 offset:46336
    v_mfma_f32_16x16x32_bf16 v[92:95], v[44:47], a[132:135], v[92:95]
    buffer_load_dwordx4 a[4:7], v11, s[88:91], s16 offen offset:0 sc1
    ds_read_b64_tr_b16 v[220:221], v10 offset:41216
    v_mfma_f32_16x16x32_bf16 v[132:135], v[44:47], a[136:139], v[132:135]
    ds_read_b64_tr_b16 v[222:223], v10 offset:46336
    v_mfma_f32_16x16x32_bf16 v[172:175], v[44:47], a[140:143], v[172:175]
    v_mfma_f32_16x16x32_bf16 v[96:99], v[48:51], a[132:135], v[96:99]
    buffer_load_dwordx4 a[8:11], v12, s[88:91], s16 offen offset:0 sc1
    v_mfma_f32_16x16x32_bf16 v[136:139], v[48:51], a[136:139], v[136:139]
    v_mfma_f32_16x16x32_bf16 v[176:179], v[48:51], a[140:143], v[176:179]
    v_mfma_f32_16x16x32_bf16 v[100:103], v[52:55], a[132:135], v[100:103]
    v_mfma_f32_16x16x32_bf16 v[140:143], v[52:55], a[136:139], v[140:143]
    v_mfma_f32_16x16x32_bf16 v[180:183], v[52:55], a[140:143], v[180:183]
    s_waitcnt lgkmcnt(0)
    v_mfma_f32_16x16x32_bf16 v[64:67], v[184:187], a[144:147], v[64:67]
    buffer_load_dwordx4 a[12:15], v0, s[88:91], s16 offen offset:1024 sc1
    ds_read_b64_tr_b16 v[16:17], v9 offset:51200
    v_mfma_f32_16x16x32_bf16 v[104:107], v[184:187], a[148:151], v[104:107]
    ds_read_b64_tr_b16 v[18:19], v9 offset:56320
    v_mfma_f32_16x16x32_bf16 v[144:147], v[184:187], a[152:155], v[144:147]
    ds_read_b64_tr_b16 v[20:21], v10 offset:51200
    v_mfma_f32_16x16x32_bf16 v[68:71], v[188:191], a[144:147], v[68:71]
    ds_read_b64_tr_b16 v[22:23], v10 offset:56320
    v_mfma_f32_16x16x32_bf16 v[108:111], v[188:191], a[148:151], v[108:111]
    ds_read_b64_tr_b16 v[24:25], v9 offset:51264
    v_mfma_f32_16x16x32_bf16 v[148:151], v[188:191], a[152:155], v[148:151]
    v_mfma_f32_16x16x32_bf16 v[72:75], v[192:195], a[144:147], v[72:75]
    ds_read_b64_tr_b16 v[26:27], v9 offset:56384
    v_mfma_f32_16x16x32_bf16 v[112:115], v[192:195], a[148:151], v[112:115]
    ds_read_b64_tr_b16 v[28:29], v10 offset:51264
    v_mfma_f32_16x16x32_bf16 v[152:155], v[192:195], a[152:155], v[152:155]
    ds_read_b64_tr_b16 v[30:31], v10 offset:56384
    v_mfma_f32_16x16x32_bf16 v[76:79], v[196:199], a[144:147], v[76:79]
    ds_read_b64_tr_b16 v[32:33], v9 offset:51328
    v_mfma_f32_16x16x32_bf16 v[116:119], v[196:199], a[148:151], v[116:119]
    ds_read_b64_tr_b16 v[34:35], v9 offset:56448
    v_mfma_f32_16x16x32_bf16 v[156:159], v[196:199], a[152:155], v[156:159]
    v_mfma_f32_16x16x32_bf16 v[80:83], v[200:203], a[144:147], v[80:83]
    ds_read_b64_tr_b16 v[36:37], v10 offset:51328
    v_mfma_f32_16x16x32_bf16 v[120:123], v[200:203], a[148:151], v[120:123]
    ds_read_b64_tr_b16 v[38:39], v10 offset:56448
    v_mfma_f32_16x16x32_bf16 v[160:163], v[200:203], a[152:155], v[160:163]
    ds_read_b64_tr_b16 v[40:41], v9 offset:51392
    v_mfma_f32_16x16x32_bf16 v[84:87], v[204:207], a[144:147], v[84:87]
    ds_read_b64_tr_b16 v[42:43], v9 offset:56512
    v_mfma_f32_16x16x32_bf16 v[124:127], v[204:207], a[148:151], v[124:127]
    ds_read_b64_tr_b16 v[44:45], v10 offset:51392
    v_mfma_f32_16x16x32_bf16 v[164:167], v[204:207], a[152:155], v[164:167]
    v_mfma_f32_16x16x32_bf16 v[88:91], v[208:211], a[144:147], v[88:91]
    ds_read_b64_tr_b16 v[46:47], v10 offset:56512
    v_mfma_f32_16x16x32_bf16 v[128:131], v[208:211], a[148:151], v[128:131]
    ds_read_b64_tr_b16 v[48:49], v9 offset:51456
    v_mfma_f32_16x16x32_bf16 v[168:171], v[208:211], a[152:155], v[168:171]
    ds_read_b64_tr_b16 v[50:51], v9 offset:56576
    v_mfma_f32_16x16x32_bf16 v[92:95], v[212:215], a[144:147], v[92:95]
    ds_read_b64_tr_b16 v[52:53], v10 offset:51456
    v_mfma_f32_16x16x32_bf16 v[132:135], v[212:215], a[148:151], v[132:135]
    ds_read_b64_tr_b16 v[54:55], v10 offset:56576
    v_mfma_f32_16x16x32_bf16 v[172:175], v[212:215], a[152:155], v[172:175]
    v_mfma_f32_16x16x32_bf16 v[96:99], v[216:219], a[144:147], v[96:99]
    v_mfma_f32_16x16x32_bf16 v[136:139], v[216:219], a[148:151], v[136:139]
    v_mfma_f32_16x16x32_bf16 v[176:179], v[216:219], a[152:155], v[176:179]
    v_mfma_f32_16x16x32_bf16 v[100:103], v[220:223], a[144:147], v[100:103]
    v_mfma_f32_16x16x32_bf16 v[140:143], v[220:223], a[148:151], v[140:143]
    v_mfma_f32_16x16x32_bf16 v[180:183], v[220:223], a[152:155], v[180:183]
    s_waitcnt vmcnt(10) lgkmcnt(0)
    s_barrier
    v_mfma_f32_16x16x32_bf16 v[64:67], v[16:19], a[156:159], v[64:67]
    s_add_u32 m0, s70, 40960
    ds_read_b64_tr_b16 v[184:185], v9 offset:0
    v_mfma_f32_16x16x32_bf16 v[104:107], v[16:19], a[160:163], v[104:107]
    ds_read_b64_tr_b16 v[186:187], v9 offset:5120
    v_mfma_f32_16x16x32_bf16 v[144:147], v[16:19], a[164:167], v[144:147]
    ds_read_b64_tr_b16 v[188:189], v10 offset:0
    v_mfma_f32_16x16x32_bf16 v[68:71], v[20:23], a[156:159], v[68:71]
    buffer_load_dwordx4 v4, s[84:87], s64 offen  lds
    s_add_u32 m0, s70, 41984
    v_mfma_f32_16x16x32_bf16 v[108:111], v[20:23], a[160:163], v[108:111]
    ds_read_b64_tr_b16 v[190:191], v10 offset:5120
    ds_read_b64_tr_b16 v[192:193], v9 offset:64
    v_mfma_f32_16x16x32_bf16 v[148:151], v[20:23], a[164:167], v[148:151]
    v_mfma_f32_16x16x32_bf16 v[72:75], v[24:27], a[156:159], v[72:75]
    buffer_load_dwordx4 v5, s[84:87], s64 offen  lds
    s_add_u32 m0, s70, 43008
    v_mfma_f32_16x16x32_bf16 v[112:115], v[24:27], a[160:163], v[112:115]
    ds_read_b64_tr_b16 v[194:195], v9 offset:5184
    ds_read_b64_tr_b16 v[196:197], v10 offset:64
    v_mfma_f32_16x16x32_bf16 v[152:155], v[24:27], a[164:167], v[152:155]
    ds_read_b64_tr_b16 v[198:199], v10 offset:5184
    v_mfma_f32_16x16x32_bf16 v[76:79], v[28:31], a[156:159], v[76:79]
    buffer_load_dwordx4 v6, s[84:87], s64 offen  lds
    s_add_u32 m0, s70, 44032
    v_mfma_f32_16x16x32_bf16 v[116:119], v[28:31], a[160:163], v[116:119]
    ds_read_b64_tr_b16 v[200:201], v9 offset:128
    ds_read_b64_tr_b16 v[202:203], v9 offset:5248
    v_mfma_f32_16x16x32_bf16 v[156:159], v[28:31], a[164:167], v[156:159]
    v_mfma_f32_16x16x32_bf16 v[80:83], v[32:35], a[156:159], v[80:83]
    buffer_load_dwordx4 v7, s[84:87], s64 offen  lds
    s_add_u32 m0, s70, 45056
    v_mfma_f32_16x16x32_bf16 v[120:123], v[32:35], a[160:163], v[120:123]
    ds_read_b64_tr_b16 v[204:205], v10 offset:128
    ds_read_b64_tr_b16 v[206:207], v10 offset:5248
    v_mfma_f32_16x16x32_bf16 v[160:163], v[32:35], a[164:167], v[160:163]
    ds_read_b64_tr_b16 v[208:209], v9 offset:192
    v_mfma_f32_16x16x32_bf16 v[84:87], v[36:39], a[156:159], v[84:87]
    buffer_load_dwordx4 v8, s[84:87], s64 offen  lds
    s_add_u32 s64, s64, 81920
    v_mfma_f32_16x16x32_bf16 v[124:127], v[36:39], a[160:163], v[124:127]
    ds_read_b64_tr_b16 v[210:211], v9 offset:5312
    ds_read_b64_tr_b16 v[212:213], v10 offset:192
    v_mfma_f32_16x16x32_bf16 v[164:167], v[36:39], a[164:167], v[164:167]
    v_mfma_f32_16x16x32_bf16 v[88:91], v[40:43], a[156:159], v[88:91]
    s_cmp_eq_u32 s64, 1310720
    s_cselect_b32 s64, 0, s64
    v_mfma_f32_16x16x32_bf16 v[128:131], v[40:43], a[160:163], v[128:131]
    ds_read_b64_tr_b16 v[214:215], v10 offset:5312
    ds_read_b64_tr_b16 v[216:217], v9 offset:256
    v_mfma_f32_16x16x32_bf16 v[168:171], v[40:43], a[164:167], v[168:171]
    ds_read_b64_tr_b16 v[218:219], v9 offset:5376
    v_mfma_f32_16x16x32_bf16 v[92:95], v[44:47], a[156:159], v[92:95]
    buffer_load_dwordx4 a[16:19], v11, s[88:91], s16 offen offset:1024 sc1
    ds_read_b64_tr_b16 v[220:221], v10 offset:256
    v_mfma_f32_16x16x32_bf16 v[132:135], v[44:47], a[160:163], v[132:135]
    ds_read_b64_tr_b16 v[222:223], v10 offset:5376
    v_mfma_f32_16x16x32_bf16 v[172:175], v[44:47], a[164:167], v[172:175]
    v_mfma_f32_16x16x32_bf16 v[96:99], v[48:51], a[156:159], v[96:99]
    buffer_load_dwordx4 a[20:23], v12, s[88:91], s16 offen offset:1024 sc1
    v_mfma_f32_16x16x32_bf16 v[136:139], v[48:51], a[160:163], v[136:139]
    v_mfma_f32_16x16x32_bf16 v[176:179], v[48:51], a[164:167], v[176:179]
    v_mfma_f32_16x16x32_bf16 v[100:103], v[52:55], a[156:159], v[100:103]
    v_mfma_f32_16x16x32_bf16 v[140:143], v[52:55], a[160:163], v[140:143]
    v_mfma_f32_16x16x32_bf16 v[180:183], v[52:55], a[164:167], v[180:183]
    s_waitcnt lgkmcnt(0)
    v_mfma_f32_16x16x32_bf16 v[64:67], v[184:187], a[168:171], v[64:67]
    buffer_load_dwordx4 a[24:27], v0, s[88:91], s16 offen offset:2048 sc1
    ds_read_b64_tr_b16 v[16:17], v9 offset:10240
    v_mfma_f32_16x16x32_bf16 v[104:107], v[184:187], a[172:175], v[104:107]
    ds_read_b64_tr_b16 v[18:19], v9 offset:15360
    v_mfma_f32_16x16x32_bf16 v[144:147], v[184:187], a[176:179], v[144:147]
    ds_read_b64_tr_b16 v[20:21], v10 offset:10240
    v_mfma_f32_16x16x32_bf16 v[68:71], v[188:191], a[168:171], v[68:71]
    ds_read_b64_tr_b16 v[22:23], v10 offset:15360
    v_mfma_f32_16x16x32_bf16 v[108:111], v[188:191], a[172:175], v[108:111]
    ds_read_b64_tr_b16 v[24:25], v9 offset:10304
    v_mfma_f32_16x16x32_bf16 v[148:151], v[188:191], a[176:179], v[148:151]
    v_mfma_f32_16x16x32_bf16 v[72:75], v[192:195], a[168:171], v[72:75]
    ds_read_b64_tr_b16 v[26:27], v9 offset:15424
    v_mfma_f32_16x16x32_bf16 v[112:115], v[192:195], a[172:175], v[112:115]
    ds_read_b64_tr_b16 v[28:29], v10 offset:10304
    v_mfma_f32_16x16x32_bf16 v[152:155], v[192:195], a[176:179], v[152:155]
    ds_read_b64_tr_b16 v[30:31], v10 offset:15424
    v_mfma_f32_16x16x32_bf16 v[76:79], v[196:199], a[168:171], v[76:79]
    ds_read_b64_tr_b16 v[32:33], v9 offset:10368
    v_mfma_f32_16x16x32_bf16 v[116:119], v[196:199], a[172:175], v[116:119]
    ds_read_b64_tr_b16 v[34:35], v9 offset:15488
    v_mfma_f32_16x16x32_bf16 v[156:159], v[196:199], a[176:179], v[156:159]
    v_mfma_f32_16x16x32_bf16 v[80:83], v[200:203], a[168:171], v[80:83]
    ds_read_b64_tr_b16 v[36:37], v10 offset:10368
    v_mfma_f32_16x16x32_bf16 v[120:123], v[200:203], a[172:175], v[120:123]
    buffer_load_dwordx4 a[28:31], v11, s[88:91], s16 offen offset:2048 sc1
    ds_read_b64_tr_b16 v[38:39], v10 offset:15488
    v_mfma_f32_16x16x32_bf16 v[160:163], v[200:203], a[176:179], v[160:163]
    ds_read_b64_tr_b16 v[40:41], v9 offset:10432
    v_mfma_f32_16x16x32_bf16 v[84:87], v[204:207], a[168:171], v[84:87]
    ds_read_b64_tr_b16 v[42:43], v9 offset:15552
    v_mfma_f32_16x16x32_bf16 v[124:127], v[204:207], a[172:175], v[124:127]
    ds_read_b64_tr_b16 v[44:45], v10 offset:10432
    v_mfma_f32_16x16x32_bf16 v[164:167], v[204:207], a[176:179], v[164:167]
    v_mfma_f32_16x16x32_bf16 v[88:91], v[208:211], a[168:171], v[88:91]
    ds_read_b64_tr_b16 v[46:47], v10 offset:15552
    v_mfma_f32_16x16x32_bf16 v[128:131], v[208:211], a[172:175], v[128:131]
    ds_read_b64_tr_b16 v[48:49], v9 offset:10496
    v_mfma_f32_16x16x32_bf16 v[168:171], v[208:211], a[176:179], v[168:171]
    ds_read_b64_tr_b16 v[50:51], v9 offset:15616
    v_mfma_f32_16x16x32_bf16 v[92:95], v[212:215], a[168:171], v[92:95]
    ds_read_b64_tr_b16 v[52:53], v10 offset:10496
    v_mfma_f32_16x16x32_bf16 v[132:135], v[212:215], a[172:175], v[132:135]
    ds_read_b64_tr_b16 v[54:55], v10 offset:15616
    v_mfma_f32_16x16x32_bf16 v[172:175], v[212:215], a[176:179], v[172:175]
    v_mfma_f32_16x16x32_bf16 v[96:99], v[216:219], a[168:171], v[96:99]
    v_mfma_f32_16x16x32_bf16 v[136:139], v[216:219], a[172:175], v[136:139]
    v_mfma_f32_16x16x32_bf16 v[176:179], v[216:219], a[176:179], v[176:179]
    v_mfma_f32_16x16x32_bf16 v[100:103], v[220:223], a[168:171], v[100:103]
    v_mfma_f32_16x16x32_bf16 v[140:143], v[220:223], a[172:175], v[140:143]
    v_mfma_f32_16x16x32_bf16 v[180:183], v[220:223], a[176:179], v[180:183]
    s_waitcnt vmcnt(12) lgkmcnt(0)
    s_barrier
    v_mfma_f32_16x16x32_bf16 v[64:67], v[16:19], a[180:183], v[64:67]
    s_add_u32 m0, s70, 0
    ds_read_b64_tr_b16 v[184:185], v9 offset:20480
    v_mfma_f32_16x16x32_bf16 v[104:107], v[16:19], a[184:187], v[104:107]
    ds_read_b64_tr_b16 v[186:187], v9 offset:25600
    v_mfma_f32_16x16x32_bf16 v[144:147], v[16:19], a[188:191], v[144:147]
    ds_read_b64_tr_b16 v[188:189], v10 offset:20480
    v_mfma_f32_16x16x32_bf16 v[68:71], v[20:23], a[180:183], v[68:71]
    buffer_load_dwordx4 v4, s[84:87], s64 offen  lds
    s_add_u32 m0, s70, 1024
    v_mfma_f32_16x16x32_bf16 v[108:111], v[20:23], a[184:187], v[108:111]
    ds_read_b64_tr_b16 v[190:191], v10 offset:25600
    ds_read_b64_tr_b16 v[192:193], v9 offset:20544
    v_mfma_f32_16x16x32_bf16 v[148:151], v[20:23], a[188:191], v[148:151]
    v_mfma_f32_16x16x32_bf16 v[72:75], v[24:27], a[180:183], v[72:75]
    ds_read_b64_tr_b16 v[194:195], v9 offset:25664
    v_mfma_f32_16x16x32_bf16 v[112:115], v[24:27], a[184:187], v[112:115]
    buffer_load_dwordx4 v5, s[84:87], s64 offen  lds
    s_add_u32 m0, s70, 2048
    v_mfma_f32_16x16x32_bf16 v[152:155], v[24:27], a[188:191], v[152:155]
    ds_read_b64_tr_b16 v[196:197], v10 offset:20544
    ds_read_b64_tr_b16 v[198:199], v10 offset:25664
    v_mfma_f32_16x16x32_bf16 v[76:79], v[28:31], a[180:183], v[76:79]
    ds_read_b64_tr_b16 v[200:201], v9 offset:20608
    v_mfma_f32_16x16x32_bf16 v[116:119], v[28:31], a[184:187], v[116:119]
    ds_read_b64_tr_b16 v[202:203], v9 offset:25728
    v_mfma_f32_16x16x32_bf16 v[156:159], v[28:31], a[188:191], v[156:159]
    buffer_load_dwordx4 v6, s[84:87], s64 offen  lds
    s_add_u32 m0, s70, 3072
    v_mfma_f32_16x16x32_bf16 v[80:83], v[32:35], a[180:183], v[80:83]
    ds_read_b64_tr_b16 v[204:205], v10 offset:20608
    v_mfma_f32_16x16x32_bf16 v[120:123], v[32:35], a[184:187], v[120:123]
    ds_read_b64_tr_b16 v[206:207], v10 offset:25728
    v_mfma_f32_16x16x32_bf16 v[160:163], v[32:35], a[188:191], v[160:163]
    ds_read_b64_tr_b16 v[208:209], v9 offset:20672
    v_mfma_f32_16x16x32_bf16 v[84:87], v[36:39], a[180:183], v[84:87]
    buffer_load_dwordx4 v7, s[84:87], s64 offen  lds
    s_add_u32 m0, s70, 4096
    v_mfma_f32_16x16x32_bf16 v[124:127], v[36:39], a[184:187], v[124:127]
    ds_read_b64_tr_b16 v[210:211], v9 offset:25792
    ds_read_b64_tr_b16 v[212:213], v10 offset:20672
    v_mfma_f32_16x16x32_bf16 v[164:167], v[36:39], a[188:191], v[164:167]
    v_mfma_f32_16x16x32_bf16 v[88:91], v[40:43], a[180:183], v[88:91]
    ds_read_b64_tr_b16 v[214:215], v10 offset:25792
    v_mfma_f32_16x16x32_bf16 v[128:131], v[40:43], a[184:187], v[128:131]
    buffer_load_dwordx4 v8, s[84:87], s64 offen  lds
    s_add_u32 s64, s64, 81920
    v_mfma_f32_16x16x32_bf16 v[168:171], v[40:43], a[188:191], v[168:171]
    ds_read_b64_tr_b16 v[216:217], v9 offset:20736
    ds_read_b64_tr_b16 v[218:219], v9 offset:25856
    v_mfma_f32_16x16x32_bf16 v[92:95], v[44:47], a[180:183], v[92:95]
    ds_read_b64_tr_b16 v[220:221], v10 offset:20736
    v_mfma_f32_16x16x32_bf16 v[132:135], v[44:47], a[184:187], v[132:135]
    ds_read_b64_tr_b16 v[222:223], v10 offset:25856
    v_mfma_f32_16x16x32_bf16 v[172:175], v[44:47], a[188:191], v[172:175]
    s_cmp_eq_u32 s64, 1310720
    s_cselect_b32 s64, 0, s64
    v_mfma_f32_16x16x32_bf16 v[96:99], v[48:51], a[180:183], v[96:99]
    v_mfma_f32_16x16x32_bf16 v[136:139], v[48:51], a[184:187], v[136:139]
    v_mfma_f32_16x16x32_bf16 v[176:179], v[48:51], a[188:191], v[176:179]
    v_mfma_f32_16x16x32_bf16 v[100:103], v[52:55], a[180:183], v[100:103]
    v_mfma_f32_16x16x32_bf16 v[140:143], v[52:55], a[184:187], v[140:143]
    v_mfma_f32_16x16x32_bf16 v[180:183], v[52:55], a[188:191], v[180:183]
    s_waitcnt vmcnt(7) lgkmcnt(0)
    s_branch L_T1
L_FALLBACK:
    s_mov_b32 s78, 1
    s_mov_b32 s71, 0
    s_mov_b32 s72, 4096
    s_mov_b32 s68, 31
    s_waitcnt vmcnt(0) lgkmcnt(0)
    v_mov_b32 v40, 0xff800000
    v_mov_b32 v44, 0xff800000
    v_mov_b32 v48, 0xff800000
    v_mov_b32 v52, 0xff800000
    v_mov_b32 v56, 0xff800000
    v_mov_b32 v60, 0xff800000
L_FBLOOP:
    s_barrier
    s_add_u32 m0, s75, 0
    s_add_u32 s71, s71, 1024
    s_and_b32 s71, s71, 0x3ffff
    s_nop 0
    buffer_load_dwordx4 v0, s[52:55], s71 offen nt lds
    s_add_u32 m0, s75, 1056
    s_add_u32 s71, s71, 1024
    s_and_b32 s71, s71, 0x3ffff
    s_nop 0
    buffer_load_dwordx4 v0, s[52:55], s71 offen nt lds
    s_add_u32 m0, s75, 2112
    s_add_u32 s71, s71, 1024
    s_and_b32 s71, s71, 0x3ffff
    s_nop 0
    buffer_load_dwordx4 v0, s[52:55], s71 offen nt lds
    s_add_u32 m0, s75, 3168
    s_add_u32 s71, s71, 1024
    s_and_b32 s71, s71, 0x3ffff
    s_nop 0
    buffer_load_dwordx4 v0, s[52:55], s71 offen nt lds
    s_add_u32 m0, s75, 4224
    s_add_u32 s71, s71, 1024
    s_and_b32 s71, s71, 0x3ffff
    s_nop 0
    buffer_load_dwordx4 v0, s[52:55], s71 offen nt lds
    s_add_u32 m0, s75, 5280
    s_add_u32 s71, s71, 1024
    s_and_b32 s71, s71, 0x3ffff
    s_nop 0
    buffer_load_dwordx4 v0, s[52:55], s71 offen nt lds
    s_add_u32 m0, s75, 6336
    s_add_u32 s71, s71, 1024
    s_and_b32 s71, s71, 0x3ffff
    s_nop 0
    buffer_load_dwordx4 v0, s[52:55], s71 offen nt lds
    s_add_u32 m0, s75, 7392
    s_add_u32 s71, s71, 1024
    s_and_b32 s71, s71, 0x3ffff
    s_nop 0
    buffer_load_dwordx4 v0, s[52:55], s71 offen nt lds
    s_waitcnt vmcnt(0)
    s_barrier
    ds_read_b128 a[96:99], v2 offset:0
    ds_read_b128 a[100:103], v2 offset:64
    ds_read_b128 a[104:107], v2 offset:128
    ds_read_b128 a[108:111], v2 offset:192
    ds_read_b128 a[112:115], v2 offset:512
    ds_read_b128 a[116:119], v2 offset:576
    ds_read_b128 a[120:123], v2 offset:640
    ds_read_b128 a[124:127], v2 offset:704
    s_waitcnt lgkmcnt(0)
    v_mfma_f32_16x16x32_bf16 v[64:67], a[96:99], a[0:3], 0
    v_mfma_f32_16x16x32_bf16 v[72:75], a[96:99], a[16:19], 0
    v_mfma_f32_16x16x32_bf16 v[80:83], a[96:99], a[32:35], 0
    v_mfma_f32_16x16x32_bf16 v[88:91], a[96:99], a[48:51], 0
    v_mfma_f32_16x16x32_bf16 v[96:99], a[96:99], a[64:67], 0
    v_mfma_f32_16x16x32_bf16 v[104:107], a[96:99], a[80:83], 0
    v_mfma_f32_16x16x32_bf16 v[64:67], a[100:103], a[4:7], v[64:67]
    v_mfma_f32_16x16x32_bf16 v[72:75], a[100:103], a[20:23], v[72:75]
    v_mfma_f32_16x16x32_bf16 v[80:83], a[100:103], a[36:39], v[80:83]
    v_mfma_f32_16x16x32_bf16 v[88:91], a[100:103], a[52:55], v[88:91]
    v_mfma_f32_16x16x32_bf16 v[96:99], a[100:103], a[68:71], v[96:99]
    v_mfma_f32_16x16x32_bf16 v[104:107], a[100:103], a[84:87], v[104:107]
    v_mfma_f32_16x16x32_bf16 v[64:67], a[104:107], a[8:11], v[64:67]
    v_mfma_f32_16x16x32_bf16 v[72:75], a[104:107], a[24:27], v[72:75]
    v_mfma_f32_16x16x32_bf16 v[80:83], a[104:107], a[40:43], v[80:83]
    v_mfma_f32_16x16x32_bf16 v[88:91], a[104:107], a[56:59], v[88:91]
    v_mfma_f32_16x16x32_bf16 v[96:99], a[104:107], a[72:75], v[96:99]
    v_mfma_f32_16x16x32_bf16 v[104:107], a[104:107], a[88:91], v[104:107]
    v_mfma_f32_16x16x32_bf16 v[64:67], a[108:111], a[12:15], v[64:67]
    v_mfma_f32_16x16x32_bf16 v[72:75], a[108:111], a[28:31], v[72:75]
    v_mfma_f32_16x16x32_bf16 v[80:83], a[108:111], a[44:47], v[80:83]
    v_mfma_f32_16x16x32_bf16 v[88:91], a[108:111], a[60:63], v[88:91]
    v_mfma_f32_16x16x32_bf16 v[96:99], a[108:111], a[76:79], v[96:99]
    v_mfma_f32_16x16x32_bf16 v[104:107], a[108:111], a[92:95], v[104:107]
    v_mfma_f32_16x16x32_bf16 v[68:71], a[112:115], a[0:3], 0
    v_mfma_f32_16x16x32_bf16 v[76:79], a[112:115], a[16:19], 0
    v_mfma_f32_16x16x32_bf16 v[84:87], a[112:115], a[32:35], 0
    v_mfma_f32_16x16x32_bf16 v[92:95], a[112:115], a[48:51], 0
    v_mfma_f32_16x16x32_bf16 v[100:103], a[112:115], a[64:67], 0
    v_mfma_f32_16x16x32_bf16 v[108:111], a[112:115], a[80:83], 0
    v_mfma_f32_16x16x32_bf16 v[68:71], a[116:119], a[4:7], v[68:71]
    v_mfma_f32_16x16x32_bf16 v[76:79], a[116:119], a[20:23], v[76:79]
    v_mfma_f32_16x16x32_bf16 v[84:87], a[116:119], a[36:39], v[84:87]
    v_mfma_f32_16x16x32_bf16 v[92:95], a[116:119], a[52:55], v[92:95]
    v_mfma_f32_16x16x32_bf16 v[100:103], a[116:119], a[68:71], v[100:103]
    v_mfma_f32_16x16x32_bf16 v[108:111], a[116:119], a[84:87], v[108:111]
    v_mfma_f32_16x16x32_bf16 v[68:71], a[120:123], a[8:11], v[68:71]
    v_mfma_f32_16x16x32_bf16 v[76:79], a[120:123], a[24:27], v[76:79]
    v_mfma_f32_16x16x32_bf16 v[84:87], a[120:123], a[40:43], v[84:87]
    v_mfma_f32_16x16x32_bf16 v[92:95], a[120:123], a[56:59], v[92:95]
    v_mfma_f32_16x16x32_bf16 v[100:103], a[120:123], a[72:75], v[100:103]
    v_mfma_f32_16x16x32_bf16 v[108:111], a[120:123], a[88:91], v[108:111]
    v_mfma_f32_16x16x32_bf16 v[68:71], a[124:127], a[12:15], v[68:71]
    v_mfma_f32_16x16x32_bf16 v[76:79], a[124:127], a[28:31], v[76:79]
    v_mfma_f32_16x16x32_bf16 v[84:87], a[124:127], a[44:47], v[84:87]
    v_mfma_f32_16x16x32_bf16 v[92:95], a[124:127], a[60:63], v[92:95]
    v_mfma_f32_16x16x32_bf16 v[100:103], a[124:127], a[76:79], v[100:103]
    v_mfma_f32_16x16x32_bf16 v[108:111], a[124:127], a[92:95], v[108:111]
    s_nop 7
    v_max3_f32 v40, v40, v64, v65
    v_max3_f32 v44, v44, v72, v73
    v_max3_f32 v48, v48, v80, v81
    v_max3_f32 v52, v52, v88, v89
    v_max3_f32 v56, v56, v96, v97
    v_max3_f32 v60, v60, v104, v105
    v_max3_f32 v40, v40, v66, v67
    v_max3_f32 v44, v44, v74, v75
    v_max3_f32 v48, v48, v82, v83
    v_max3_f32 v52, v52, v90, v91
    v_max3_f32 v56, v56, v98, v99
    v_max3_f32 v60, v60, v106, v107
    v_max3_f32 v40, v40, v68, v69
    v_max3_f32 v44, v44, v76, v77
    v_max3_f32 v48, v48, v84, v85
    v_max3_f32 v52, v52, v92, v93
    v_max3_f32 v56, v56, v100, v101
    v_max3_f32 v60, v60, v108, v109
    v_max3_f32 v40, v40, v70, v71
    v_max3_f32 v44, v44, v78, v79
    v_max3_f32 v48, v48, v86, v87
    v_max3_f32 v52, v52, v94, v95
    v_max3_f32 v56, v56, v102, v103
    v_max3_f32 v60, v60, v110, v111
    s_sub_u32 s68, s68, 1
    s_cbranch_scc0 L_FBLOOP
    v_mov_b32 v41, v40
    v_mov_b32 v42, v40
    v_mov_b32 v43, v40
    v_mov_b32 v45, v44
    v_mov_b32 v46, v44
    v_mov_b32 v47, v44
    v_mov_b32 v49, v48
    v_mov_b32 v50, v48
    v_mov_b32 v51, v48
    v_mov_b32 v53, v52
    v_mov_b32 v54, v52
    v_mov_b32 v55, v52
    v_mov_b32 v57, v56
    v_mov_b32 v58, v56
    v_mov_b32 v59, v56
    v_mov_b32 v61, v60
    v_mov_b32 v62, v60
    v_mov_b32 v63, v60
    s_barrier
    s_add_u32 m0, s75, 0
    s_add_u32 s71, s71, 1024
    s_and_b32 s71, s71, 0x3ffff
    s_nop 0
    buffer_load_dwordx4 v0, s[52:55], s71 offen nt lds
    s_add_u32 m0, s75, 1056
    s_add_u32 s71, s71, 1024
    s_and_b32 s71, s71, 0x3ffff
    s_nop 0
    buffer_load_dwordx4 v0, s[52:55], s71 offen nt lds
    s_add_u32 m0, s75, 2112
    s_add_u32 s71, s71, 1024
    s_and_b32 s71, s71, 0x3ffff
    s_nop 0
    buffer_load_dwordx4 v0, s[52:55], s71 offen nt lds
    s_add_u32 m0, s75, 3168
    s_add_u32 s71, s71, 1024
    s_and_b32 s71, s71, 0x3ffff
    s_nop 0
    buffer_load_dwordx4 v0, s[52:55], s71 offen nt lds
    s_add_u32 m0, s75, 4224
    s_add_u32 s71, s71, 1024
    s_and_b32 s71, s71, 0x3ffff
    s_nop 0
    buffer_load_dwordx4 v0, s[52:55], s71 offen nt lds
    s_add_u32 m0, s75, 5280
    s_add_u32 s71, s71, 1024
    s_and_b32 s71, s71, 0x3ffff
    s_nop 0
    buffer_load_dwordx4 v0, s[52:55], s71 offen nt lds
    s_add_u32 m0, s75, 6336
    s_add_u32 s71, s71, 1024
    s_and_b32 s71, s71, 0x3ffff
    s_nop 0
    buffer_load_dwordx4 v0, s[52:55], s71 offen nt lds
    s_add_u32 m0, s75, 7392
    s_add_u32 s71, s71, 1024
    s_and_b32 s71, s71, 0x3ffff
    s_nop 0
    buffer_load_dwordx4 v0, s[52:55], s71 offen nt lds
    s_add_u32 m0, s75, 33664
    s_add_u32 s71, s71, 1024
    s_and_b32 s71, s71, 0x3ffff
    s_nop 0
    buffer_load_dwordx4 v0, s[52:55], s71 offen nt lds
    s_add_u32 m0, s75, 34720
    s_add_u32 s71, s71, 1024
    s_and_b32 s71, s71, 0x3ffff
    s_nop 0
    buffer_load_dwordx4 v0, s[52:55], s71 offen nt lds
    s_add_u32 m0, s75, 35776
    s_add_u32 s71, s71, 1024
    s_and_b32 s71, s71, 0x3ffff
    s_nop 0
    buffer_load_dwordx4 v0, s[52:55], s71 offen nt lds
    s_add_u32 m0, s75, 36832
    s_add_u32 s71, s71, 1024
    s_and_b32 s71, s71, 0x3ffff
    s_nop 0
    buffer_load_dwordx4 v0, s[52:55], s71 offen nt lds
    s_add_u32 m0, s75, 37888
    s_add_u32 s71, s71, 1024
    s_and_b32 s71, s71, 0x3ffff
    s_nop 0
    buffer_load_dwordx4 v0, s[52:55], s71 offen nt lds
    s_add_u32 m0, s75, 38944
    s_add_u32 s71, s71, 1024
    s_and_b32 s71, s71, 0x3ffff
    s_nop 0
    buffer_load_dwordx4 v0, s[52:55], s71 offen nt lds
    s_add_u32 m0, s75, 40000
    s_add_u32 s71, s71, 1024
    s_and_b32 s71, s71, 0x3ffff
    s_nop 0
    buffer_load_dwordx4 v0, s[52:55], s71 offen nt lds
    s_add_u32 m0, s75, 41056
    s_add_u32 s71, s71, 1024
    s_and_b32 s71, s71, 0x3ffff
    s_nop 0
    buffer_load_dwordx4 v0, s[52:55], s71 offen nt lds
    s_add_u32 m0, s75, 67328
    s_add_u32 s71, s71, 1024
    s_and_b32 s71, s71, 0x3ffff
    s_nop 0
    buffer_load_dwordx4 v0, s[52:55], s71 offen nt lds
    s_add_u32 m0, s75, 68384
    s_add_u32 s71, s71, 1024
    s_and_b32 s71, s71, 0x3ffff
    s_nop 0
    buffer_load_dwordx4 v0, s[52:55], s71 offen nt lds
    s_add_u32 m0, s75, 69440
    s_add_u32 s71, s71, 1024
    s_and_b32 s71, s71, 0x3ffff
    s_nop 0
    buffer_load_dwordx4 v0, s[52:55], s71 offen nt lds
    s_add_u32 m0, s75, 70496
    s_add_u32 s71, s71, 1024
    s_and_b32 s71, s71, 0x3ffff
    s_nop 0
    buffer_load_dwordx4 v0, s[52:55], s71 offen nt lds
    s_add_u32 m0, s75, 71552
    s_add_u32 s71, s71, 1024
    s_and_b32 s71, s71, 0x3ffff
    s_nop 0
    buffer_load_dwordx4 v0, s[52:55], s71 offen nt lds
    s_add_u32 m0, s75, 72608
    s_add_u32 s71, s71, 1024
    s_and_b32 s71, s71, 0x3ffff
    s_nop 0
    buffer_load_dwordx4 v0, s[52:55], s71 offen nt lds
    s_add_u32 m0, s75, 73664
    s_add_u32 s71, s71, 1024
    s_and_b32 s71, s71, 0x3ffff
    s_nop 0
    buffer_load_dwordx4 v0, s[52:55], s71 offen nt lds
    s_add_u32 m0, s75, 74720
    s_add_u32 s71, s71, 1024
    s_and_b32 s71, s71, 0x3ffff
    s_nop 0
    buffer_load_dwordx4 v0, s[52:55], s71 offen nt lds
    s_add_u32 m0, s75, 100992
    s_add_u32 s71, s71, 1024
    s_and_b32 s71, s71, 0x3ffff
    s_nop 0
    buffer_load_dwordx4 v0, s[52:55], s71 offen nt lds
    s_add_u32 m0, s75, 102048
    s_add_u32 s71, s71, 1024
    s_and_b32 s71, s71, 0x3ffff
    s_nop 0
    buffer_load_dwordx4 v0, s[52:55], s71 offen nt lds
    s_add_u32 m0, s75, 103104
    s_add_u32 s71, s71, 1024
    s_and_b32 s71, s71, 0x3ffff
    s_nop 0
    buffer_load_dwordx4 v0, s[52:55], s71 offen nt lds
    s_add_u32 m0, s75, 104160
    s_add_u32 s71, s71, 1024
    s_and_b32 s71, s71, 0x3ffff
    s_nop 0
    buffer_load_dwordx4 v0, s[52:55], s71 offen nt lds
    s_add_u32 m0, s75, 105216
    s_add_u32 s71, s71, 1024
    s_and_b32 s71, s71, 0x3ffff
    s_nop 0
    buffer_load_dwordx4 v0, s[52:55], s71 offen nt lds
    s_add_u32 m0, s75, 106272
    s_add_u32 s71, s71, 1024
    s_and_b32 s71, s71, 0x3ffff
    s_nop 0
    buffer_load_dwordx4 v0, s[52:55], s71 offen nt lds
    s_add_u32 m0, s75, 107328
    s_add_u32 s71, s71, 1024
    s_and_b32 s71, s71, 0x3ffff
    s_nop 0
    buffer_load_dwordx4 v0, s[52:55], s71 offen nt lds
    s_add_u32 m0, s75, 108384
    s_add_u32 s71, s71, 1024
    s_and_b32 s71, s71, 0x3ffff
    s_nop 0
    buffer_load_dwordx4 v0, s[52:55], s71 offen nt lds
    s_waitcnt vmcnt(0)
    s_add_u32 s73, s75, 67328
    s_mov_b32 s72, s75
    s_mov_b32 s74, 67328
    s_mov_b32 s68, 11
    s_barrier
    ds_read_b128 a[96:99], v2 offset:0
    ds_read_b128 a[100:103], v2 offset:64
    ds_read_b128 a[104:107], v2 offset:128
    ds_read_b128 a[108:111], v2 offset:192
    ds_read_b128 a[112:115], v2 offset:512
    ds_read_b128 a[116:119], v2 offset:576
    ds_read_b128 a[120:123], v2 offset:640
    ds_read_b128 a[124:127], v2 offset:704
    ds_read_b64_tr_b16 a[160:161], v3 offset:0
    ds_read_b64_tr_b16 a[162:163], v3 offset:512
    ds_read_b64_tr_b16 a[164:165], v3 offset:32
    ds_read_b64_tr_b16 a[166:167], v3 offset:544
    ds_read_b64_tr_b16 a[168:169], v3 offset:64
    ds_read_b64_tr_b16 a[170:171], v3 offset:576
    ds_read_b64_tr_b16 a[172:173], v3 offset:96
    ds_read_b64_tr_b16 a[174:175], v3 offset:608
    ds_read_b64_tr_b16 a[176:177], v3 offset:128
    ds_read_b64_tr_b16 a[178:179], v3 offset:640
    ds_read_b64_tr_b16 a[180:181], v3 offset:160
    ds_read_b64_tr_b16 a[182:183], v3 offset:672
    ds_read_b64_tr_b16 a[184:185], v3 offset:192
    ds_read_b64_tr_b16 a[186:187], v3 offset:704
    ds_read_b64_tr_b16 a[188:189], v3 offset:224
    ds_read_b64_tr_b16 a[190:191], v3 offset:736
    v_max3_f32 v40, v40, v41, v42
    v_max_f32 v40, v40, v43
    v_mov_b32 v41, v40
    s_nop 1
    v_permlane16_swap_b32 v40, v41
    v_max_f32 v40, v40, v41
    v_mov_b32 v41, v40
    s_nop 1
    v_permlane32_swap_b32 v40, v41
    v_max_f32 v40, v40, v41
    v_sub_f32 v43, 0, v40
    v_sub_f32 v42, 0, v40
    v_sub_f32 v41, 0, v40
    v_sub_f32 v40, 0, v40
    v_max3_f32 v44, v44, v45, v46
    v_max_f32 v44, v44, v47
    v_mov_b32 v45, v44
    s_nop 1
    v_permlane16_swap_b32 v44, v45
    v_max_f32 v44, v44, v45
    v_mov_b32 v45, v44
    s_nop 1
    v_permlane32_swap_b32 v44, v45
    v_max_f32 v44, v44, v45
    v_sub_f32 v47, 0, v44
    v_sub_f32 v46, 0, v44
    v_sub_f32 v45, 0, v44
    v_sub_f32 v44, 0, v44
    v_max3_f32 v48, v48, v49, v50
    v_max_f32 v48, v48, v51
    v_mov_b32 v49, v48
    s_nop 1
    v_permlane16_swap_b32 v48, v49
    v_max_f32 v48, v48, v49
    v_mov_b32 v49, v48
    s_nop 1
    v_permlane32_swap_b32 v48, v49
    v_max_f32 v48, v48, v49
    v_sub_f32 v51, 0, v48
    v_sub_f32 v50, 0, v48
    v_sub_f32 v49, 0, v48
    v_sub_f32 v48, 0, v48
    v_max3_f32 v52, v52, v53, v54
    v_max_f32 v52, v52, v55
    v_mov_b32 v53, v52
    s_nop 1
    v_permlane16_swap_b32 v52, v53
    v_max_f32 v52, v52, v53
    v_mov_b32 v53, v52
    s_nop 1
    v_permlane32_swap_b32 v52, v53
    v_max_f32 v52, v52, v53
    v_sub_f32 v55, 0, v52
    v_sub_f32 v54, 0, v52
    v_sub_f32 v53, 0, v52
    v_sub_f32 v52, 0, v52
    v_max3_f32 v56, v56, v57, v58
    v_max_f32 v56, v56, v59
    v_mov_b32 v57, v56
    s_nop 1
    v_permlane16_swap_b32 v56, v57
    v_max_f32 v56, v56, v57
    v_mov_b32 v57, v56
    s_nop 1
    v_permlane32_swap_b32 v56, v57
    v_max_f32 v56, v56, v57
    v_sub_f32 v59, 0, v56
    v_sub_f32 v58, 0, v56
    v_sub_f32 v57, 0, v56
    v_sub_f32 v56, 0, v56
    v_max3_f32 v60, v60, v61, v62
    v_max_f32 v60, v60, v63
    v_mov_b32 v61, v60
    s_nop 1
    v_permlane16_swap_b32 v60, v61
    v_max_f32 v60, v60, v61
    v_mov_b32 v61, v60
    s_nop 1
    v_permlane32_swap_b32 v60, v61
    v_max_f32 v60, v60, v61
    v_sub_f32 v63, 0, v60
    v_sub_f32 v62, 0, v60
    v_sub_f32 v61, 0, v60
    v_sub_f32 v60, 0, v60
    s_waitcnt lgkmcnt(0)
    s_branch L_W0
.fill (67584 - (. - concat_heads__mha_block_cached__gqa_block_cached__near_ridge_kernel)) / 4, 4, 0xbf800000
.section .rodata,"a"
.p2align 6
.amdhsa_kernel concat_heads__mha_block_cached__gqa_block_cached__near_ridge_kernel
  .amdhsa_next_free_vgpr 512
  .amdhsa_next_free_sgpr 102
  .amdhsa_accum_offset 256
  .amdhsa_group_segment_fixed_size 0
  .amdhsa_kernarg_size 104
  .amdhsa_user_sgpr_count 2
  .amdhsa_user_sgpr_kernarg_segment_ptr 1
  .amdhsa_system_sgpr_workgroup_id_x 1
.end_amdhsa_kernel
```
